```python
import torch

def _softmax(x, axis=-1):
    return torch.softmax(x, dim=axis)
def _gelu(x):
    return torch.nn.functional.gelu(x, approximate="tanh")
def _silu(x):
    return torch.nn.functional.silu(x)
def _sigmoid(x):
    return torch.sigmoid(x)
def _layernorm(x, axis=-1, eps=1e-5):
    m = x.mean(dim=axis, keepdim=True)
    v = x.var(dim=axis, keepdim=True, unbiased=False)
    return (x - m) / torch.sqrt(v + eps)
def _scatter_add(tgt, idx, src, axis=0):
    return tgt.clone().index_add_(axis, idx, src)
def _segment_sum(src, seg, n):
    out = torch.zeros((n,) + src.shape[1:], dtype=src.dtype)
    return out.index_add_(0, seg, src)
def _pad(x, pw):
    flat = tuple(v for pair in reversed(pw) for v in pair)
    return torch.nn.functional.pad(x, flat)

kernel_name = 'recurrent_scan__sliding_local_dilated__dense_activation_silu__prompt'

def setup_inputs():

    _w = (lambda a: (lambda t: t.to(torch.bfloat16) if t.is_floating_point() else t)(torch.as_tensor(a)))
    def _A_setup():
        B, S, D = 1, 2048, 640
        return {
            "x": _w((lambda *s: torch.randn(*s, dtype=torch.bfloat16) * 0.1)(B, S, D)),
            "wqkv": _w((lambda *s: torch.randn(*s, dtype=torch.bfloat16) * 0.2)(D, 3 * D)),
            "wo": _w((lambda *s: torch.randn(*s, dtype=torch.bfloat16) * 0.4)(D, D)),
        }
    _A_in = _A_setup()

    def _B_setup():
        B, S, D, F = 1, 2048, 640, 1728
        return {
            "x": _w((lambda *s: torch.randn(*s, dtype=torch.bfloat16) * 0.1)(B, S, D)),
            "w1": _w((lambda *s: torch.randn(*s, dtype=torch.bfloat16) * 3.2)(D, F) * (D ** -0.5)),
            "w2": _w((lambda *s: torch.randn(*s, dtype=torch.bfloat16) * 3.2)(F, D) * (F ** -0.5)),
        }
    _B_in = _B_setup()

    return {
        "A_x": _A_in["x"],
        "A_wqkv": _A_in["wqkv"],
        "A_wo": _A_in["wo"],
        "B_x": _B_in["x"],
        "B_w1": _B_in["w1"],
        "B_w2": _B_in["w2"],
    }

def reference(A_x, A_wqkv, A_wo, B_x, B_w1, B_w2):
    def _A_ref(x, wqkv, wo):
        B, S, D = x.shape
        H = 32; Dh = D // H
        W, dil = 8, 2
        qkv = (lambda x, *d: x.permute(*d))((x @ wqkv).reshape(B, S, 3, H, Dh), 2, 0, 3, 1, 4)
        q, k, v = qkv[0], qkv[1], qkv[2]
        scale = Dh ** -0.5
        pos = torch.arange(S)
        off = torch.arange(W) * dil
        idx = pos[:, None] - off[None, :]
        mask = idx >= 0
        idx_c = torch.where(mask, idx, 0).reshape(-1)
        kg = k[:, :, idx_c, :].reshape(B, H, S, W, Dh)
        vg = v[:, :, idx_c, :].reshape(B, H, S, W, Dh)
        logits = torch.einsum("bhsd,bhswd->bhsw", q, kg) * scale
        logits = torch.where(mask[None, None, :, :], logits, -1e9)
        attn = _softmax(logits, axis=-1)
        o = torch.einsum("bhsw,bhswd->bhsd", attn, vg)
        return (lambda x, *d: x.permute(*d))(o, 0, 2, 1, 3).reshape(B, S, D) @ wo

    def _B_ref(x, w1, w2):
        h = torch.einsum("bsd,df->bsf", x, w1)
        h = _silu(h)
        out = torch.einsum("bsf,fd->bsd", h, w2)
        return out

    x = A_x
    xn = _layernorm(x, axis=-1)
    s = _A_ref(xn, A_wqkv, A_wo)
    g = _silu(_B_ref(xn, B_w1, B_w2))
    return x + s * g
```

```asm
; @launch kernel=rs_g1_kernel grid=(256,1,1) block=(512,1,1) lds=163840
; @launch kernel=rs_g2_kernel grid=(256,1,1) block=(512,1,1) lds=163840
.amdgcn_target "amdgcn-amd-amdhsa--gfx950"
.text
.globl rs_g1_kernel
.p2align 8
.type rs_g1_kernel,@function
rs_g1_kernel:
    s_cmp_ge_u32 s2, 256
    s_cbranch_scc1 L_k1_end
    s_load_dwordx2 s[50:51], s[0:1], 0
    s_load_dwordx4 s[52:55], s[0:1], 8
    s_load_dwordx4 s[56:59], s[0:1], 32
    s_load_dwordx2 s[60:61], s[0:1], 64
    v_lshrrev_b32 v1, 6, v0
    s_nop 0
    v_readfirstlane_b32 s20, v1
    s_and_b32 s3, s2, 7
    s_lshr_b32 s4, s2, 3
    s_and_b32 s5, s3, 1
    s_lshr_b32 s6, s3, 1
    s_waitcnt lgkmcnt(0)
    s_cmp_ge_u32 s4, 30
    s_cbranch_scc1 L_k1_r
    s_mov_b32 s12, s50
    s_and_b32 s13, s51, 0xffff
    s_mov_b32 s14, 0x280000
    s_mov_b32 s15, 0x00020000
    s_add_u32 s16, s60, 0x400000
    s_addc_u32 s17, s61, 0
    s_and_b32 s17, s17, 0xffff
    s_mov_b32 s18, 0x940000
    s_mov_b32 s19, 0x00020000
    s_cmp_ge_u32 s4, 16
    s_cbranch_scc1 L_k1_h
    s_lshr_b32 s7, s4, 3
    s_lshl_b32 s25, s6, 1
    s_add_u32 s25, s25, s7
    s_and_b32 s7, s4, 7
    s_lshl_b32 s24, s5, 3
    s_add_u32 s24, s24, s7
    s_mov_b32 s8, s52
    s_and_b32 s9, s53, 0xffff
    s_mov_b32 s10, 0x258000
    s_mov_b32 s11, 0x00020000
    s_mov_b32 s23, 0
    v_and_b32 v1, 63, v0
    s_lshl_b32 s26, s24, 3
    s_add_u32 s26, s26, s20
    s_mul_i32 s26, s26, 20480
    v_lshrrev_b32 v204, 4, v1
    v_mul_u32_u24 v204, 1280, v204
    v_and_b32 v205, 15, v1
    v_lshl_add_u32 v204, v205, 4, v204
    v_add_u32 v204, s26, v204
    s_lshl_b32 s26, s24, 7
    s_lshl_b32 s27, s20, 1
    s_add_u32 s26, s26, s27
    s_sub_i32 s26, s26, 16
    s_max_i32 s26, s26, 0
    v_lshrrev_b32 v205, 5, v1
    v_add_u32 v205, s26, v205
    v_mul_u32_u24 v205, 1280, v205
    v_and_b32 v206, 31, v1
    v_lshl_add_u32 v205, v206, 4, v205
    v_mov_b32 v124, 0
    v_mov_b32 v125, 0
    v_mov_b32 v126, 0
    v_mov_b32 v127, 0
    buffer_load_dwordx4 v[116:119], v205, s[12:15], 0 offen offset:0
    buffer_load_dwordx4 v[120:123], v205, s[12:15], 0 offen offset:512
    s_mov_b32 exec_lo, 0x0000ffff
    s_mov_b32 exec_hi, 0x0000ffff
    buffer_load_dwordx4 v[124:127], v205, s[12:15], 0 offen offset:1024
    s_mov_b64 exec, -1
    s_movk_i32 s27, 0
    buffer_load_dwordx4 v[36:39], v204, s[12:15], s27 offen offset:0
    buffer_load_dwordx4 v[40:43], v204, s[12:15], s27 offen offset:256
    buffer_load_dwordx4 v[44:47], v204, s[12:15], s27 offen offset:512
    buffer_load_dwordx4 v[48:51], v204, s[12:15], s27 offen offset:768
    buffer_load_dwordx4 v[52:55], v204, s[12:15], s27 offen offset:1024
    s_movk_i32 s27, 5120
    buffer_load_dwordx4 v[56:59], v204, s[12:15], s27 offen offset:0
    buffer_load_dwordx4 v[60:63], v204, s[12:15], s27 offen offset:256
    buffer_load_dwordx4 v[64:67], v204, s[12:15], s27 offen offset:512
    buffer_load_dwordx4 v[68:71], v204, s[12:15], s27 offen offset:768
    buffer_load_dwordx4 v[72:75], v204, s[12:15], s27 offen offset:1024
    v_and_b32 v1, 63, v0
    v_lshlrev_b32 v2, 4, v1
    s_and_b32 s21, s20, 3
    s_lshr_b32 s22, s20, 2
    s_lshl_b32 s28, s20, 11
    v_lshrrev_b32 v128, 5, v1
    v_and_b32 v129, 31, v1
    s_lshl_b32 s26, s20, 2
    v_add_u32 v130, s26, v128
    v_add_u32 v130, 0, v130
    v_and_b32 v131, 7, v130
    v_lshlrev_b32 v131, 1, v131
    v_xor_b32 v131, v131, v129
    v_and_b32 v132, 0x13, v130
    v_and_b32 v133, 4, v130
    v_lshl_or_b32 v132, v133, 1, v132
    v_and_b32 v133, 8, v130
    v_lshrrev_b32 v133, 1, v133
    v_or_b32 v132, v132, v133
    s_movk_i32 s26, 3840
    v_mul_lo_u32 v132, v132, s26
    v_min_u32 v131, 29, v131
    v_mul_u32_u24 v133, 26, v131
    v_lshrrev_b32 v133, 8, v133
    v_mul_u32_u24 v133, 1120, v133
    v_add_u32 v132, v132, v133
    v_lshl_add_u32 v132, v131, 4, v132
    s_mul_i32 s26, s25, 160
    v_add_u32 v8, s26, v132
    s_lshl_b32 s26, s20, 2
    v_add_u32 v130, s26, v128
    v_add_u32 v130, 2, v130
    v_and_b32 v131, 7, v130
    v_lshlrev_b32 v131, 1, v131
    v_xor_b32 v131, v131, v129
    v_and_b32 v132, 0x13, v130
    v_and_b32 v133, 4, v130
    v_lshl_or_b32 v132, v133, 1, v132
    v_and_b32 v133, 8, v130
    v_lshrrev_b32 v133, 1, v133
    v_or_b32 v132, v132, v133
    s_movk_i32 s26, 3840
    v_mul_lo_u32 v132, v132, s26
    v_min_u32 v131, 29, v131
    v_mul_u32_u24 v133, 26, v131
    v_lshrrev_b32 v133, 8, v133
    v_mul_u32_u24 v133, 1120, v133
    v_add_u32 v132, v132, v133
    v_lshl_add_u32 v132, v131, 4, v132
    s_mul_i32 s26, s25, 160
    v_add_u32 v9, s26, v132
    v_lshrrev_b32 v128, 4, v1
    v_bfe_u32 v129, v1, 2, 2
    v_and_b32 v130, 1, v128
    v_lshl_add_u32 v130, v130, 2, v129
    v_lshlrev_b32 v130, 1, v130
    v_lshrrev_b32 v131, 1, v128
    v_lshlrev_b32 v131, 4, v131
    v_lshrrev_b32 v132, 1, v130
    v_add_u32 v131, v131, v132
    v_lshlrev_b32 v131, 9, v131
    v_and_b32 v132, 3, v1
    v_lshlrev_b32 v132, 3, v132
    s_mul_i32 s26, s22, 80
    s_add_u32 s26, s26, 0
    v_add_u32 v133, s26, v132
    v_lshrrev_b32 v134, 4, v133
    v_xor_b32 v134, v134, v130
    v_and_b32 v133, 8, v133
    v_lshl_add_u32 v133, v134, 4, v133
    v_add_u32 v10, v133, v131
    v_add_u32 v21, 0x10000, v10
    s_mul_i32 s26, s22, 80
    s_add_u32 s26, s26, 32
    v_add_u32 v133, s26, v132
    v_lshrrev_b32 v134, 4, v133
    v_xor_b32 v134, v134, v130
    v_and_b32 v133, 8, v133
    v_lshl_add_u32 v133, v134, 4, v133
    v_add_u32 v11, v133, v131
    v_add_u32 v22, 0x10000, v11
    s_mul_i32 s26, s22, 80
    s_add_u32 s26, s26, 64
    v_add_u32 v133, s26, v132
    v_lshrrev_b32 v134, 4, v133
    v_xor_b32 v134, v134, v130
    v_and_b32 v133, 8, v133
    v_lshl_add_u32 v133, v134, 4, v133
    v_add_u32 v12, v133, v131
    v_add_u32 v23, 0x10000, v12
    s_mul_i32 s26, s22, 80
    s_add_u32 s26, s26, 160
    v_add_u32 v133, s26, v132
    v_lshrrev_b32 v134, 4, v133
    v_xor_b32 v134, v134, v130
    v_and_b32 v133, 8, v133
    v_lshl_add_u32 v133, v134, 4, v133
    v_add_u32 v13, v133, v131
    v_add_u32 v24, 0x10000, v13
    s_mul_i32 s26, s22, 80
    s_add_u32 s26, s26, 192
    v_add_u32 v133, s26, v132
    v_lshrrev_b32 v134, 4, v133
    v_xor_b32 v134, v134, v130
    v_and_b32 v133, 8, v133
    v_lshl_add_u32 v133, v134, 4, v133
    v_add_u32 v14, v133, v131
    v_add_u32 v25, 0x10000, v14
    s_mul_i32 s26, s22, 80
    s_add_u32 s26, s26, 224
    v_add_u32 v133, s26, v132
    v_lshrrev_b32 v134, 4, v133
    v_xor_b32 v134, v134, v130
    v_and_b32 v133, 8, v133
    v_lshl_add_u32 v133, v134, 4, v133
    v_add_u32 v15, v133, v131
    v_add_u32 v26, 0x10000, v15
    s_mul_i32 s26, s22, 80
    s_add_u32 s26, s26, 320
    v_add_u32 v133, s26, v132
    v_lshrrev_b32 v134, 4, v133
    v_xor_b32 v134, v134, v130
    v_and_b32 v133, 8, v133
    v_lshl_add_u32 v133, v134, 4, v133
    v_add_u32 v16, v133, v131
    v_add_u32 v27, 0x10000, v16
    s_mul_i32 s26, s22, 80
    s_add_u32 s26, s26, 352
    v_add_u32 v133, s26, v132
    v_lshrrev_b32 v134, 4, v133
    v_xor_b32 v134, v134, v130
    v_and_b32 v133, 8, v133
    v_lshl_add_u32 v133, v134, 4, v133
    v_add_u32 v17, v133, v131
    v_add_u32 v28, 0x10000, v17
    s_mul_i32 s26, s22, 80
    s_add_u32 s26, s26, 384
    v_add_u32 v133, s26, v132
    v_lshrrev_b32 v134, 4, v133
    v_xor_b32 v134, v134, v130
    v_and_b32 v133, 8, v133
    v_lshl_add_u32 v133, v134, 4, v133
    v_add_u32 v18, v133, v131
    v_add_u32 v29, 0x10000, v18
    s_min_u32 s27, s21, 2
    s_lshl_b32 s27, s27, 5
    s_mul_i32 s26, s22, 80
    s_add_u32 s26, s26, s27
    s_add_u32 s26, s26, 160
    v_add_u32 v133, s26, v132
    v_lshrrev_b32 v134, 4, v133
    v_xor_b32 v134, v134, v130
    v_and_b32 v133, 8, v133
    v_lshl_add_u32 v133, v134, 4, v133
    v_add_u32 v19, v133, v131
    v_add_u32 v30, 0x10000, v19
    s_min_u32 s27, s21, 2
    s_lshl_b32 s27, s27, 5
    s_mul_i32 s26, s22, 80
    s_add_u32 s26, s26, s27
    s_add_u32 s26, s26, 320
    v_add_u32 v133, s26, v132
    v_lshrrev_b32 v134, 4, v133
    v_xor_b32 v134, v134, v130
    v_and_b32 v133, 8, v133
    v_lshl_add_u32 v133, v134, 4, v133
    v_add_u32 v20, v133, v131
    v_add_u32 v31, 0x10000, v20
    v_and_b32 v128, 15, v1
    v_lshrrev_b32 v129, 4, v1
    v_lshrrev_b32 v130, 2, v128
    v_sub_u32 v130, 4, v130
    v_and_b32 v130, 3, v130
    v_xor_b32 v129, v129, v130
    v_lshlrev_b32 v128, 6, v128
    v_lshl_add_u32 v128, v129, 4, v128
    v_add_u32 v33, 0x14000, v128
    s_lshl_b32 s26, s21, 11
    s_add_u32 s26, s26, 1024
    v_add_u32 v32, s26, v33
    v_add_u32 v35, 37120, v32
    v_lshrrev_b32 v128, 4, v1
    v_lshlrev_b32 v128, 6, v128
    v_bfe_u32 v129, v1, 2, 2
    v_mul_u32_u24 v129, 9280, v129
    v_add_u32 v128, v128, v129
    s_lshl_b32 s26, s20, 10
    s_add_u32 s26, s26, 0x14400
    v_add_u32 v128, s26, v128
    v_and_b32 v129, 3, v1
    v_xor_b32 v130, 0, v129
    v_lshl_add_u32 v4, v130, 4, v128
    v_add_u32 v4, 0, v4
    v_xor_b32 v130, 3, v129
    v_lshl_add_u32 v5, v130, 4, v128
    v_add_u32 v5, 256, v5
    v_xor_b32 v130, 2, v129
    v_lshl_add_u32 v6, v130, 4, v128
    v_add_u32 v6, 512, v6
    v_xor_b32 v130, 1, v129
    v_lshl_add_u32 v7, v130, 4, v128
    v_add_u32 v7, 768, v7
    v_lshrrev_b32 v128, 5, v1
    s_lshl_b32 s26, s20, 1
    v_add_u32 v128, s26, v128
    v_lshlrev_b32 v128, 6, v128
    v_bfe_u32 v130, v1, 2, 2
    v_mul_u32_u24 v130, 9280, v130
    v_add_u32 v128, v128, v130
    s_lshr_b32 s26, s20, 1
    s_sub_u32 s26, 4, s26
    s_and_b32 s26, s26, 3
    v_xor_b32 v130, s26, v129
    v_lshl_add_u32 v128, v130, 4, v128
    v_add_u32 v34, 0x14000, v128
    s_mov_b32 s64, 0xf000f
    s_mov_b32 s65, 0xf000f
    s_mov_b32 s66, 0xf000f0
    s_mov_b32 s67, 0xf000f0
    s_mov_b32 s68, 0xf000f00
    s_mov_b32 s69, 0xf000f00
    s_mov_b32 s70, 0xf000f000
    s_mov_b32 s71, 0xf000f000
    v_mov_b32 v198, 0x3f803f80
    s_movk_i32 s27, 10240
    buffer_load_dwordx4 v[76:79], v204, s[12:15], s27 offen offset:0
    buffer_load_dwordx4 v[80:83], v204, s[12:15], s27 offen offset:256
    buffer_load_dwordx4 v[84:87], v204, s[12:15], s27 offen offset:512
    buffer_load_dwordx4 v[88:91], v204, s[12:15], s27 offen offset:768
    buffer_load_dwordx4 v[92:95], v204, s[12:15], s27 offen offset:1024
    s_waitcnt vmcnt(10)
    v_dot2_f32_bf16 v128, v116, v198, 0
    v_dot2_f32_bf16 v132, v36, v198, 0
    v_dot2_f32_bf16 v129, v116, v116, 0
    v_dot2_f32_bf16 v133, v36, v36, 0
    v_dot2_f32_bf16 v130, v117, v198, 0
    v_dot2_f32_bf16 v134, v37, v198, 0
    v_dot2_f32_bf16 v131, v117, v117, 0
    v_dot2_f32_bf16 v135, v37, v37, 0
    v_dot2_f32_bf16 v128, v118, v198, v128
    v_dot2_f32_bf16 v132, v38, v198, v132
    v_dot2_f32_bf16 v129, v118, v118, v129
    v_dot2_f32_bf16 v133, v38, v38, v133
    v_dot2_f32_bf16 v130, v119, v198, v130
    v_dot2_f32_bf16 v134, v39, v198, v134
    v_dot2_f32_bf16 v131, v119, v119, v131
    v_dot2_f32_bf16 v135, v39, v39, v135
    v_dot2_f32_bf16 v128, v120, v198, v128
    v_dot2_f32_bf16 v132, v40, v198, v132
    v_dot2_f32_bf16 v129, v120, v120, v129
    v_dot2_f32_bf16 v133, v40, v40, v133
    v_dot2_f32_bf16 v130, v121, v198, v130
    v_dot2_f32_bf16 v134, v41, v198, v134
    v_dot2_f32_bf16 v131, v121, v121, v131
    v_dot2_f32_bf16 v135, v41, v41, v135
    v_dot2_f32_bf16 v128, v122, v198, v128
    v_dot2_f32_bf16 v132, v42, v198, v132
    v_dot2_f32_bf16 v129, v122, v122, v129
    v_dot2_f32_bf16 v133, v42, v42, v133
    v_dot2_f32_bf16 v130, v123, v198, v130
    v_dot2_f32_bf16 v134, v43, v198, v134
    v_dot2_f32_bf16 v131, v123, v123, v131
    v_dot2_f32_bf16 v135, v43, v43, v135
    v_dot2_f32_bf16 v128, v124, v198, v128
    v_dot2_f32_bf16 v132, v44, v198, v132
    v_dot2_f32_bf16 v129, v124, v124, v129
    v_dot2_f32_bf16 v133, v44, v44, v133
    v_dot2_f32_bf16 v130, v125, v198, v130
    v_dot2_f32_bf16 v134, v45, v198, v134
    v_dot2_f32_bf16 v131, v125, v125, v131
    v_dot2_f32_bf16 v135, v45, v45, v135
    v_dot2_f32_bf16 v128, v126, v198, v128
    v_dot2_f32_bf16 v132, v46, v198, v132
    v_dot2_f32_bf16 v129, v126, v126, v129
    v_dot2_f32_bf16 v133, v46, v46, v133
    v_dot2_f32_bf16 v130, v127, v198, v130
    v_dot2_f32_bf16 v134, v47, v198, v134
    v_dot2_f32_bf16 v131, v127, v127, v131
    v_dot2_f32_bf16 v135, v47, v47, v135
    v_dot2_f32_bf16 v132, v48, v198, v132
    v_dot2_f32_bf16 v133, v48, v48, v133
    v_dot2_f32_bf16 v134, v49, v198, v134
    v_dot2_f32_bf16 v135, v49, v49, v135
    v_dot2_f32_bf16 v132, v50, v198, v132
    v_dot2_f32_bf16 v133, v50, v50, v133
    v_dot2_f32_bf16 v134, v51, v198, v134
    v_dot2_f32_bf16 v135, v51, v51, v135
    v_dot2_f32_bf16 v132, v52, v198, v132
    v_dot2_f32_bf16 v133, v52, v52, v133
    v_dot2_f32_bf16 v134, v53, v198, v134
    v_dot2_f32_bf16 v135, v53, v53, v135
    v_dot2_f32_bf16 v132, v54, v198, v132
    v_dot2_f32_bf16 v133, v54, v54, v133
    v_dot2_f32_bf16 v134, v55, v198, v134
    v_dot2_f32_bf16 v135, v55, v55, v135
    s_nop 3
    v_add_f32 v128, v128, v130
    v_add_f32 v129, v129, v131
    v_add_f32 v132, v132, v134
    v_add_f32 v133, v133, v135
    s_nop 1
    v_add_f32_dpp v128, v128, v128 row_ror:8 row_mask:0xf bank_mask:0xf
    v_add_f32_dpp v129, v129, v129 row_ror:8 row_mask:0xf bank_mask:0xf
    v_add_f32_dpp v132, v132, v132 row_ror:8 row_mask:0xf bank_mask:0xf
    v_add_f32_dpp v133, v133, v133 row_ror:8 row_mask:0xf bank_mask:0xf
    s_nop 1
    v_add_f32_dpp v128, v128, v128 row_ror:4 row_mask:0xf bank_mask:0xf
    v_add_f32_dpp v129, v129, v129 row_ror:4 row_mask:0xf bank_mask:0xf
    v_add_f32_dpp v132, v132, v132 row_ror:4 row_mask:0xf bank_mask:0xf
    v_add_f32_dpp v133, v133, v133 row_ror:4 row_mask:0xf bank_mask:0xf
    s_nop 1
    v_add_f32_dpp v128, v128, v128 row_ror:2 row_mask:0xf bank_mask:0xf
    v_add_f32_dpp v129, v129, v129 row_ror:2 row_mask:0xf bank_mask:0xf
    v_add_f32_dpp v132, v132, v132 row_ror:2 row_mask:0xf bank_mask:0xf
    v_add_f32_dpp v133, v133, v133 row_ror:2 row_mask:0xf bank_mask:0xf
    s_nop 1
    v_add_f32_dpp v128, v128, v128 row_ror:1 row_mask:0xf bank_mask:0xf
    v_add_f32_dpp v129, v129, v129 row_ror:1 row_mask:0xf bank_mask:0xf
    v_add_f32_dpp v132, v132, v132 row_ror:1 row_mask:0xf bank_mask:0xf
    v_add_f32_dpp v133, v133, v133 row_ror:1 row_mask:0xf bank_mask:0xf
    s_nop 1
    v_mov_b32 v140, v128
    v_mov_b32 v141, v129
    s_nop 1
    v_permlane16_swap_b32 v128, v140
    v_permlane16_swap_b32 v129, v141
    s_nop 1
    v_add_f32 v128, v128, v140
    v_add_f32 v129, v129, v141
    s_mov_b32 s26, 0x3acccccd
    s_mov_b32 s27, 0x3727c5ac
    v_mul_f32 v128, s26, v128
    v_mul_f32 v132, s26, v132
    v_mul_f32 v129, s26, v129
    v_mul_f32 v133, s26, v133
    v_fma_f32 v129, -v128, v128, v129
    v_fma_f32 v133, -v132, v132, v133
    v_max_f32 v129, 0, v129
    v_max_f32 v133, 0, v133
    v_cvt_pk_bf16_f32 v128, 0, v128
    v_cvt_pk_bf16_f32 v132, 0, v132
    v_cvt_pk_bf16_f32 v129, 0, v129
    v_cvt_pk_bf16_f32 v133, 0, v133
    v_add_f32 v129, s27, v129
    v_add_f32 v133, s27, v133
    v_cvt_pk_bf16_f32 v129, 0, v129
    v_cvt_pk_bf16_f32 v133, 0, v133
    v_sqrt_f32 v129, v129
    v_sqrt_f32 v133, v133
    s_nop 0
    v_xor_b32 v128, 0x80000000, v128
    v_xor_b32 v132, 0x80000000, v132
    v_cvt_pk_bf16_f32 v129, 0, v129
    v_cvt_pk_bf16_f32 v133, 0, v133
    v_rcp_f32 v140, v129
    v_rcp_f32 v141, v133
    s_nop 0
    v_fma_f32 v129, -v129, v140, 2.0
    v_fma_f32 v133, -v133, v141, 2.0
    v_mul_f32 v129, v140, v129
    v_mul_f32 v133, v141, v133
    v_lshlrev_b32 v148, 16, v116
    v_and_b32 v149, 0xffff0000, v116
    v_lshlrev_b32 v150, 16, v117
    v_and_b32 v151, 0xffff0000, v117
    v_lshlrev_b32 v152, 16, v118
    v_and_b32 v153, 0xffff0000, v118
    v_lshlrev_b32 v154, 16, v119
    v_and_b32 v155, 0xffff0000, v119
    v_pk_add_f32 v[148:149], v[148:149], v[128:129] op_sel_hi:[1,0]
    v_pk_add_f32 v[150:151], v[150:151], v[128:129] op_sel_hi:[1,0]
    v_pk_add_f32 v[152:153], v[152:153], v[128:129] op_sel_hi:[1,0]
    v_pk_add_f32 v[154:155], v[154:155], v[128:129] op_sel_hi:[1,0]
    v_cvt_pk_bf16_f32 v148, 0, v148
    v_cvt_pk_bf16_f32 v149, 0, v149
    v_cvt_pk_bf16_f32 v150, 0, v150
    v_cvt_pk_bf16_f32 v151, 0, v151
    v_cvt_pk_bf16_f32 v152, 0, v152
    v_cvt_pk_bf16_f32 v153, 0, v153
    v_cvt_pk_bf16_f32 v154, 0, v154
    v_cvt_pk_bf16_f32 v155, 0, v155
    v_pk_mul_f32 v[148:149], v[148:149], v[128:129] op_sel:[0,1] op_sel_hi:[1,1]
    v_pk_mul_f32 v[150:151], v[150:151], v[128:129] op_sel:[0,1] op_sel_hi:[1,1]
    v_pk_mul_f32 v[152:153], v[152:153], v[128:129] op_sel:[0,1] op_sel_hi:[1,1]
    v_pk_mul_f32 v[154:155], v[154:155], v[128:129] op_sel:[0,1] op_sel_hi:[1,1]
    v_cvt_pk_bf16_f32 v116, v148, v149
    v_cvt_pk_bf16_f32 v117, v150, v151
    v_cvt_pk_bf16_f32 v118, v152, v153
    v_cvt_pk_bf16_f32 v119, v154, v155
    v_lshlrev_b32 v148, 16, v120
    v_and_b32 v149, 0xffff0000, v120
    v_lshlrev_b32 v150, 16, v121
    v_and_b32 v151, 0xffff0000, v121
    v_lshlrev_b32 v152, 16, v122
    v_and_b32 v153, 0xffff0000, v122
    v_lshlrev_b32 v154, 16, v123
    v_and_b32 v155, 0xffff0000, v123
    v_pk_add_f32 v[148:149], v[148:149], v[128:129] op_sel_hi:[1,0]
    v_pk_add_f32 v[150:151], v[150:151], v[128:129] op_sel_hi:[1,0]
    v_pk_add_f32 v[152:153], v[152:153], v[128:129] op_sel_hi:[1,0]
    v_pk_add_f32 v[154:155], v[154:155], v[128:129] op_sel_hi:[1,0]
    v_cvt_pk_bf16_f32 v148, 0, v148
    v_cvt_pk_bf16_f32 v149, 0, v149
    v_cvt_pk_bf16_f32 v150, 0, v150
    v_cvt_pk_bf16_f32 v151, 0, v151
    v_cvt_pk_bf16_f32 v152, 0, v152
    v_cvt_pk_bf16_f32 v153, 0, v153
    v_cvt_pk_bf16_f32 v154, 0, v154
    v_cvt_pk_bf16_f32 v155, 0, v155
    v_pk_mul_f32 v[148:149], v[148:149], v[128:129] op_sel:[0,1] op_sel_hi:[1,1]
    v_pk_mul_f32 v[150:151], v[150:151], v[128:129] op_sel:[0,1] op_sel_hi:[1,1]
    v_pk_mul_f32 v[152:153], v[152:153], v[128:129] op_sel:[0,1] op_sel_hi:[1,1]
    v_pk_mul_f32 v[154:155], v[154:155], v[128:129] op_sel:[0,1] op_sel_hi:[1,1]
    v_cvt_pk_bf16_f32 v120, v148, v149
    v_cvt_pk_bf16_f32 v121, v150, v151
    v_cvt_pk_bf16_f32 v122, v152, v153
    v_cvt_pk_bf16_f32 v123, v154, v155
    v_lshlrev_b32 v148, 16, v124
    v_and_b32 v149, 0xffff0000, v124
    v_lshlrev_b32 v150, 16, v125
    v_and_b32 v151, 0xffff0000, v125
    v_lshlrev_b32 v152, 16, v126
    v_and_b32 v153, 0xffff0000, v126
    v_lshlrev_b32 v154, 16, v127
    v_and_b32 v155, 0xffff0000, v127
    v_pk_add_f32 v[148:149], v[148:149], v[128:129] op_sel_hi:[1,0]
    v_pk_add_f32 v[150:151], v[150:151], v[128:129] op_sel_hi:[1,0]
    v_pk_add_f32 v[152:153], v[152:153], v[128:129] op_sel_hi:[1,0]
    v_pk_add_f32 v[154:155], v[154:155], v[128:129] op_sel_hi:[1,0]
    v_cvt_pk_bf16_f32 v148, 0, v148
    v_cvt_pk_bf16_f32 v149, 0, v149
    v_cvt_pk_bf16_f32 v150, 0, v150
    v_cvt_pk_bf16_f32 v151, 0, v151
    v_cvt_pk_bf16_f32 v152, 0, v152
    v_cvt_pk_bf16_f32 v153, 0, v153
    v_cvt_pk_bf16_f32 v154, 0, v154
    v_cvt_pk_bf16_f32 v155, 0, v155
    v_pk_mul_f32 v[148:149], v[148:149], v[128:129] op_sel:[0,1] op_sel_hi:[1,1]
    v_pk_mul_f32 v[150:151], v[150:151], v[128:129] op_sel:[0,1] op_sel_hi:[1,1]
    v_pk_mul_f32 v[152:153], v[152:153], v[128:129] op_sel:[0,1] op_sel_hi:[1,1]
    v_pk_mul_f32 v[154:155], v[154:155], v[128:129] op_sel:[0,1] op_sel_hi:[1,1]
    v_cvt_pk_bf16_f32 v124, v148, v149
    v_cvt_pk_bf16_f32 v125, v150, v151
    v_cvt_pk_bf16_f32 v126, v152, v153
    v_cvt_pk_bf16_f32 v127, v154, v155
    v_lshlrev_b32 v148, 16, v36
    v_and_b32 v149, 0xffff0000, v36
    v_lshlrev_b32 v150, 16, v37
    v_and_b32 v151, 0xffff0000, v37
    v_lshlrev_b32 v152, 16, v38
    v_and_b32 v153, 0xffff0000, v38
    v_lshlrev_b32 v154, 16, v39
    v_and_b32 v155, 0xffff0000, v39
    v_pk_add_f32 v[148:149], v[148:149], v[132:133] op_sel_hi:[1,0]
    v_pk_add_f32 v[150:151], v[150:151], v[132:133] op_sel_hi:[1,0]
    v_pk_add_f32 v[152:153], v[152:153], v[132:133] op_sel_hi:[1,0]
    v_pk_add_f32 v[154:155], v[154:155], v[132:133] op_sel_hi:[1,0]
    v_cvt_pk_bf16_f32 v148, 0, v148
    v_cvt_pk_bf16_f32 v149, 0, v149
    v_cvt_pk_bf16_f32 v150, 0, v150
    v_cvt_pk_bf16_f32 v151, 0, v151
    v_cvt_pk_bf16_f32 v152, 0, v152
    v_cvt_pk_bf16_f32 v153, 0, v153
    v_cvt_pk_bf16_f32 v154, 0, v154
    v_cvt_pk_bf16_f32 v155, 0, v155
    v_pk_mul_f32 v[148:149], v[148:149], v[132:133] op_sel:[0,1] op_sel_hi:[1,1]
    v_pk_mul_f32 v[150:151], v[150:151], v[132:133] op_sel:[0,1] op_sel_hi:[1,1]
    v_pk_mul_f32 v[152:153], v[152:153], v[132:133] op_sel:[0,1] op_sel_hi:[1,1]
    v_pk_mul_f32 v[154:155], v[154:155], v[132:133] op_sel:[0,1] op_sel_hi:[1,1]
    v_cvt_pk_bf16_f32 v36, v148, v149
    v_cvt_pk_bf16_f32 v37, v150, v151
    v_cvt_pk_bf16_f32 v38, v152, v153
    v_cvt_pk_bf16_f32 v39, v154, v155
    v_lshlrev_b32 v148, 16, v40
    v_and_b32 v149, 0xffff0000, v40
    v_lshlrev_b32 v150, 16, v41
    v_and_b32 v151, 0xffff0000, v41
    v_lshlrev_b32 v152, 16, v42
    v_and_b32 v153, 0xffff0000, v42
    v_lshlrev_b32 v154, 16, v43
    v_and_b32 v155, 0xffff0000, v43
    v_pk_add_f32 v[148:149], v[148:149], v[132:133] op_sel_hi:[1,0]
    v_pk_add_f32 v[150:151], v[150:151], v[132:133] op_sel_hi:[1,0]
    v_pk_add_f32 v[152:153], v[152:153], v[132:133] op_sel_hi:[1,0]
    v_pk_add_f32 v[154:155], v[154:155], v[132:133] op_sel_hi:[1,0]
    v_cvt_pk_bf16_f32 v148, 0, v148
    v_cvt_pk_bf16_f32 v149, 0, v149
    v_cvt_pk_bf16_f32 v150, 0, v150
    v_cvt_pk_bf16_f32 v151, 0, v151
    v_cvt_pk_bf16_f32 v152, 0, v152
    v_cvt_pk_bf16_f32 v153, 0, v153
    v_cvt_pk_bf16_f32 v154, 0, v154
    v_cvt_pk_bf16_f32 v155, 0, v155
    v_pk_mul_f32 v[148:149], v[148:149], v[132:133] op_sel:[0,1] op_sel_hi:[1,1]
    v_pk_mul_f32 v[150:151], v[150:151], v[132:133] op_sel:[0,1] op_sel_hi:[1,1]
    v_pk_mul_f32 v[152:153], v[152:153], v[132:133] op_sel:[0,1] op_sel_hi:[1,1]
    v_pk_mul_f32 v[154:155], v[154:155], v[132:133] op_sel:[0,1] op_sel_hi:[1,1]
    v_cvt_pk_bf16_f32 v40, v148, v149
    v_cvt_pk_bf16_f32 v41, v150, v151
    v_cvt_pk_bf16_f32 v42, v152, v153
    v_cvt_pk_bf16_f32 v43, v154, v155
    v_lshlrev_b32 v148, 16, v44
    v_and_b32 v149, 0xffff0000, v44
    v_lshlrev_b32 v150, 16, v45
    v_and_b32 v151, 0xffff0000, v45
    v_lshlrev_b32 v152, 16, v46
    v_and_b32 v153, 0xffff0000, v46
    v_lshlrev_b32 v154, 16, v47
    v_and_b32 v155, 0xffff0000, v47
    v_pk_add_f32 v[148:149], v[148:149], v[132:133] op_sel_hi:[1,0]
    v_pk_add_f32 v[150:151], v[150:151], v[132:133] op_sel_hi:[1,0]
    v_pk_add_f32 v[152:153], v[152:153], v[132:133] op_sel_hi:[1,0]
    v_pk_add_f32 v[154:155], v[154:155], v[132:133] op_sel_hi:[1,0]
    v_cvt_pk_bf16_f32 v148, 0, v148
    v_cvt_pk_bf16_f32 v149, 0, v149
    v_cvt_pk_bf16_f32 v150, 0, v150
    v_cvt_pk_bf16_f32 v151, 0, v151
    v_cvt_pk_bf16_f32 v152, 0, v152
    v_cvt_pk_bf16_f32 v153, 0, v153
    v_cvt_pk_bf16_f32 v154, 0, v154
    v_cvt_pk_bf16_f32 v155, 0, v155
    v_pk_mul_f32 v[148:149], v[148:149], v[132:133] op_sel:[0,1] op_sel_hi:[1,1]
    v_pk_mul_f32 v[150:151], v[150:151], v[132:133] op_sel:[0,1] op_sel_hi:[1,1]
    v_pk_mul_f32 v[152:153], v[152:153], v[132:133] op_sel:[0,1] op_sel_hi:[1,1]
    v_pk_mul_f32 v[154:155], v[154:155], v[132:133] op_sel:[0,1] op_sel_hi:[1,1]
    v_cvt_pk_bf16_f32 v44, v148, v149
    v_cvt_pk_bf16_f32 v45, v150, v151
    v_cvt_pk_bf16_f32 v46, v152, v153
    v_cvt_pk_bf16_f32 v47, v154, v155
    v_lshlrev_b32 v148, 16, v48
    v_and_b32 v149, 0xffff0000, v48
    v_lshlrev_b32 v150, 16, v49
    v_and_b32 v151, 0xffff0000, v49
    v_lshlrev_b32 v152, 16, v50
    v_and_b32 v153, 0xffff0000, v50
    v_lshlrev_b32 v154, 16, v51
    v_and_b32 v155, 0xffff0000, v51
    v_pk_add_f32 v[148:149], v[148:149], v[132:133] op_sel_hi:[1,0]
    v_pk_add_f32 v[150:151], v[150:151], v[132:133] op_sel_hi:[1,0]
    v_pk_add_f32 v[152:153], v[152:153], v[132:133] op_sel_hi:[1,0]
    v_pk_add_f32 v[154:155], v[154:155], v[132:133] op_sel_hi:[1,0]
    v_cvt_pk_bf16_f32 v148, 0, v148
    v_cvt_pk_bf16_f32 v149, 0, v149
    v_cvt_pk_bf16_f32 v150, 0, v150
    v_cvt_pk_bf16_f32 v151, 0, v151
    v_cvt_pk_bf16_f32 v152, 0, v152
    v_cvt_pk_bf16_f32 v153, 0, v153
    v_cvt_pk_bf16_f32 v154, 0, v154
    v_cvt_pk_bf16_f32 v155, 0, v155
    v_pk_mul_f32 v[148:149], v[148:149], v[132:133] op_sel:[0,1] op_sel_hi:[1,1]
    v_pk_mul_f32 v[150:151], v[150:151], v[132:133] op_sel:[0,1] op_sel_hi:[1,1]
    v_pk_mul_f32 v[152:153], v[152:153], v[132:133] op_sel:[0,1] op_sel_hi:[1,1]
    v_pk_mul_f32 v[154:155], v[154:155], v[132:133] op_sel:[0,1] op_sel_hi:[1,1]
    v_cvt_pk_bf16_f32 v48, v148, v149
    v_cvt_pk_bf16_f32 v49, v150, v151
    v_cvt_pk_bf16_f32 v50, v152, v153
    v_cvt_pk_bf16_f32 v51, v154, v155
    v_lshlrev_b32 v148, 16, v52
    v_and_b32 v149, 0xffff0000, v52
    v_lshlrev_b32 v150, 16, v53
    v_and_b32 v151, 0xffff0000, v53
    v_lshlrev_b32 v152, 16, v54
    v_and_b32 v153, 0xffff0000, v54
    v_lshlrev_b32 v154, 16, v55
    v_and_b32 v155, 0xffff0000, v55
    v_pk_add_f32 v[148:149], v[148:149], v[132:133] op_sel_hi:[1,0]
    v_pk_add_f32 v[150:151], v[150:151], v[132:133] op_sel_hi:[1,0]
    v_pk_add_f32 v[152:153], v[152:153], v[132:133] op_sel_hi:[1,0]
    v_pk_add_f32 v[154:155], v[154:155], v[132:133] op_sel_hi:[1,0]
    v_cvt_pk_bf16_f32 v148, 0, v148
    v_cvt_pk_bf16_f32 v149, 0, v149
    v_cvt_pk_bf16_f32 v150, 0, v150
    v_cvt_pk_bf16_f32 v151, 0, v151
    v_cvt_pk_bf16_f32 v152, 0, v152
    v_cvt_pk_bf16_f32 v153, 0, v153
    v_cvt_pk_bf16_f32 v154, 0, v154
    v_cvt_pk_bf16_f32 v155, 0, v155
    v_pk_mul_f32 v[148:149], v[148:149], v[132:133] op_sel:[0,1] op_sel_hi:[1,1]
    v_pk_mul_f32 v[150:151], v[150:151], v[132:133] op_sel:[0,1] op_sel_hi:[1,1]
    v_pk_mul_f32 v[152:153], v[152:153], v[132:133] op_sel:[0,1] op_sel_hi:[1,1]
    v_pk_mul_f32 v[154:155], v[154:155], v[132:133] op_sel:[0,1] op_sel_hi:[1,1]
    v_cvt_pk_bf16_f32 v52, v148, v149
    v_cvt_pk_bf16_f32 v53, v150, v151
    v_cvt_pk_bf16_f32 v54, v152, v153
    v_cvt_pk_bf16_f32 v55, v154, v155
    s_movk_i32 s27, 15360
    buffer_load_dwordx4 v[96:99], v204, s[12:15], s27 offen offset:0
    buffer_load_dwordx4 v[100:103], v204, s[12:15], s27 offen offset:256
    buffer_load_dwordx4 v[104:107], v204, s[12:15], s27 offen offset:512
    buffer_load_dwordx4 v[108:111], v204, s[12:15], s27 offen offset:768
    buffer_load_dwordx4 v[112:115], v204, s[12:15], s27 offen offset:1024
    s_waitcnt vmcnt(10)
    v_dot2_f32_bf16 v128, v56, v198, 0
    v_dot2_f32_bf16 v129, v56, v56, 0
    v_dot2_f32_bf16 v130, v57, v198, 0
    v_dot2_f32_bf16 v131, v57, v57, 0
    v_dot2_f32_bf16 v128, v58, v198, v128
    v_dot2_f32_bf16 v129, v58, v58, v129
    v_dot2_f32_bf16 v130, v59, v198, v130
    v_dot2_f32_bf16 v131, v59, v59, v131
    v_dot2_f32_bf16 v128, v60, v198, v128
    v_dot2_f32_bf16 v129, v60, v60, v129
    v_dot2_f32_bf16 v130, v61, v198, v130
    v_dot2_f32_bf16 v131, v61, v61, v131
    v_dot2_f32_bf16 v128, v62, v198, v128
    v_dot2_f32_bf16 v129, v62, v62, v129
    v_dot2_f32_bf16 v130, v63, v198, v130
    v_dot2_f32_bf16 v131, v63, v63, v131
    v_dot2_f32_bf16 v128, v64, v198, v128
    v_dot2_f32_bf16 v129, v64, v64, v129
    v_dot2_f32_bf16 v130, v65, v198, v130
    v_dot2_f32_bf16 v131, v65, v65, v131
    v_dot2_f32_bf16 v128, v66, v198, v128
    v_dot2_f32_bf16 v129, v66, v66, v129
    v_dot2_f32_bf16 v130, v67, v198, v130
    v_dot2_f32_bf16 v131, v67, v67, v131
    v_dot2_f32_bf16 v128, v68, v198, v128
    v_dot2_f32_bf16 v129, v68, v68, v129
    v_dot2_f32_bf16 v130, v69, v198, v130
    v_dot2_f32_bf16 v131, v69, v69, v131
    v_dot2_f32_bf16 v128, v70, v198, v128
    v_dot2_f32_bf16 v129, v70, v70, v129
    v_dot2_f32_bf16 v130, v71, v198, v130
    v_dot2_f32_bf16 v131, v71, v71, v131
    v_dot2_f32_bf16 v128, v72, v198, v128
    v_dot2_f32_bf16 v129, v72, v72, v129
    v_dot2_f32_bf16 v130, v73, v198, v130
    v_dot2_f32_bf16 v131, v73, v73, v131
    v_dot2_f32_bf16 v128, v74, v198, v128
    v_dot2_f32_bf16 v129, v74, v74, v129
    v_dot2_f32_bf16 v130, v75, v198, v130
    v_dot2_f32_bf16 v131, v75, v75, v131
    s_nop 3
    v_add_f32 v128, v128, v130
    v_add_f32 v129, v129, v131
    s_nop 1
    v_add_f32_dpp v128, v128, v128 row_ror:8 row_mask:0xf bank_mask:0xf
    v_add_f32_dpp v129, v129, v129 row_ror:8 row_mask:0xf bank_mask:0xf
    s_nop 1
    v_add_f32_dpp v128, v128, v128 row_ror:4 row_mask:0xf bank_mask:0xf
    v_add_f32_dpp v129, v129, v129 row_ror:4 row_mask:0xf bank_mask:0xf
    s_nop 1
    v_add_f32_dpp v128, v128, v128 row_ror:2 row_mask:0xf bank_mask:0xf
    v_add_f32_dpp v129, v129, v129 row_ror:2 row_mask:0xf bank_mask:0xf
    s_nop 1
    v_add_f32_dpp v128, v128, v128 row_ror:1 row_mask:0xf bank_mask:0xf
    v_add_f32_dpp v129, v129, v129 row_ror:1 row_mask:0xf bank_mask:0xf
    s_nop 1
    s_mov_b32 s26, 0x3acccccd
    s_mov_b32 s27, 0x3727c5ac
    v_mul_f32 v128, s26, v128
    v_mul_f32 v129, s26, v129
    v_fma_f32 v129, -v128, v128, v129
    v_max_f32 v129, 0, v129
    v_cvt_pk_bf16_f32 v128, 0, v128
    v_cvt_pk_bf16_f32 v129, 0, v129
    v_add_f32 v129, s27, v129
    v_cvt_pk_bf16_f32 v129, 0, v129
    v_sqrt_f32 v129, v129
    s_nop 0
    v_xor_b32 v128, 0x80000000, v128
    v_cvt_pk_bf16_f32 v129, 0, v129
    v_rcp_f32 v140, v129
    s_nop 0
    v_fma_f32 v129, -v129, v140, 2.0
    v_mul_f32 v129, v140, v129
    v_lshlrev_b32 v148, 16, v56
    v_and_b32 v149, 0xffff0000, v56
    v_lshlrev_b32 v150, 16, v57
    v_and_b32 v151, 0xffff0000, v57
    v_lshlrev_b32 v152, 16, v58
    v_and_b32 v153, 0xffff0000, v58
    v_lshlrev_b32 v154, 16, v59
    v_and_b32 v155, 0xffff0000, v59
    v_pk_add_f32 v[148:149], v[148:149], v[128:129] op_sel_hi:[1,0]
    v_pk_add_f32 v[150:151], v[150:151], v[128:129] op_sel_hi:[1,0]
    v_pk_add_f32 v[152:153], v[152:153], v[128:129] op_sel_hi:[1,0]
    v_pk_add_f32 v[154:155], v[154:155], v[128:129] op_sel_hi:[1,0]
    v_cvt_pk_bf16_f32 v148, 0, v148
    v_cvt_pk_bf16_f32 v149, 0, v149
    v_cvt_pk_bf16_f32 v150, 0, v150
    v_cvt_pk_bf16_f32 v151, 0, v151
    v_cvt_pk_bf16_f32 v152, 0, v152
    v_cvt_pk_bf16_f32 v153, 0, v153
    v_cvt_pk_bf16_f32 v154, 0, v154
    v_cvt_pk_bf16_f32 v155, 0, v155
    v_pk_mul_f32 v[148:149], v[148:149], v[128:129] op_sel:[0,1] op_sel_hi:[1,1]
    v_pk_mul_f32 v[150:151], v[150:151], v[128:129] op_sel:[0,1] op_sel_hi:[1,1]
    v_pk_mul_f32 v[152:153], v[152:153], v[128:129] op_sel:[0,1] op_sel_hi:[1,1]
    v_pk_mul_f32 v[154:155], v[154:155], v[128:129] op_sel:[0,1] op_sel_hi:[1,1]
    v_cvt_pk_bf16_f32 v56, v148, v149
    v_cvt_pk_bf16_f32 v57, v150, v151
    v_cvt_pk_bf16_f32 v58, v152, v153
    v_cvt_pk_bf16_f32 v59, v154, v155
    v_lshlrev_b32 v148, 16, v60
    v_and_b32 v149, 0xffff0000, v60
    v_lshlrev_b32 v150, 16, v61
    v_and_b32 v151, 0xffff0000, v61
    v_lshlrev_b32 v152, 16, v62
    v_and_b32 v153, 0xffff0000, v62
    v_lshlrev_b32 v154, 16, v63
    v_and_b32 v155, 0xffff0000, v63
    v_pk_add_f32 v[148:149], v[148:149], v[128:129] op_sel_hi:[1,0]
    v_pk_add_f32 v[150:151], v[150:151], v[128:129] op_sel_hi:[1,0]
    v_pk_add_f32 v[152:153], v[152:153], v[128:129] op_sel_hi:[1,0]
    v_pk_add_f32 v[154:155], v[154:155], v[128:129] op_sel_hi:[1,0]
    v_cvt_pk_bf16_f32 v148, 0, v148
    v_cvt_pk_bf16_f32 v149, 0, v149
    v_cvt_pk_bf16_f32 v150, 0, v150
    v_cvt_pk_bf16_f32 v151, 0, v151
    v_cvt_pk_bf16_f32 v152, 0, v152
    v_cvt_pk_bf16_f32 v153, 0, v153
    v_cvt_pk_bf16_f32 v154, 0, v154
    v_cvt_pk_bf16_f32 v155, 0, v155
    v_pk_mul_f32 v[148:149], v[148:149], v[128:129] op_sel:[0,1] op_sel_hi:[1,1]
    v_pk_mul_f32 v[150:151], v[150:151], v[128:129] op_sel:[0,1] op_sel_hi:[1,1]
    v_pk_mul_f32 v[152:153], v[152:153], v[128:129] op_sel:[0,1] op_sel_hi:[1,1]
    v_pk_mul_f32 v[154:155], v[154:155], v[128:129] op_sel:[0,1] op_sel_hi:[1,1]
    v_cvt_pk_bf16_f32 v60, v148, v149
    v_cvt_pk_bf16_f32 v61, v150, v151
    v_cvt_pk_bf16_f32 v62, v152, v153
    v_cvt_pk_bf16_f32 v63, v154, v155
    v_lshlrev_b32 v148, 16, v64
    v_and_b32 v149, 0xffff0000, v64
    v_lshlrev_b32 v150, 16, v65
    v_and_b32 v151, 0xffff0000, v65
    v_lshlrev_b32 v152, 16, v66
    v_and_b32 v153, 0xffff0000, v66
    v_lshlrev_b32 v154, 16, v67
    v_and_b32 v155, 0xffff0000, v67
    v_pk_add_f32 v[148:149], v[148:149], v[128:129] op_sel_hi:[1,0]
    v_pk_add_f32 v[150:151], v[150:151], v[128:129] op_sel_hi:[1,0]
    v_pk_add_f32 v[152:153], v[152:153], v[128:129] op_sel_hi:[1,0]
    v_pk_add_f32 v[154:155], v[154:155], v[128:129] op_sel_hi:[1,0]
    v_cvt_pk_bf16_f32 v148, 0, v148
    v_cvt_pk_bf16_f32 v149, 0, v149
    v_cvt_pk_bf16_f32 v150, 0, v150
    v_cvt_pk_bf16_f32 v151, 0, v151
    v_cvt_pk_bf16_f32 v152, 0, v152
    v_cvt_pk_bf16_f32 v153, 0, v153
    v_cvt_pk_bf16_f32 v154, 0, v154
    v_cvt_pk_bf16_f32 v155, 0, v155
    v_pk_mul_f32 v[148:149], v[148:149], v[128:129] op_sel:[0,1] op_sel_hi:[1,1]
    v_pk_mul_f32 v[150:151], v[150:151], v[128:129] op_sel:[0,1] op_sel_hi:[1,1]
    v_pk_mul_f32 v[152:153], v[152:153], v[128:129] op_sel:[0,1] op_sel_hi:[1,1]
    v_pk_mul_f32 v[154:155], v[154:155], v[128:129] op_sel:[0,1] op_sel_hi:[1,1]
    v_cvt_pk_bf16_f32 v64, v148, v149
    v_cvt_pk_bf16_f32 v65, v150, v151
    v_cvt_pk_bf16_f32 v66, v152, v153
    v_cvt_pk_bf16_f32 v67, v154, v155
    v_lshlrev_b32 v148, 16, v68
    v_and_b32 v149, 0xffff0000, v68
    v_lshlrev_b32 v150, 16, v69
    v_and_b32 v151, 0xffff0000, v69
    v_lshlrev_b32 v152, 16, v70
    v_and_b32 v153, 0xffff0000, v70
    v_lshlrev_b32 v154, 16, v71
    v_and_b32 v155, 0xffff0000, v71
    v_pk_add_f32 v[148:149], v[148:149], v[128:129] op_sel_hi:[1,0]
    v_pk_add_f32 v[150:151], v[150:151], v[128:129] op_sel_hi:[1,0]
    v_pk_add_f32 v[152:153], v[152:153], v[128:129] op_sel_hi:[1,0]
    v_pk_add_f32 v[154:155], v[154:155], v[128:129] op_sel_hi:[1,0]
    v_cvt_pk_bf16_f32 v148, 0, v148
    v_cvt_pk_bf16_f32 v149, 0, v149
    v_cvt_pk_bf16_f32 v150, 0, v150
    v_cvt_pk_bf16_f32 v151, 0, v151
    v_cvt_pk_bf16_f32 v152, 0, v152
    v_cvt_pk_bf16_f32 v153, 0, v153
    v_cvt_pk_bf16_f32 v154, 0, v154
    v_cvt_pk_bf16_f32 v155, 0, v155
    v_pk_mul_f32 v[148:149], v[148:149], v[128:129] op_sel:[0,1] op_sel_hi:[1,1]
    v_pk_mul_f32 v[150:151], v[150:151], v[128:129] op_sel:[0,1] op_sel_hi:[1,1]
    v_pk_mul_f32 v[152:153], v[152:153], v[128:129] op_sel:[0,1] op_sel_hi:[1,1]
    v_pk_mul_f32 v[154:155], v[154:155], v[128:129] op_sel:[0,1] op_sel_hi:[1,1]
    v_cvt_pk_bf16_f32 v68, v148, v149
    v_cvt_pk_bf16_f32 v69, v150, v151
    v_cvt_pk_bf16_f32 v70, v152, v153
    v_cvt_pk_bf16_f32 v71, v154, v155
    v_lshlrev_b32 v148, 16, v72
    v_and_b32 v149, 0xffff0000, v72
    v_lshlrev_b32 v150, 16, v73
    v_and_b32 v151, 0xffff0000, v73
    v_lshlrev_b32 v152, 16, v74
    v_and_b32 v153, 0xffff0000, v74
    v_lshlrev_b32 v154, 16, v75
    v_and_b32 v155, 0xffff0000, v75
    v_pk_add_f32 v[148:149], v[148:149], v[128:129] op_sel_hi:[1,0]
    v_pk_add_f32 v[150:151], v[150:151], v[128:129] op_sel_hi:[1,0]
    v_pk_add_f32 v[152:153], v[152:153], v[128:129] op_sel_hi:[1,0]
    v_pk_add_f32 v[154:155], v[154:155], v[128:129] op_sel_hi:[1,0]
    v_cvt_pk_bf16_f32 v148, 0, v148
    v_cvt_pk_bf16_f32 v149, 0, v149
    v_cvt_pk_bf16_f32 v150, 0, v150
    v_cvt_pk_bf16_f32 v151, 0, v151
    v_cvt_pk_bf16_f32 v152, 0, v152
    v_cvt_pk_bf16_f32 v153, 0, v153
    v_cvt_pk_bf16_f32 v154, 0, v154
    v_cvt_pk_bf16_f32 v155, 0, v155
    v_pk_mul_f32 v[148:149], v[148:149], v[128:129] op_sel:[0,1] op_sel_hi:[1,1]
    v_pk_mul_f32 v[150:151], v[150:151], v[128:129] op_sel:[0,1] op_sel_hi:[1,1]
    v_pk_mul_f32 v[152:153], v[152:153], v[128:129] op_sel:[0,1] op_sel_hi:[1,1]
    v_pk_mul_f32 v[154:155], v[154:155], v[128:129] op_sel:[0,1] op_sel_hi:[1,1]
    v_cvt_pk_bf16_f32 v72, v148, v149
    v_cvt_pk_bf16_f32 v73, v150, v151
    v_cvt_pk_bf16_f32 v74, v152, v153
    v_cvt_pk_bf16_f32 v75, v154, v155
    s_add_u32 m0, s28, 0x0
    s_nop 0
    buffer_load_dwordx4 v8, s[8:11], s23 offen lds
    s_add_u32 m0, s28, 0x400
    s_nop 0
    buffer_load_dwordx4 v9, s[8:11], s23 offen lds
    s_add_u32 s23, s23, 122880
    s_add_u32 m0, s28, 0x4000
    s_nop 0
    buffer_load_dwordx4 v8, s[8:11], s23 offen lds
    s_add_u32 m0, s28, 0x4400
    s_nop 0
    buffer_load_dwordx4 v9, s[8:11], s23 offen lds
    s_add_u32 s23, s23, 122880
    s_add_u32 m0, s28, 0x8000
    s_nop 0
    buffer_load_dwordx4 v8, s[8:11], s23 offen lds
    s_add_u32 m0, s28, 0x8400
    s_nop 0
    buffer_load_dwordx4 v9, s[8:11], s23 offen lds
    s_add_u32 s23, s23, 122880
    s_add_u32 m0, s28, 0xc000
    s_nop 0
    buffer_load_dwordx4 v8, s[8:11], s23 offen lds
    s_add_u32 m0, s28, 0xc400
    s_nop 0
    buffer_load_dwordx4 v9, s[8:11], s23 offen lds
    s_add_u32 s23, s23, 122880
    s_waitcnt vmcnt(13)
    v_dot2_f32_bf16 v128, v76, v198, 0
    v_dot2_f32_bf16 v129, v76, v76, 0
    v_dot2_f32_bf16 v130, v77, v198, 0
    v_dot2_f32_bf16 v131, v77, v77, 0
    v_dot2_f32_bf16 v128, v78, v198, v128
    v_dot2_f32_bf16 v129, v78, v78, v129
    v_dot2_f32_bf16 v130, v79, v198, v130
    v_dot2_f32_bf16 v131, v79, v79, v131
    v_dot2_f32_bf16 v128, v80, v198, v128
    v_dot2_f32_bf16 v129, v80, v80, v129
    v_dot2_f32_bf16 v130, v81, v198, v130
    v_dot2_f32_bf16 v131, v81, v81, v131
    v_dot2_f32_bf16 v128, v82, v198, v128
    v_dot2_f32_bf16 v129, v82, v82, v129
    v_dot2_f32_bf16 v130, v83, v198, v130
    v_dot2_f32_bf16 v131, v83, v83, v131
    v_dot2_f32_bf16 v128, v84, v198, v128
    v_dot2_f32_bf16 v129, v84, v84, v129
    v_dot2_f32_bf16 v130, v85, v198, v130
    v_dot2_f32_bf16 v131, v85, v85, v131
    v_dot2_f32_bf16 v128, v86, v198, v128
    v_dot2_f32_bf16 v129, v86, v86, v129
    v_dot2_f32_bf16 v130, v87, v198, v130
    v_dot2_f32_bf16 v131, v87, v87, v131
    v_dot2_f32_bf16 v128, v88, v198, v128
    v_dot2_f32_bf16 v129, v88, v88, v129
    v_dot2_f32_bf16 v130, v89, v198, v130
    v_dot2_f32_bf16 v131, v89, v89, v131
    v_dot2_f32_bf16 v128, v90, v198, v128
    v_dot2_f32_bf16 v129, v90, v90, v129
    v_dot2_f32_bf16 v130, v91, v198, v130
    v_dot2_f32_bf16 v131, v91, v91, v131
    v_dot2_f32_bf16 v128, v92, v198, v128
    v_dot2_f32_bf16 v129, v92, v92, v129
    v_dot2_f32_bf16 v130, v93, v198, v130
    v_dot2_f32_bf16 v131, v93, v93, v131
    v_dot2_f32_bf16 v128, v94, v198, v128
    v_dot2_f32_bf16 v129, v94, v94, v129
    v_dot2_f32_bf16 v130, v95, v198, v130
    v_dot2_f32_bf16 v131, v95, v95, v131
    s_nop 3
    v_add_f32 v128, v128, v130
    v_add_f32 v129, v129, v131
    s_nop 1
    v_add_f32_dpp v128, v128, v128 row_ror:8 row_mask:0xf bank_mask:0xf
    v_add_f32_dpp v129, v129, v129 row_ror:8 row_mask:0xf bank_mask:0xf
    s_nop 1
    v_add_f32_dpp v128, v128, v128 row_ror:4 row_mask:0xf bank_mask:0xf
    v_add_f32_dpp v129, v129, v129 row_ror:4 row_mask:0xf bank_mask:0xf
    s_nop 1
    v_add_f32_dpp v128, v128, v128 row_ror:2 row_mask:0xf bank_mask:0xf
    v_add_f32_dpp v129, v129, v129 row_ror:2 row_mask:0xf bank_mask:0xf
    s_nop 1
    v_add_f32_dpp v128, v128, v128 row_ror:1 row_mask:0xf bank_mask:0xf
    v_add_f32_dpp v129, v129, v129 row_ror:1 row_mask:0xf bank_mask:0xf
    s_nop 1
    s_mov_b32 s26, 0x3acccccd
    s_mov_b32 s27, 0x3727c5ac
    v_mul_f32 v128, s26, v128
    v_mul_f32 v129, s26, v129
    v_fma_f32 v129, -v128, v128, v129
    v_max_f32 v129, 0, v129
    v_cvt_pk_bf16_f32 v128, 0, v128
    v_cvt_pk_bf16_f32 v129, 0, v129
    v_add_f32 v129, s27, v129
    v_cvt_pk_bf16_f32 v129, 0, v129
    v_sqrt_f32 v129, v129
    s_nop 0
    v_xor_b32 v128, 0x80000000, v128
    v_cvt_pk_bf16_f32 v129, 0, v129
    v_rcp_f32 v140, v129
    s_nop 0
    v_fma_f32 v129, -v129, v140, 2.0
    v_mul_f32 v129, v140, v129
    v_lshlrev_b32 v148, 16, v76
    v_and_b32 v149, 0xffff0000, v76
    v_lshlrev_b32 v150, 16, v77
    v_and_b32 v151, 0xffff0000, v77
    v_lshlrev_b32 v152, 16, v78
    v_and_b32 v153, 0xffff0000, v78
    v_lshlrev_b32 v154, 16, v79
    v_and_b32 v155, 0xffff0000, v79
    v_pk_add_f32 v[148:149], v[148:149], v[128:129] op_sel_hi:[1,0]
    v_pk_add_f32 v[150:151], v[150:151], v[128:129] op_sel_hi:[1,0]
    v_pk_add_f32 v[152:153], v[152:153], v[128:129] op_sel_hi:[1,0]
    v_pk_add_f32 v[154:155], v[154:155], v[128:129] op_sel_hi:[1,0]
    v_cvt_pk_bf16_f32 v148, 0, v148
    v_cvt_pk_bf16_f32 v149, 0, v149
    v_cvt_pk_bf16_f32 v150, 0, v150
    v_cvt_pk_bf16_f32 v151, 0, v151
    v_cvt_pk_bf16_f32 v152, 0, v152
    v_cvt_pk_bf16_f32 v153, 0, v153
    v_cvt_pk_bf16_f32 v154, 0, v154
    v_cvt_pk_bf16_f32 v155, 0, v155
    v_pk_mul_f32 v[148:149], v[148:149], v[128:129] op_sel:[0,1] op_sel_hi:[1,1]
    v_pk_mul_f32 v[150:151], v[150:151], v[128:129] op_sel:[0,1] op_sel_hi:[1,1]
    v_pk_mul_f32 v[152:153], v[152:153], v[128:129] op_sel:[0,1] op_sel_hi:[1,1]
    v_pk_mul_f32 v[154:155], v[154:155], v[128:129] op_sel:[0,1] op_sel_hi:[1,1]
    v_cvt_pk_bf16_f32 v76, v148, v149
    v_cvt_pk_bf16_f32 v77, v150, v151
    v_cvt_pk_bf16_f32 v78, v152, v153
    v_cvt_pk_bf16_f32 v79, v154, v155
    v_lshlrev_b32 v148, 16, v80
    v_and_b32 v149, 0xffff0000, v80
    v_lshlrev_b32 v150, 16, v81
    v_and_b32 v151, 0xffff0000, v81
    v_lshlrev_b32 v152, 16, v82
    v_and_b32 v153, 0xffff0000, v82
    v_lshlrev_b32 v154, 16, v83
    v_and_b32 v155, 0xffff0000, v83
    v_pk_add_f32 v[148:149], v[148:149], v[128:129] op_sel_hi:[1,0]
    v_pk_add_f32 v[150:151], v[150:151], v[128:129] op_sel_hi:[1,0]
    v_pk_add_f32 v[152:153], v[152:153], v[128:129] op_sel_hi:[1,0]
    v_pk_add_f32 v[154:155], v[154:155], v[128:129] op_sel_hi:[1,0]
    v_cvt_pk_bf16_f32 v148, 0, v148
    v_cvt_pk_bf16_f32 v149, 0, v149
    v_cvt_pk_bf16_f32 v150, 0, v150
    v_cvt_pk_bf16_f32 v151, 0, v151
    v_cvt_pk_bf16_f32 v152, 0, v152
    v_cvt_pk_bf16_f32 v153, 0, v153
    v_cvt_pk_bf16_f32 v154, 0, v154
    v_cvt_pk_bf16_f32 v155, 0, v155
    v_pk_mul_f32 v[148:149], v[148:149], v[128:129] op_sel:[0,1] op_sel_hi:[1,1]
    v_pk_mul_f32 v[150:151], v[150:151], v[128:129] op_sel:[0,1] op_sel_hi:[1,1]
    v_pk_mul_f32 v[152:153], v[152:153], v[128:129] op_sel:[0,1] op_sel_hi:[1,1]
    v_pk_mul_f32 v[154:155], v[154:155], v[128:129] op_sel:[0,1] op_sel_hi:[1,1]
    v_cvt_pk_bf16_f32 v80, v148, v149
    v_cvt_pk_bf16_f32 v81, v150, v151
    v_cvt_pk_bf16_f32 v82, v152, v153
    v_cvt_pk_bf16_f32 v83, v154, v155
    v_lshlrev_b32 v148, 16, v84
    v_and_b32 v149, 0xffff0000, v84
    v_lshlrev_b32 v150, 16, v85
    v_and_b32 v151, 0xffff0000, v85
    v_lshlrev_b32 v152, 16, v86
    v_and_b32 v153, 0xffff0000, v86
    v_lshlrev_b32 v154, 16, v87
    v_and_b32 v155, 0xffff0000, v87
    v_pk_add_f32 v[148:149], v[148:149], v[128:129] op_sel_hi:[1,0]
    v_pk_add_f32 v[150:151], v[150:151], v[128:129] op_sel_hi:[1,0]
    v_pk_add_f32 v[152:153], v[152:153], v[128:129] op_sel_hi:[1,0]
    v_pk_add_f32 v[154:155], v[154:155], v[128:129] op_sel_hi:[1,0]
    v_cvt_pk_bf16_f32 v148, 0, v148
    v_cvt_pk_bf16_f32 v149, 0, v149
    v_cvt_pk_bf16_f32 v150, 0, v150
    v_cvt_pk_bf16_f32 v151, 0, v151
    v_cvt_pk_bf16_f32 v152, 0, v152
    v_cvt_pk_bf16_f32 v153, 0, v153
    v_cvt_pk_bf16_f32 v154, 0, v154
    v_cvt_pk_bf16_f32 v155, 0, v155
    v_pk_mul_f32 v[148:149], v[148:149], v[128:129] op_sel:[0,1] op_sel_hi:[1,1]
    v_pk_mul_f32 v[150:151], v[150:151], v[128:129] op_sel:[0,1] op_sel_hi:[1,1]
    v_pk_mul_f32 v[152:153], v[152:153], v[128:129] op_sel:[0,1] op_sel_hi:[1,1]
    v_pk_mul_f32 v[154:155], v[154:155], v[128:129] op_sel:[0,1] op_sel_hi:[1,1]
    v_cvt_pk_bf16_f32 v84, v148, v149
    v_cvt_pk_bf16_f32 v85, v150, v151
    v_cvt_pk_bf16_f32 v86, v152, v153
    v_cvt_pk_bf16_f32 v87, v154, v155
    v_lshlrev_b32 v148, 16, v88
    v_and_b32 v149, 0xffff0000, v88
    v_lshlrev_b32 v150, 16, v89
    v_and_b32 v151, 0xffff0000, v89
    v_lshlrev_b32 v152, 16, v90
    v_and_b32 v153, 0xffff0000, v90
    v_lshlrev_b32 v154, 16, v91
    v_and_b32 v155, 0xffff0000, v91
    v_pk_add_f32 v[148:149], v[148:149], v[128:129] op_sel_hi:[1,0]
    v_pk_add_f32 v[150:151], v[150:151], v[128:129] op_sel_hi:[1,0]
    v_pk_add_f32 v[152:153], v[152:153], v[128:129] op_sel_hi:[1,0]
    v_pk_add_f32 v[154:155], v[154:155], v[128:129] op_sel_hi:[1,0]
    v_cvt_pk_bf16_f32 v148, 0, v148
    v_cvt_pk_bf16_f32 v149, 0, v149
    v_cvt_pk_bf16_f32 v150, 0, v150
    v_cvt_pk_bf16_f32 v151, 0, v151
    v_cvt_pk_bf16_f32 v152, 0, v152
    v_cvt_pk_bf16_f32 v153, 0, v153
    v_cvt_pk_bf16_f32 v154, 0, v154
    v_cvt_pk_bf16_f32 v155, 0, v155
    v_pk_mul_f32 v[148:149], v[148:149], v[128:129] op_sel:[0,1] op_sel_hi:[1,1]
    v_pk_mul_f32 v[150:151], v[150:151], v[128:129] op_sel:[0,1] op_sel_hi:[1,1]
    v_pk_mul_f32 v[152:153], v[152:153], v[128:129] op_sel:[0,1] op_sel_hi:[1,1]
    v_pk_mul_f32 v[154:155], v[154:155], v[128:129] op_sel:[0,1] op_sel_hi:[1,1]
    v_cvt_pk_bf16_f32 v88, v148, v149
    v_cvt_pk_bf16_f32 v89, v150, v151
    v_cvt_pk_bf16_f32 v90, v152, v153
    v_cvt_pk_bf16_f32 v91, v154, v155
    v_lshlrev_b32 v148, 16, v92
    v_and_b32 v149, 0xffff0000, v92
    v_lshlrev_b32 v150, 16, v93
    v_and_b32 v151, 0xffff0000, v93
    v_lshlrev_b32 v152, 16, v94
    v_and_b32 v153, 0xffff0000, v94
    v_lshlrev_b32 v154, 16, v95
    v_and_b32 v155, 0xffff0000, v95
    v_pk_add_f32 v[148:149], v[148:149], v[128:129] op_sel_hi:[1,0]
    v_pk_add_f32 v[150:151], v[150:151], v[128:129] op_sel_hi:[1,0]
    v_pk_add_f32 v[152:153], v[152:153], v[128:129] op_sel_hi:[1,0]
    v_pk_add_f32 v[154:155], v[154:155], v[128:129] op_sel_hi:[1,0]
    v_cvt_pk_bf16_f32 v148, 0, v148
    v_cvt_pk_bf16_f32 v149, 0, v149
    v_cvt_pk_bf16_f32 v150, 0, v150
    v_cvt_pk_bf16_f32 v151, 0, v151
    v_cvt_pk_bf16_f32 v152, 0, v152
    v_cvt_pk_bf16_f32 v153, 0, v153
    v_cvt_pk_bf16_f32 v154, 0, v154
    v_cvt_pk_bf16_f32 v155, 0, v155
    v_pk_mul_f32 v[148:149], v[148:149], v[128:129] op_sel:[0,1] op_sel_hi:[1,1]
    v_pk_mul_f32 v[150:151], v[150:151], v[128:129] op_sel:[0,1] op_sel_hi:[1,1]
    v_pk_mul_f32 v[152:153], v[152:153], v[128:129] op_sel:[0,1] op_sel_hi:[1,1]
    v_pk_mul_f32 v[154:155], v[154:155], v[128:129] op_sel:[0,1] op_sel_hi:[1,1]
    v_cvt_pk_bf16_f32 v92, v148, v149
    v_cvt_pk_bf16_f32 v93, v150, v151
    v_cvt_pk_bf16_f32 v94, v152, v153
    v_cvt_pk_bf16_f32 v95, v154, v155
    s_waitcnt vmcnt(8)
    v_dot2_f32_bf16 v128, v96, v198, 0
    v_dot2_f32_bf16 v129, v96, v96, 0
    v_dot2_f32_bf16 v130, v97, v198, 0
    v_dot2_f32_bf16 v131, v97, v97, 0
    v_dot2_f32_bf16 v128, v98, v198, v128
    v_dot2_f32_bf16 v129, v98, v98, v129
    v_dot2_f32_bf16 v130, v99, v198, v130
    v_dot2_f32_bf16 v131, v99, v99, v131
    v_dot2_f32_bf16 v128, v100, v198, v128
    v_dot2_f32_bf16 v129, v100, v100, v129
    v_dot2_f32_bf16 v130, v101, v198, v130
    v_dot2_f32_bf16 v131, v101, v101, v131
    v_dot2_f32_bf16 v128, v102, v198, v128
    v_dot2_f32_bf16 v129, v102, v102, v129
    v_dot2_f32_bf16 v130, v103, v198, v130
    v_dot2_f32_bf16 v131, v103, v103, v131
    v_dot2_f32_bf16 v128, v104, v198, v128
    v_dot2_f32_bf16 v129, v104, v104, v129
    v_dot2_f32_bf16 v130, v105, v198, v130
    v_dot2_f32_bf16 v131, v105, v105, v131
    v_dot2_f32_bf16 v128, v106, v198, v128
    v_dot2_f32_bf16 v129, v106, v106, v129
    v_dot2_f32_bf16 v130, v107, v198, v130
    v_dot2_f32_bf16 v131, v107, v107, v131
    v_dot2_f32_bf16 v128, v108, v198, v128
    v_dot2_f32_bf16 v129, v108, v108, v129
    v_dot2_f32_bf16 v130, v109, v198, v130
    v_dot2_f32_bf16 v131, v109, v109, v131
    v_dot2_f32_bf16 v128, v110, v198, v128
    v_dot2_f32_bf16 v129, v110, v110, v129
    v_dot2_f32_bf16 v130, v111, v198, v130
    v_dot2_f32_bf16 v131, v111, v111, v131
    v_dot2_f32_bf16 v128, v112, v198, v128
    v_dot2_f32_bf16 v129, v112, v112, v129
    v_dot2_f32_bf16 v130, v113, v198, v130
    v_dot2_f32_bf16 v131, v113, v113, v131
    v_dot2_f32_bf16 v128, v114, v198, v128
    v_dot2_f32_bf16 v129, v114, v114, v129
    v_dot2_f32_bf16 v130, v115, v198, v130
    v_dot2_f32_bf16 v131, v115, v115, v131
    s_nop 3
    v_add_f32 v128, v128, v130
    v_add_f32 v129, v129, v131
    s_nop 1
    v_add_f32_dpp v128, v128, v128 row_ror:8 row_mask:0xf bank_mask:0xf
    v_add_f32_dpp v129, v129, v129 row_ror:8 row_mask:0xf bank_mask:0xf
    s_nop 1
    v_add_f32_dpp v128, v128, v128 row_ror:4 row_mask:0xf bank_mask:0xf
    v_add_f32_dpp v129, v129, v129 row_ror:4 row_mask:0xf bank_mask:0xf
    s_nop 1
    v_add_f32_dpp v128, v128, v128 row_ror:2 row_mask:0xf bank_mask:0xf
    v_add_f32_dpp v129, v129, v129 row_ror:2 row_mask:0xf bank_mask:0xf
    s_nop 1
    v_add_f32_dpp v128, v128, v128 row_ror:1 row_mask:0xf bank_mask:0xf
    v_add_f32_dpp v129, v129, v129 row_ror:1 row_mask:0xf bank_mask:0xf
    s_nop 1
    s_mov_b32 s26, 0x3acccccd
    s_mov_b32 s27, 0x3727c5ac
    v_mul_f32 v128, s26, v128
    v_mul_f32 v129, s26, v129
    v_fma_f32 v129, -v128, v128, v129
    v_max_f32 v129, 0, v129
    v_cvt_pk_bf16_f32 v128, 0, v128
    v_cvt_pk_bf16_f32 v129, 0, v129
    v_add_f32 v129, s27, v129
    v_cvt_pk_bf16_f32 v129, 0, v129
    v_sqrt_f32 v129, v129
    s_nop 0
    v_xor_b32 v128, 0x80000000, v128
    v_cvt_pk_bf16_f32 v129, 0, v129
    v_rcp_f32 v140, v129
    s_nop 0
    v_fma_f32 v129, -v129, v140, 2.0
    v_mul_f32 v129, v140, v129
    v_lshlrev_b32 v148, 16, v96
    v_and_b32 v149, 0xffff0000, v96
    v_lshlrev_b32 v150, 16, v97
    v_and_b32 v151, 0xffff0000, v97
    v_lshlrev_b32 v152, 16, v98
    v_and_b32 v153, 0xffff0000, v98
    v_lshlrev_b32 v154, 16, v99
    v_and_b32 v155, 0xffff0000, v99
    v_pk_add_f32 v[148:149], v[148:149], v[128:129] op_sel_hi:[1,0]
    v_pk_add_f32 v[150:151], v[150:151], v[128:129] op_sel_hi:[1,0]
    v_pk_add_f32 v[152:153], v[152:153], v[128:129] op_sel_hi:[1,0]
    v_pk_add_f32 v[154:155], v[154:155], v[128:129] op_sel_hi:[1,0]
    v_cvt_pk_bf16_f32 v148, 0, v148
    v_cvt_pk_bf16_f32 v149, 0, v149
    v_cvt_pk_bf16_f32 v150, 0, v150
    v_cvt_pk_bf16_f32 v151, 0, v151
    v_cvt_pk_bf16_f32 v152, 0, v152
    v_cvt_pk_bf16_f32 v153, 0, v153
    v_cvt_pk_bf16_f32 v154, 0, v154
    v_cvt_pk_bf16_f32 v155, 0, v155
    v_pk_mul_f32 v[148:149], v[148:149], v[128:129] op_sel:[0,1] op_sel_hi:[1,1]
    v_pk_mul_f32 v[150:151], v[150:151], v[128:129] op_sel:[0,1] op_sel_hi:[1,1]
    v_pk_mul_f32 v[152:153], v[152:153], v[128:129] op_sel:[0,1] op_sel_hi:[1,1]
    v_pk_mul_f32 v[154:155], v[154:155], v[128:129] op_sel:[0,1] op_sel_hi:[1,1]
    v_cvt_pk_bf16_f32 v96, v148, v149
    v_cvt_pk_bf16_f32 v97, v150, v151
    v_cvt_pk_bf16_f32 v98, v152, v153
    v_cvt_pk_bf16_f32 v99, v154, v155
    v_lshlrev_b32 v148, 16, v100
    v_and_b32 v149, 0xffff0000, v100
    v_lshlrev_b32 v150, 16, v101
    v_and_b32 v151, 0xffff0000, v101
    v_lshlrev_b32 v152, 16, v102
    v_and_b32 v153, 0xffff0000, v102
    v_lshlrev_b32 v154, 16, v103
    v_and_b32 v155, 0xffff0000, v103
    v_pk_add_f32 v[148:149], v[148:149], v[128:129] op_sel_hi:[1,0]
    v_pk_add_f32 v[150:151], v[150:151], v[128:129] op_sel_hi:[1,0]
    v_pk_add_f32 v[152:153], v[152:153], v[128:129] op_sel_hi:[1,0]
    v_pk_add_f32 v[154:155], v[154:155], v[128:129] op_sel_hi:[1,0]
    v_cvt_pk_bf16_f32 v148, 0, v148
    v_cvt_pk_bf16_f32 v149, 0, v149
    v_cvt_pk_bf16_f32 v150, 0, v150
    v_cvt_pk_bf16_f32 v151, 0, v151
    v_cvt_pk_bf16_f32 v152, 0, v152
    v_cvt_pk_bf16_f32 v153, 0, v153
    v_cvt_pk_bf16_f32 v154, 0, v154
    v_cvt_pk_bf16_f32 v155, 0, v155
    v_pk_mul_f32 v[148:149], v[148:149], v[128:129] op_sel:[0,1] op_sel_hi:[1,1]
    v_pk_mul_f32 v[150:151], v[150:151], v[128:129] op_sel:[0,1] op_sel_hi:[1,1]
    v_pk_mul_f32 v[152:153], v[152:153], v[128:129] op_sel:[0,1] op_sel_hi:[1,1]
    v_pk_mul_f32 v[154:155], v[154:155], v[128:129] op_sel:[0,1] op_sel_hi:[1,1]
    v_cvt_pk_bf16_f32 v100, v148, v149
    v_cvt_pk_bf16_f32 v101, v150, v151
    v_cvt_pk_bf16_f32 v102, v152, v153
    v_cvt_pk_bf16_f32 v103, v154, v155
    v_lshlrev_b32 v148, 16, v104
    v_and_b32 v149, 0xffff0000, v104
    v_lshlrev_b32 v150, 16, v105
    v_and_b32 v151, 0xffff0000, v105
    v_lshlrev_b32 v152, 16, v106
    v_and_b32 v153, 0xffff0000, v106
    v_lshlrev_b32 v154, 16, v107
    v_and_b32 v155, 0xffff0000, v107
    v_pk_add_f32 v[148:149], v[148:149], v[128:129] op_sel_hi:[1,0]
    v_pk_add_f32 v[150:151], v[150:151], v[128:129] op_sel_hi:[1,0]
    v_pk_add_f32 v[152:153], v[152:153], v[128:129] op_sel_hi:[1,0]
    v_pk_add_f32 v[154:155], v[154:155], v[128:129] op_sel_hi:[1,0]
    v_cvt_pk_bf16_f32 v148, 0, v148
    v_cvt_pk_bf16_f32 v149, 0, v149
    v_cvt_pk_bf16_f32 v150, 0, v150
    v_cvt_pk_bf16_f32 v151, 0, v151
    v_cvt_pk_bf16_f32 v152, 0, v152
    v_cvt_pk_bf16_f32 v153, 0, v153
    v_cvt_pk_bf16_f32 v154, 0, v154
    v_cvt_pk_bf16_f32 v155, 0, v155
    v_pk_mul_f32 v[148:149], v[148:149], v[128:129] op_sel:[0,1] op_sel_hi:[1,1]
    v_pk_mul_f32 v[150:151], v[150:151], v[128:129] op_sel:[0,1] op_sel_hi:[1,1]
    v_pk_mul_f32 v[152:153], v[152:153], v[128:129] op_sel:[0,1] op_sel_hi:[1,1]
    v_pk_mul_f32 v[154:155], v[154:155], v[128:129] op_sel:[0,1] op_sel_hi:[1,1]
    v_cvt_pk_bf16_f32 v104, v148, v149
    v_cvt_pk_bf16_f32 v105, v150, v151
    v_cvt_pk_bf16_f32 v106, v152, v153
    v_cvt_pk_bf16_f32 v107, v154, v155
    v_lshlrev_b32 v148, 16, v108
    v_and_b32 v149, 0xffff0000, v108
    v_lshlrev_b32 v150, 16, v109
    v_and_b32 v151, 0xffff0000, v109
    v_lshlrev_b32 v152, 16, v110
    v_and_b32 v153, 0xffff0000, v110
    v_lshlrev_b32 v154, 16, v111
    v_and_b32 v155, 0xffff0000, v111
    v_pk_add_f32 v[148:149], v[148:149], v[128:129] op_sel_hi:[1,0]
    v_pk_add_f32 v[150:151], v[150:151], v[128:129] op_sel_hi:[1,0]
    v_pk_add_f32 v[152:153], v[152:153], v[128:129] op_sel_hi:[1,0]
    v_pk_add_f32 v[154:155], v[154:155], v[128:129] op_sel_hi:[1,0]
    v_cvt_pk_bf16_f32 v148, 0, v148
    v_cvt_pk_bf16_f32 v149, 0, v149
    v_cvt_pk_bf16_f32 v150, 0, v150
    v_cvt_pk_bf16_f32 v151, 0, v151
    v_cvt_pk_bf16_f32 v152, 0, v152
    v_cvt_pk_bf16_f32 v153, 0, v153
    v_cvt_pk_bf16_f32 v154, 0, v154
    v_cvt_pk_bf16_f32 v155, 0, v155
    v_pk_mul_f32 v[148:149], v[148:149], v[128:129] op_sel:[0,1] op_sel_hi:[1,1]
    v_pk_mul_f32 v[150:151], v[150:151], v[128:129] op_sel:[0,1] op_sel_hi:[1,1]
    v_pk_mul_f32 v[152:153], v[152:153], v[128:129] op_sel:[0,1] op_sel_hi:[1,1]
    v_pk_mul_f32 v[154:155], v[154:155], v[128:129] op_sel:[0,1] op_sel_hi:[1,1]
    v_cvt_pk_bf16_f32 v108, v148, v149
    v_cvt_pk_bf16_f32 v109, v150, v151
    v_cvt_pk_bf16_f32 v110, v152, v153
    v_cvt_pk_bf16_f32 v111, v154, v155
    v_lshlrev_b32 v148, 16, v112
    v_and_b32 v149, 0xffff0000, v112
    v_lshlrev_b32 v150, 16, v113
    v_and_b32 v151, 0xffff0000, v113
    v_lshlrev_b32 v152, 16, v114
    v_and_b32 v153, 0xffff0000, v114
    v_lshlrev_b32 v154, 16, v115
    v_and_b32 v155, 0xffff0000, v115
    v_pk_add_f32 v[148:149], v[148:149], v[128:129] op_sel_hi:[1,0]
    v_pk_add_f32 v[150:151], v[150:151], v[128:129] op_sel_hi:[1,0]
    v_pk_add_f32 v[152:153], v[152:153], v[128:129] op_sel_hi:[1,0]
    v_pk_add_f32 v[154:155], v[154:155], v[128:129] op_sel_hi:[1,0]
    v_cvt_pk_bf16_f32 v148, 0, v148
    v_cvt_pk_bf16_f32 v149, 0, v149
    v_cvt_pk_bf16_f32 v150, 0, v150
    v_cvt_pk_bf16_f32 v151, 0, v151
    v_cvt_pk_bf16_f32 v152, 0, v152
    v_cvt_pk_bf16_f32 v153, 0, v153
    v_cvt_pk_bf16_f32 v154, 0, v154
    v_cvt_pk_bf16_f32 v155, 0, v155
    v_pk_mul_f32 v[148:149], v[148:149], v[128:129] op_sel:[0,1] op_sel_hi:[1,1]
    v_pk_mul_f32 v[150:151], v[150:151], v[128:129] op_sel:[0,1] op_sel_hi:[1,1]
    v_pk_mul_f32 v[152:153], v[152:153], v[128:129] op_sel:[0,1] op_sel_hi:[1,1]
    v_pk_mul_f32 v[154:155], v[154:155], v[128:129] op_sel:[0,1] op_sel_hi:[1,1]
    v_cvt_pk_bf16_f32 v112, v148, v149
    v_cvt_pk_bf16_f32 v113, v150, v151
    v_cvt_pk_bf16_f32 v114, v152, v153
    v_cvt_pk_bf16_f32 v115, v154, v155
    ds_write_b128 v4, v[36:39] offset:0
    ds_write_b128 v5, v[56:59] offset:0
    ds_write_b128 v6, v[76:79] offset:0
    ds_write_b128 v7, v[96:99] offset:0
    s_mov_b32 exec_lo, 0xffff
    s_mov_b32 exec_hi, 0xffff
    ds_write_b128 v34, v[116:119] offset:0
    s_mov_b64 exec, -1
    s_waitcnt lgkmcnt(0)
    s_cmp_eq_u32 s22, 0
    s_cbranch_scc0 L_k1_Q_ph1
    s_waitcnt vmcnt(6)
    s_barrier
    ds_read_b128 a[24:27], v32 offset:0
    ds_read_b128 a[28:31], v32 offset:1024
    ds_read_b128 a[32:35], v33 offset:0
    ds_read_b64_tr_b16 a[0:1], v10 offset:0
    ds_read_b64_tr_b16 a[2:3], v10 offset:4096
    ds_read_b64_tr_b16 a[4:5], v11 offset:0
    ds_read_b64_tr_b16 a[6:7], v11 offset:4096
    ds_read_b64_tr_b16 a[8:9], v12 offset:0
    ds_read_b64_tr_b16 a[10:11], v12 offset:4096
    ds_read_b64_tr_b16 a[12:13], v13 offset:0
    ds_read_b64_tr_b16 a[14:15], v13 offset:4096
    s_waitcnt lgkmcnt(4)
    v_mfma_f32_16x16x32_bf16 v[128:131], a[0:3], a[24:27], 0
    ds_read_b64_tr_b16 a[16:17], v14 offset:0
    v_mfma_f32_16x16x32_bf16 v[164:167], a[0:3], a[28:31], 0
    ds_read_b64_tr_b16 a[18:19], v14 offset:4096
    v_mfma_f32_16x16x32_bf16 v[132:135], a[4:7], a[24:27], 0
    ds_read_b64_tr_b16 a[20:21], v15 offset:0
    v_mfma_f32_16x16x32_bf16 v[168:171], a[4:7], a[28:31], 0
    ds_read_b64_tr_b16 a[22:23], v15 offset:4096
    s_waitcnt lgkmcnt(4)
    v_mfma_f32_16x16x32_bf16 v[136:139], a[8:11], a[24:27], 0
    ds_read_b64_tr_b16 a[0:1], v16 offset:0
    v_mfma_f32_16x16x32_bf16 v[172:175], a[8:11], a[28:31], 0
    ds_read_b64_tr_b16 a[2:3], v16 offset:4096
    v_mfma_f32_16x16x32_bf16 v[140:143], a[12:15], a[24:27], 0
    ds_read_b64_tr_b16 a[4:5], v17 offset:0
    v_mfma_f32_16x16x32_bf16 v[176:179], a[12:15], a[28:31], 0
    ds_read_b64_tr_b16 a[6:7], v17 offset:4096
    s_waitcnt lgkmcnt(4)
    v_mfma_f32_16x16x32_bf16 v[144:147], a[16:19], a[24:27], 0
    ds_read_b64_tr_b16 a[8:9], v18 offset:0
    v_mfma_f32_16x16x32_bf16 v[180:183], a[16:19], a[28:31], 0
    ds_read_b64_tr_b16 a[10:11], v18 offset:4096
    v_mfma_f32_16x16x32_bf16 v[148:151], a[20:23], a[24:27], 0
    ds_read_b64_tr_b16 a[12:13], v19 offset:0
    v_mfma_f32_16x16x32_bf16 v[184:187], a[20:23], a[28:31], 0
    ds_read_b64_tr_b16 a[14:15], v19 offset:4096
    s_waitcnt lgkmcnt(4)
    v_mfma_f32_16x16x32_bf16 v[152:155], a[24:27], a[0:3], 0
    ds_read_b64_tr_b16 a[16:17], v20 offset:0
    v_mfma_f32_16x16x32_bf16 v[188:191], a[28:31], a[0:3], 0
    ds_read_b64_tr_b16 a[18:19], v20 offset:4096
    s_waitcnt vmcnt(4)
    s_barrier
    ds_write_b128 v4, v[40:43] offset:37120
    ds_write_b128 v5, v[60:63] offset:37120
    ds_write_b128 v6, v[80:83] offset:37120
    ds_write_b128 v7, v[100:103] offset:37120
    s_mov_b32 exec_lo, 0xffff0000
    s_mov_b32 exec_hi, 0xffff0000
    ds_write_b128 v34, v[116:119] offset:37120
    s_mov_b64 exec, -1
    ds_read_b128 a[36:39], v32 offset:9280
    ds_read_b128 a[40:43], v32 offset:10304
    ds_read_b128 a[44:47], v33 offset:9280
    s_add_u32 m0, s28, 0x10000
    s_nop 0
    buffer_load_dwordx4 v8, s[8:11], s23 offen lds
    v_mfma_f32_16x16x32_bf16 v[156:159], a[24:27], a[4:7], 0
    ds_read_b64_tr_b16 a[20:21], v10 offset:16384
    v_mfma_f32_16x16x32_bf16 v[192:195], a[28:31], a[4:7], 0
    ds_read_b64_tr_b16 a[22:23], v10 offset:20480
    s_waitcnt lgkmcnt(12)
    v_mfma_f32_16x16x32_bf16 v[160:163], a[24:27], a[8:11], 0
    ds_read_b64_tr_b16 a[0:1], v11 offset:16384
    v_mfma_f32_16x16x32_bf16 v[196:199], a[28:31], a[8:11], 0
    ds_read_b64_tr_b16 a[2:3], v11 offset:20480
    s_add_u32 m0, s28, 0x10400
    s_nop 0
    buffer_load_dwordx4 v9, s[8:11], s23 offen lds
    s_add_u32 s23, s23, 122880
    v_mfma_f32_16x16x32_bf16 v[200:203], a[12:15], a[32:35], 0
    ds_read_b64_tr_b16 a[4:5], v12 offset:16384
    ds_read_b64_tr_b16 a[6:7], v12 offset:20480
    s_waitcnt lgkmcnt(4)
    v_mfma_f32_16x16x32_bf16 v[204:207], a[32:35], a[16:19], 0
    ds_read_b64_tr_b16 a[8:9], v13 offset:16384
    ds_read_b64_tr_b16 a[10:11], v13 offset:20480
    v_mfma_f32_16x16x32_bf16 v[128:131], a[20:23], a[36:39], v[128:131]
    ds_read_b64_tr_b16 a[12:13], v14 offset:16384
    v_mfma_f32_16x16x32_bf16 v[164:167], a[20:23], a[40:43], v[164:167]
    ds_read_b64_tr_b16 a[14:15], v14 offset:20480
    s_waitcnt lgkmcnt(4)
    v_mfma_f32_16x16x32_bf16 v[132:135], a[0:3], a[36:39], v[132:135]
    ds_read_b64_tr_b16 a[16:17], v15 offset:16384
    v_mfma_f32_16x16x32_bf16 v[168:171], a[0:3], a[40:43], v[168:171]
    ds_read_b64_tr_b16 a[18:19], v15 offset:20480
    v_mfma_f32_16x16x32_bf16 v[136:139], a[4:7], a[36:39], v[136:139]
    ds_read_b64_tr_b16 a[20:21], v16 offset:16384
    v_mfma_f32_16x16x32_bf16 v[172:175], a[4:7], a[40:43], v[172:175]
    ds_read_b64_tr_b16 a[22:23], v16 offset:20480
    s_waitcnt lgkmcnt(4)
    v_mfma_f32_16x16x32_bf16 v[140:143], a[8:11], a[36:39], v[140:143]
    ds_read_b64_tr_b16 a[0:1], v17 offset:16384
    v_mfma_f32_16x16x32_bf16 v[176:179], a[8:11], a[40:43], v[176:179]
    ds_read_b64_tr_b16 a[2:3], v17 offset:20480
    v_mfma_f32_16x16x32_bf16 v[144:147], a[12:15], a[36:39], v[144:147]
    ds_read_b64_tr_b16 a[4:5], v18 offset:16384
    v_mfma_f32_16x16x32_bf16 v[180:183], a[12:15], a[40:43], v[180:183]
    ds_read_b64_tr_b16 a[6:7], v18 offset:20480
    s_waitcnt lgkmcnt(4)
    v_mfma_f32_16x16x32_bf16 v[148:151], a[16:19], a[36:39], v[148:151]
    ds_read_b64_tr_b16 a[8:9], v19 offset:16384
    v_mfma_f32_16x16x32_bf16 v[184:187], a[16:19], a[40:43], v[184:187]
    ds_read_b64_tr_b16 a[10:11], v19 offset:20480
    v_mfma_f32_16x16x32_bf16 v[152:155], a[36:39], a[20:23], v[152:155]
    ds_read_b64_tr_b16 a[12:13], v20 offset:16384
    v_mfma_f32_16x16x32_bf16 v[188:191], a[40:43], a[20:23], v[188:191]
    ds_read_b64_tr_b16 a[14:15], v20 offset:20480
    s_waitcnt vmcnt(4)
    s_barrier
    ds_read_b128 a[24:27], v32 offset:18560
    ds_read_b128 a[28:31], v32 offset:19584
    ds_read_b128 a[32:35], v33 offset:18560
    s_add_u32 m0, s28, 0x0
    s_nop 0
    buffer_load_dwordx4 v8, s[8:11], s23 offen lds
    s_waitcnt lgkmcnt(7)
    v_mfma_f32_16x16x32_bf16 v[156:159], a[36:39], a[0:3], v[156:159]
    ds_read_b64_tr_b16 a[16:17], v10 offset:32768
    v_mfma_f32_16x16x32_bf16 v[192:195], a[40:43], a[0:3], v[192:195]
    ds_read_b64_tr_b16 a[18:19], v10 offset:36864
    v_mfma_f32_16x16x32_bf16 v[160:163], a[36:39], a[4:7], v[160:163]
    ds_read_b64_tr_b16 a[20:21], v11 offset:32768
    v_mfma_f32_16x16x32_bf16 v[196:199], a[40:43], a[4:7], v[196:199]
    ds_read_b64_tr_b16 a[22:23], v11 offset:36864
    s_add_u32 m0, s28, 0x400
    s_nop 0
    buffer_load_dwordx4 v9, s[8:11], s23 offen lds
    s_add_u32 s23, s23, 122880
    s_waitcnt lgkmcnt(7)
    v_mfma_f32_16x16x32_bf16 v[200:203], a[8:11], a[44:47], v[200:203]
    ds_read_b64_tr_b16 a[0:1], v12 offset:32768
    ds_read_b64_tr_b16 a[2:3], v12 offset:36864
    v_mfma_f32_16x16x32_bf16 v[204:207], a[44:47], a[12:15], v[204:207]
    ds_read_b64_tr_b16 a[4:5], v13 offset:32768
    ds_read_b64_tr_b16 a[6:7], v13 offset:36864
    s_waitcnt lgkmcnt(4)
    v_mfma_f32_16x16x32_bf16 v[128:131], a[16:19], a[24:27], v[128:131]
    ds_read_b64_tr_b16 a[8:9], v14 offset:32768
    v_mfma_f32_16x16x32_bf16 v[164:167], a[16:19], a[28:31], v[164:167]
    ds_read_b64_tr_b16 a[10:11], v14 offset:36864
    v_mfma_f32_16x16x32_bf16 v[132:135], a[20:23], a[24:27], v[132:135]
    ds_read_b64_tr_b16 a[12:13], v15 offset:32768
    v_mfma_f32_16x16x32_bf16 v[168:171], a[20:23], a[28:31], v[168:171]
    ds_read_b64_tr_b16 a[14:15], v15 offset:36864
    s_waitcnt lgkmcnt(4)
    v_mfma_f32_16x16x32_bf16 v[136:139], a[0:3], a[24:27], v[136:139]
    ds_read_b64_tr_b16 a[16:17], v16 offset:32768
    v_mfma_f32_16x16x32_bf16 v[172:175], a[0:3], a[28:31], v[172:175]
    ds_read_b64_tr_b16 a[18:19], v16 offset:36864
    v_mfma_f32_16x16x32_bf16 v[140:143], a[4:7], a[24:27], v[140:143]
    ds_read_b64_tr_b16 a[20:21], v17 offset:32768
    v_mfma_f32_16x16x32_bf16 v[176:179], a[4:7], a[28:31], v[176:179]
    ds_read_b64_tr_b16 a[22:23], v17 offset:36864
    s_waitcnt lgkmcnt(4)
    v_mfma_f32_16x16x32_bf16 v[144:147], a[8:11], a[24:27], v[144:147]
    ds_read_b64_tr_b16 a[0:1], v18 offset:32768
    v_mfma_f32_16x16x32_bf16 v[180:183], a[8:11], a[28:31], v[180:183]
    ds_read_b64_tr_b16 a[2:3], v18 offset:36864
    v_mfma_f32_16x16x32_bf16 v[148:151], a[12:15], a[24:27], v[148:151]
    ds_read_b64_tr_b16 a[4:5], v19 offset:32768
    v_mfma_f32_16x16x32_bf16 v[184:187], a[12:15], a[28:31], v[184:187]
    ds_read_b64_tr_b16 a[6:7], v19 offset:36864
    s_waitcnt lgkmcnt(4)
    v_mfma_f32_16x16x32_bf16 v[152:155], a[24:27], a[16:19], v[152:155]
    ds_read_b64_tr_b16 a[8:9], v20 offset:32768
    v_mfma_f32_16x16x32_bf16 v[188:191], a[28:31], a[16:19], v[188:191]
    ds_read_b64_tr_b16 a[10:11], v20 offset:36864
    s_waitcnt vmcnt(4)
    s_barrier
    ds_read_b128 a[36:39], v32 offset:27840
    ds_read_b128 a[40:43], v32 offset:28864
    ds_read_b128 a[44:47], v33 offset:27840
    s_add_u32 m0, s28, 0x4000
    s_nop 0
    buffer_load_dwordx4 v8, s[8:11], s23 offen lds
    v_mfma_f32_16x16x32_bf16 v[156:159], a[24:27], a[20:23], v[156:159]
    ds_read_b64_tr_b16 a[12:13], v10 offset:49152
    v_mfma_f32_16x16x32_bf16 v[192:195], a[28:31], a[20:23], v[192:195]
    ds_read_b64_tr_b16 a[14:15], v10 offset:53248
    s_waitcnt lgkmcnt(7)
    v_mfma_f32_16x16x32_bf16 v[160:163], a[24:27], a[0:3], v[160:163]
    ds_read_b64_tr_b16 a[16:17], v11 offset:49152
    v_mfma_f32_16x16x32_bf16 v[196:199], a[28:31], a[0:3], v[196:199]
    ds_read_b64_tr_b16 a[18:19], v11 offset:53248
    s_add_u32 m0, s28, 0x4400
    s_nop 0
    buffer_load_dwordx4 v9, s[8:11], s23 offen lds
    s_add_u32 s23, s23, 122880
    v_mfma_f32_16x16x32_bf16 v[200:203], a[4:7], a[32:35], v[200:203]
    ds_read_b64_tr_b16 a[20:21], v12 offset:49152
    ds_read_b64_tr_b16 a[22:23], v12 offset:53248
    s_waitcnt lgkmcnt(4)
    v_mfma_f32_16x16x32_bf16 v[204:207], a[32:35], a[8:11], v[204:207]
    ds_read_b64_tr_b16 a[0:1], v13 offset:49152
    ds_read_b64_tr_b16 a[2:3], v13 offset:53248
    v_mfma_f32_16x16x32_bf16 v[128:131], a[12:15], a[36:39], v[128:131]
    ds_read_b64_tr_b16 a[4:5], v14 offset:49152
    v_mfma_f32_16x16x32_bf16 v[164:167], a[12:15], a[40:43], v[164:167]
    ds_read_b64_tr_b16 a[6:7], v14 offset:53248
    s_waitcnt lgkmcnt(4)
    v_mfma_f32_16x16x32_bf16 v[132:135], a[16:19], a[36:39], v[132:135]
    ds_read_b64_tr_b16 a[8:9], v15 offset:49152
    v_mfma_f32_16x16x32_bf16 v[168:171], a[16:19], a[40:43], v[168:171]
    ds_read_b64_tr_b16 a[10:11], v15 offset:53248
    v_mfma_f32_16x16x32_bf16 v[136:139], a[20:23], a[36:39], v[136:139]
    ds_read_b64_tr_b16 a[12:13], v16 offset:49152
    v_mfma_f32_16x16x32_bf16 v[172:175], a[20:23], a[40:43], v[172:175]
    ds_read_b64_tr_b16 a[14:15], v16 offset:53248
    s_waitcnt lgkmcnt(4)
    v_mfma_f32_16x16x32_bf16 v[140:143], a[0:3], a[36:39], v[140:143]
    ds_read_b64_tr_b16 a[16:17], v17 offset:49152
    v_mfma_f32_16x16x32_bf16 v[176:179], a[0:3], a[40:43], v[176:179]
    ds_read_b64_tr_b16 a[18:19], v17 offset:53248
    v_mfma_f32_16x16x32_bf16 v[144:147], a[4:7], a[36:39], v[144:147]
    ds_read_b64_tr_b16 a[20:21], v18 offset:49152
    v_mfma_f32_16x16x32_bf16 v[180:183], a[4:7], a[40:43], v[180:183]
    ds_read_b64_tr_b16 a[22:23], v18 offset:53248
    s_waitcnt lgkmcnt(4)
    v_mfma_f32_16x16x32_bf16 v[148:151], a[8:11], a[36:39], v[148:151]
    ds_read_b64_tr_b16 a[0:1], v19 offset:49152
    v_mfma_f32_16x16x32_bf16 v[184:187], a[8:11], a[40:43], v[184:187]
    ds_read_b64_tr_b16 a[2:3], v19 offset:53248
    v_mfma_f32_16x16x32_bf16 v[152:155], a[36:39], a[12:15], v[152:155]
    ds_read_b64_tr_b16 a[4:5], v20 offset:49152
    v_mfma_f32_16x16x32_bf16 v[188:191], a[40:43], a[12:15], v[188:191]
    ds_read_b64_tr_b16 a[6:7], v20 offset:53248
    s_waitcnt vmcnt(4)
    s_barrier
    ds_read_b128 a[24:27], v35 offset:0
    ds_read_b128 a[28:31], v35 offset:1024
    ds_read_b128 a[32:35], v33 offset:37120
    s_add_u32 m0, s28, 0x8000
    s_nop 0
    buffer_load_dwordx4 v8, s[8:11], s23 offen lds
    s_waitcnt lgkmcnt(7)
    v_mfma_f32_16x16x32_bf16 v[156:159], a[36:39], a[16:19], v[156:159]
    ds_read_b64_tr_b16 a[8:9], v21 offset:0
    v_mfma_f32_16x16x32_bf16 v[192:195], a[40:43], a[16:19], v[192:195]
    ds_read_b64_tr_b16 a[10:11], v21 offset:4096
    v_mfma_f32_16x16x32_bf16 v[160:163], a[36:39], a[20:23], v[160:163]
    ds_read_b64_tr_b16 a[12:13], v22 offset:0
    v_mfma_f32_16x16x32_bf16 v[196:199], a[40:43], a[20:23], v[196:199]
    ds_read_b64_tr_b16 a[14:15], v22 offset:4096
    s_add_u32 m0, s28, 0x8400
    s_nop 0
    buffer_load_dwordx4 v9, s[8:11], s23 offen lds
    s_add_u32 s23, s23, 122880
    s_waitcnt lgkmcnt(7)
    v_mfma_f32_16x16x32_bf16 v[200:203], a[0:3], a[44:47], v[200:203]
    ds_read_b64_tr_b16 a[16:17], v23 offset:0
    ds_read_b64_tr_b16 a[18:19], v23 offset:4096
    v_mfma_f32_16x16x32_bf16 v[204:207], a[44:47], a[4:7], v[204:207]
    ds_read_b64_tr_b16 a[20:21], v24 offset:0
    ds_read_b64_tr_b16 a[22:23], v24 offset:4096
    s_waitcnt lgkmcnt(4)
    v_mfma_f32_16x16x32_bf16 v[128:131], a[8:11], a[24:27], v[128:131]
    ds_read_b64_tr_b16 a[0:1], v25 offset:0
    v_mfma_f32_16x16x32_bf16 v[164:167], a[8:11], a[28:31], v[164:167]
    ds_read_b64_tr_b16 a[2:3], v25 offset:4096
    v_mfma_f32_16x16x32_bf16 v[132:135], a[12:15], a[24:27], v[132:135]
    ds_read_b64_tr_b16 a[4:5], v26 offset:0
    v_mfma_f32_16x16x32_bf16 v[168:171], a[12:15], a[28:31], v[168:171]
    ds_read_b64_tr_b16 a[6:7], v26 offset:4096
    s_waitcnt lgkmcnt(4)
    v_mfma_f32_16x16x32_bf16 v[136:139], a[16:19], a[24:27], v[136:139]
    ds_read_b64_tr_b16 a[8:9], v27 offset:0
    v_mfma_f32_16x16x32_bf16 v[172:175], a[16:19], a[28:31], v[172:175]
    ds_read_b64_tr_b16 a[10:11], v27 offset:4096
    v_mfma_f32_16x16x32_bf16 v[140:143], a[20:23], a[24:27], v[140:143]
    ds_read_b64_tr_b16 a[12:13], v28 offset:0
    v_mfma_f32_16x16x32_bf16 v[176:179], a[20:23], a[28:31], v[176:179]
    ds_read_b64_tr_b16 a[14:15], v28 offset:4096
    s_waitcnt lgkmcnt(4)
    v_mfma_f32_16x16x32_bf16 v[144:147], a[0:3], a[24:27], v[144:147]
    ds_read_b64_tr_b16 a[16:17], v29 offset:0
    v_mfma_f32_16x16x32_bf16 v[180:183], a[0:3], a[28:31], v[180:183]
    ds_read_b64_tr_b16 a[18:19], v29 offset:4096
    v_mfma_f32_16x16x32_bf16 v[148:151], a[4:7], a[24:27], v[148:151]
    ds_read_b64_tr_b16 a[20:21], v30 offset:0
    v_mfma_f32_16x16x32_bf16 v[184:187], a[4:7], a[28:31], v[184:187]
    ds_read_b64_tr_b16 a[22:23], v30 offset:4096
    s_waitcnt lgkmcnt(4)
    v_mfma_f32_16x16x32_bf16 v[152:155], a[24:27], a[8:11], v[152:155]
    ds_read_b64_tr_b16 a[0:1], v31 offset:0
    v_mfma_f32_16x16x32_bf16 v[188:191], a[28:31], a[8:11], v[188:191]
    ds_read_b64_tr_b16 a[2:3], v31 offset:4096
    s_waitcnt vmcnt(4)
    s_barrier
    ds_write_b128 v4, v[44:47] offset:0
    ds_write_b128 v5, v[64:67] offset:0
    ds_write_b128 v6, v[84:87] offset:0
    ds_write_b128 v7, v[104:107] offset:0
    s_mov_b32 exec_lo, 0xffff
    s_mov_b32 exec_hi, 0xffff
    ds_write_b128 v34, v[120:123] offset:0
    s_mov_b64 exec, -1
    ds_read_b128 a[36:39], v35 offset:9280
    ds_read_b128 a[40:43], v35 offset:10304
    ds_read_b128 a[44:47], v33 offset:46400
    s_add_u32 m0, s28, 0xc000
    s_nop 0
    buffer_load_dwordx4 v8, s[8:11], s23 offen lds
    v_mfma_f32_16x16x32_bf16 v[156:159], a[24:27], a[12:15], v[156:159]
    ds_read_b64_tr_b16 a[4:5], v10 offset:0
    v_mfma_f32_16x16x32_bf16 v[192:195], a[28:31], a[12:15], v[192:195]
    ds_read_b64_tr_b16 a[6:7], v10 offset:4096
    s_waitcnt lgkmcnt(12)
    v_mfma_f32_16x16x32_bf16 v[160:163], a[24:27], a[16:19], v[160:163]
    ds_read_b64_tr_b16 a[8:9], v11 offset:0
    v_mfma_f32_16x16x32_bf16 v[196:199], a[28:31], a[16:19], v[196:199]
    ds_read_b64_tr_b16 a[10:11], v11 offset:4096
    s_add_u32 m0, s28, 0xc400
    s_nop 0
    buffer_load_dwordx4 v9, s[8:11], s23 offen lds
    s_add_u32 s23, s23, 122880
    v_mfma_f32_16x16x32_bf16 v[200:203], a[20:23], a[32:35], v[200:203]
    ds_read_b64_tr_b16 a[12:13], v12 offset:0
    ds_read_b64_tr_b16 a[14:15], v12 offset:4096
    s_waitcnt lgkmcnt(4)
    v_mfma_f32_16x16x32_bf16 v[204:207], a[32:35], a[0:3], v[204:207]
    ds_read_b64_tr_b16 a[16:17], v13 offset:0
    ds_read_b64_tr_b16 a[18:19], v13 offset:4096
    v_mfma_f32_16x16x32_bf16 v[128:131], a[4:7], a[36:39], v[128:131]
    ds_read_b64_tr_b16 a[20:21], v14 offset:0
    v_mfma_f32_16x16x32_bf16 v[164:167], a[4:7], a[40:43], v[164:167]
    ds_read_b64_tr_b16 a[22:23], v14 offset:4096
    s_waitcnt lgkmcnt(4)
    v_mfma_f32_16x16x32_bf16 v[132:135], a[8:11], a[36:39], v[132:135]
    ds_read_b64_tr_b16 a[0:1], v15 offset:0
    v_mfma_f32_16x16x32_bf16 v[168:171], a[8:11], a[40:43], v[168:171]
    ds_read_b64_tr_b16 a[2:3], v15 offset:4096
    v_mfma_f32_16x16x32_bf16 v[136:139], a[12:15], a[36:39], v[136:139]
    ds_read_b64_tr_b16 a[4:5], v16 offset:0
    v_mfma_f32_16x16x32_bf16 v[172:175], a[12:15], a[40:43], v[172:175]
    ds_read_b64_tr_b16 a[6:7], v16 offset:4096
    s_waitcnt lgkmcnt(4)
    v_mfma_f32_16x16x32_bf16 v[140:143], a[16:19], a[36:39], v[140:143]
    ds_read_b64_tr_b16 a[8:9], v17 offset:0
    v_mfma_f32_16x16x32_bf16 v[176:179], a[16:19], a[40:43], v[176:179]
    ds_read_b64_tr_b16 a[10:11], v17 offset:4096
    v_mfma_f32_16x16x32_bf16 v[144:147], a[20:23], a[36:39], v[144:147]
    ds_read_b64_tr_b16 a[12:13], v18 offset:0
    v_mfma_f32_16x16x32_bf16 v[180:183], a[20:23], a[40:43], v[180:183]
    ds_read_b64_tr_b16 a[14:15], v18 offset:4096
    s_waitcnt lgkmcnt(4)
    v_mfma_f32_16x16x32_bf16 v[148:151], a[0:3], a[36:39], v[148:151]
    ds_read_b64_tr_b16 a[16:17], v19 offset:0
    v_mfma_f32_16x16x32_bf16 v[184:187], a[0:3], a[40:43], v[184:187]
    ds_read_b64_tr_b16 a[18:19], v19 offset:4096
    v_mfma_f32_16x16x32_bf16 v[152:155], a[36:39], a[4:7], v[152:155]
    ds_read_b64_tr_b16 a[20:21], v20 offset:0
    v_mfma_f32_16x16x32_bf16 v[188:191], a[40:43], a[4:7], v[188:191]
    ds_read_b64_tr_b16 a[22:23], v20 offset:4096
    s_waitcnt vmcnt(4)
    s_barrier
    ds_read_b128 a[24:27], v35 offset:18560
    ds_read_b128 a[28:31], v35 offset:19584
    ds_read_b128 a[32:35], v33 offset:55680
    s_add_u32 m0, s28, 0x10000
    s_nop 0
    buffer_load_dwordx4 v8, s[8:11], s23 offen lds
    s_waitcnt lgkmcnt(7)
    v_mfma_f32_16x16x32_bf16 v[156:159], a[36:39], a[8:11], v[156:159]
    ds_read_b64_tr_b16 a[0:1], v10 offset:16384
    v_mfma_f32_16x16x32_bf16 v[192:195], a[40:43], a[8:11], v[192:195]
    ds_read_b64_tr_b16 a[2:3], v10 offset:20480
    v_mfma_f32_16x16x32_bf16 v[160:163], a[36:39], a[12:15], v[160:163]
    ds_read_b64_tr_b16 a[4:5], v11 offset:16384
    v_mfma_f32_16x16x32_bf16 v[196:199], a[40:43], a[12:15], v[196:199]
    ds_read_b64_tr_b16 a[6:7], v11 offset:20480
    s_add_u32 m0, s28, 0x10400
    s_nop 0
    buffer_load_dwordx4 v9, s[8:11], s23 offen lds
    s_add_u32 s23, s23, 122880
    s_waitcnt lgkmcnt(7)
    v_mfma_f32_16x16x32_bf16 v[200:203], a[16:19], a[44:47], v[200:203]
    ds_read_b64_tr_b16 a[8:9], v12 offset:16384
    ds_read_b64_tr_b16 a[10:11], v12 offset:20480
    v_mfma_f32_16x16x32_bf16 v[204:207], a[44:47], a[20:23], v[204:207]
    ds_read_b64_tr_b16 a[12:13], v13 offset:16384
    ds_read_b64_tr_b16 a[14:15], v13 offset:20480
    s_waitcnt lgkmcnt(4)
    v_mfma_f32_16x16x32_bf16 v[128:131], a[0:3], a[24:27], v[128:131]
    ds_read_b64_tr_b16 a[16:17], v14 offset:16384
    v_mfma_f32_16x16x32_bf16 v[164:167], a[0:3], a[28:31], v[164:167]
    ds_read_b64_tr_b16 a[18:19], v14 offset:20480
    v_mfma_f32_16x16x32_bf16 v[132:135], a[4:7], a[24:27], v[132:135]
    ds_read_b64_tr_b16 a[20:21], v15 offset:16384
    v_mfma_f32_16x16x32_bf16 v[168:171], a[4:7], a[28:31], v[168:171]
    ds_read_b64_tr_b16 a[22:23], v15 offset:20480
    s_waitcnt lgkmcnt(4)
    v_mfma_f32_16x16x32_bf16 v[136:139], a[8:11], a[24:27], v[136:139]
    ds_read_b64_tr_b16 a[0:1], v16 offset:16384
    v_mfma_f32_16x16x32_bf16 v[172:175], a[8:11], a[28:31], v[172:175]
    ds_read_b64_tr_b16 a[2:3], v16 offset:20480
    v_mfma_f32_16x16x32_bf16 v[140:143], a[12:15], a[24:27], v[140:143]
    ds_read_b64_tr_b16 a[4:5], v17 offset:16384
    v_mfma_f32_16x16x32_bf16 v[176:179], a[12:15], a[28:31], v[176:179]
    ds_read_b64_tr_b16 a[6:7], v17 offset:20480
    s_waitcnt lgkmcnt(4)
    v_mfma_f32_16x16x32_bf16 v[144:147], a[16:19], a[24:27], v[144:147]
    ds_read_b64_tr_b16 a[8:9], v18 offset:16384
    v_mfma_f32_16x16x32_bf16 v[180:183], a[16:19], a[28:31], v[180:183]
    ds_read_b64_tr_b16 a[10:11], v18 offset:20480
    v_mfma_f32_16x16x32_bf16 v[148:151], a[20:23], a[24:27], v[148:151]
    ds_read_b64_tr_b16 a[12:13], v19 offset:16384
    v_mfma_f32_16x16x32_bf16 v[184:187], a[20:23], a[28:31], v[184:187]
    ds_read_b64_tr_b16 a[14:15], v19 offset:20480
    s_waitcnt lgkmcnt(4)
    v_mfma_f32_16x16x32_bf16 v[152:155], a[24:27], a[0:3], v[152:155]
    ds_read_b64_tr_b16 a[16:17], v20 offset:16384
    v_mfma_f32_16x16x32_bf16 v[188:191], a[28:31], a[0:3], v[188:191]
    ds_read_b64_tr_b16 a[18:19], v20 offset:20480
    s_waitcnt vmcnt(4)
    s_barrier
    ds_read_b128 a[36:39], v35 offset:27840
    ds_read_b128 a[40:43], v35 offset:28864
    ds_read_b128 a[44:47], v33 offset:64960
    s_add_u32 m0, s28, 0x0
    s_nop 0
    buffer_load_dwordx4 v8, s[8:11], s23 offen lds
    v_mfma_f32_16x16x32_bf16 v[156:159], a[24:27], a[4:7], v[156:159]
    ds_read_b64_tr_b16 a[20:21], v10 offset:32768
    v_mfma_f32_16x16x32_bf16 v[192:195], a[28:31], a[4:7], v[192:195]
    ds_read_b64_tr_b16 a[22:23], v10 offset:36864
    s_waitcnt lgkmcnt(7)
    v_mfma_f32_16x16x32_bf16 v[160:163], a[24:27], a[8:11], v[160:163]
    ds_read_b64_tr_b16 a[0:1], v11 offset:32768
    v_mfma_f32_16x16x32_bf16 v[196:199], a[28:31], a[8:11], v[196:199]
    ds_read_b64_tr_b16 a[2:3], v11 offset:36864
    s_add_u32 m0, s28, 0x400
    s_nop 0
    buffer_load_dwordx4 v9, s[8:11], s23 offen lds
    s_add_u32 s23, s23, 122880
    v_mfma_f32_16x16x32_bf16 v[200:203], a[12:15], a[32:35], v[200:203]
    ds_read_b64_tr_b16 a[4:5], v12 offset:32768
    ds_read_b64_tr_b16 a[6:7], v12 offset:36864
    s_waitcnt lgkmcnt(4)
    v_mfma_f32_16x16x32_bf16 v[204:207], a[32:35], a[16:19], v[204:207]
    ds_read_b64_tr_b16 a[8:9], v13 offset:32768
    ds_read_b64_tr_b16 a[10:11], v13 offset:36864
    v_mfma_f32_16x16x32_bf16 v[128:131], a[20:23], a[36:39], v[128:131]
    ds_read_b64_tr_b16 a[12:13], v14 offset:32768
    v_mfma_f32_16x16x32_bf16 v[164:167], a[20:23], a[40:43], v[164:167]
    ds_read_b64_tr_b16 a[14:15], v14 offset:36864
    s_waitcnt lgkmcnt(4)
    v_mfma_f32_16x16x32_bf16 v[132:135], a[0:3], a[36:39], v[132:135]
    ds_read_b64_tr_b16 a[16:17], v15 offset:32768
    v_mfma_f32_16x16x32_bf16 v[168:171], a[0:3], a[40:43], v[168:171]
    ds_read_b64_tr_b16 a[18:19], v15 offset:36864
    v_mfma_f32_16x16x32_bf16 v[136:139], a[4:7], a[36:39], v[136:139]
    ds_read_b64_tr_b16 a[20:21], v16 offset:32768
    v_mfma_f32_16x16x32_bf16 v[172:175], a[4:7], a[40:43], v[172:175]
    ds_read_b64_tr_b16 a[22:23], v16 offset:36864
    s_waitcnt lgkmcnt(4)
    v_mfma_f32_16x16x32_bf16 v[140:143], a[8:11], a[36:39], v[140:143]
    ds_read_b64_tr_b16 a[0:1], v17 offset:32768
    v_mfma_f32_16x16x32_bf16 v[176:179], a[8:11], a[40:43], v[176:179]
    ds_read_b64_tr_b16 a[2:3], v17 offset:36864
    v_mfma_f32_16x16x32_bf16 v[144:147], a[12:15], a[36:39], v[144:147]
    ds_read_b64_tr_b16 a[4:5], v18 offset:32768
    v_mfma_f32_16x16x32_bf16 v[180:183], a[12:15], a[40:43], v[180:183]
    ds_read_b64_tr_b16 a[6:7], v18 offset:36864
    s_waitcnt lgkmcnt(4)
    v_mfma_f32_16x16x32_bf16 v[148:151], a[16:19], a[36:39], v[148:151]
    ds_read_b64_tr_b16 a[8:9], v19 offset:32768
    v_mfma_f32_16x16x32_bf16 v[184:187], a[16:19], a[40:43], v[184:187]
    ds_read_b64_tr_b16 a[10:11], v19 offset:36864
    v_mfma_f32_16x16x32_bf16 v[152:155], a[36:39], a[20:23], v[152:155]
    ds_read_b64_tr_b16 a[12:13], v20 offset:32768
    v_mfma_f32_16x16x32_bf16 v[188:191], a[40:43], a[20:23], v[188:191]
    ds_read_b64_tr_b16 a[14:15], v20 offset:36864
    s_waitcnt vmcnt(4)
    s_barrier
    ds_read_b128 a[24:27], v32 offset:0
    ds_read_b128 a[28:31], v32 offset:1024
    ds_read_b128 a[32:35], v33 offset:0
    s_add_u32 m0, s28, 0x4000
    s_nop 0
    buffer_load_dwordx4 v8, s[8:11], s23 offen lds
    s_waitcnt lgkmcnt(7)
    v_mfma_f32_16x16x32_bf16 v[156:159], a[36:39], a[0:3], v[156:159]
    ds_read_b64_tr_b16 a[16:17], v10 offset:49152
    v_mfma_f32_16x16x32_bf16 v[192:195], a[40:43], a[0:3], v[192:195]
    ds_read_b64_tr_b16 a[18:19], v10 offset:53248
    v_mfma_f32_16x16x32_bf16 v[160:163], a[36:39], a[4:7], v[160:163]
    ds_read_b64_tr_b16 a[20:21], v11 offset:49152
    v_mfma_f32_16x16x32_bf16 v[196:199], a[40:43], a[4:7], v[196:199]
    ds_read_b64_tr_b16 a[22:23], v11 offset:53248
    s_add_u32 m0, s28, 0x4400
    s_nop 0
    buffer_load_dwordx4 v9, s[8:11], s23 offen lds
    s_add_u32 s23, s23, 122880
    s_waitcnt lgkmcnt(7)
    v_mfma_f32_16x16x32_bf16 v[200:203], a[8:11], a[44:47], v[200:203]
    ds_read_b64_tr_b16 a[0:1], v12 offset:49152
    ds_read_b64_tr_b16 a[2:3], v12 offset:53248
    v_mfma_f32_16x16x32_bf16 v[204:207], a[44:47], a[12:15], v[204:207]
    ds_read_b64_tr_b16 a[4:5], v13 offset:49152
    ds_read_b64_tr_b16 a[6:7], v13 offset:53248
    s_waitcnt lgkmcnt(4)
    v_mfma_f32_16x16x32_bf16 v[128:131], a[16:19], a[24:27], v[128:131]
    ds_read_b64_tr_b16 a[8:9], v14 offset:49152
    v_mfma_f32_16x16x32_bf16 v[164:167], a[16:19], a[28:31], v[164:167]
    ds_read_b64_tr_b16 a[10:11], v14 offset:53248
    v_mfma_f32_16x16x32_bf16 v[132:135], a[20:23], a[24:27], v[132:135]
    ds_read_b64_tr_b16 a[12:13], v15 offset:49152
    v_mfma_f32_16x16x32_bf16 v[168:171], a[20:23], a[28:31], v[168:171]
    ds_read_b64_tr_b16 a[14:15], v15 offset:53248
    s_waitcnt lgkmcnt(4)
    v_mfma_f32_16x16x32_bf16 v[136:139], a[0:3], a[24:27], v[136:139]
    ds_read_b64_tr_b16 a[16:17], v16 offset:49152
    v_mfma_f32_16x16x32_bf16 v[172:175], a[0:3], a[28:31], v[172:175]
    ds_read_b64_tr_b16 a[18:19], v16 offset:53248
    v_mfma_f32_16x16x32_bf16 v[140:143], a[4:7], a[24:27], v[140:143]
    ds_read_b64_tr_b16 a[20:21], v17 offset:49152
    v_mfma_f32_16x16x32_bf16 v[176:179], a[4:7], a[28:31], v[176:179]
    ds_read_b64_tr_b16 a[22:23], v17 offset:53248
    s_waitcnt lgkmcnt(4)
    v_mfma_f32_16x16x32_bf16 v[144:147], a[8:11], a[24:27], v[144:147]
    ds_read_b64_tr_b16 a[0:1], v18 offset:49152
    v_mfma_f32_16x16x32_bf16 v[180:183], a[8:11], a[28:31], v[180:183]
    ds_read_b64_tr_b16 a[2:3], v18 offset:53248
    v_mfma_f32_16x16x32_bf16 v[148:151], a[12:15], a[24:27], v[148:151]
    ds_read_b64_tr_b16 a[4:5], v19 offset:49152
    v_mfma_f32_16x16x32_bf16 v[184:187], a[12:15], a[28:31], v[184:187]
    ds_read_b64_tr_b16 a[6:7], v19 offset:53248
    s_waitcnt lgkmcnt(4)
    v_mfma_f32_16x16x32_bf16 v[152:155], a[24:27], a[16:19], v[152:155]
    ds_read_b64_tr_b16 a[8:9], v20 offset:49152
    v_mfma_f32_16x16x32_bf16 v[188:191], a[28:31], a[16:19], v[188:191]
    ds_read_b64_tr_b16 a[10:11], v20 offset:53248
    s_waitcnt vmcnt(4)
    s_barrier
    ds_write_b128 v4, v[48:51] offset:37120
    ds_write_b128 v5, v[68:71] offset:37120
    ds_write_b128 v6, v[88:91] offset:37120
    ds_write_b128 v7, v[108:111] offset:37120
    s_mov_b32 exec_lo, 0xffff0000
    s_mov_b32 exec_hi, 0xffff0000
    ds_write_b128 v34, v[120:123] offset:37120
    s_mov_b64 exec, -1
    ds_read_b128 a[36:39], v32 offset:9280
    ds_read_b128 a[40:43], v32 offset:10304
    ds_read_b128 a[44:47], v33 offset:9280
    s_add_u32 m0, s28, 0x8000
    s_nop 0
    buffer_load_dwordx4 v8, s[8:11], s23 offen lds
    v_mfma_f32_16x16x32_bf16 v[156:159], a[24:27], a[20:23], v[156:159]
    ds_read_b64_tr_b16 a[12:13], v21 offset:0
    v_mfma_f32_16x16x32_bf16 v[192:195], a[28:31], a[20:23], v[192:195]
    ds_read_b64_tr_b16 a[14:15], v21 offset:4096
    s_waitcnt lgkmcnt(12)
    v_mfma_f32_16x16x32_bf16 v[160:163], a[24:27], a[0:3], v[160:163]
    ds_read_b64_tr_b16 a[16:17], v22 offset:0
    v_mfma_f32_16x16x32_bf16 v[196:199], a[28:31], a[0:3], v[196:199]
    ds_read_b64_tr_b16 a[18:19], v22 offset:4096
    s_add_u32 m0, s28, 0x8400
    s_nop 0
    buffer_load_dwordx4 v9, s[8:11], s23 offen lds
    s_add_u32 s23, s23, 122880
    v_mfma_f32_16x16x32_bf16 v[200:203], a[4:7], a[32:35], v[200:203]
    ds_read_b64_tr_b16 a[20:21], v23 offset:0
    ds_read_b64_tr_b16 a[22:23], v23 offset:4096
    s_waitcnt lgkmcnt(4)
    v_mfma_f32_16x16x32_bf16 v[204:207], a[32:35], a[8:11], v[204:207]
    ds_read_b64_tr_b16 a[0:1], v24 offset:0
    ds_read_b64_tr_b16 a[2:3], v24 offset:4096
    v_mfma_f32_16x16x32_bf16 v[128:131], a[12:15], a[36:39], v[128:131]
    ds_read_b64_tr_b16 a[4:5], v25 offset:0
    v_mfma_f32_16x16x32_bf16 v[164:167], a[12:15], a[40:43], v[164:167]
    ds_read_b64_tr_b16 a[6:7], v25 offset:4096
    s_waitcnt lgkmcnt(4)
    v_mfma_f32_16x16x32_bf16 v[132:135], a[16:19], a[36:39], v[132:135]
    ds_read_b64_tr_b16 a[8:9], v26 offset:0
    v_mfma_f32_16x16x32_bf16 v[168:171], a[16:19], a[40:43], v[168:171]
    ds_read_b64_tr_b16 a[10:11], v26 offset:4096
    v_mfma_f32_16x16x32_bf16 v[136:139], a[20:23], a[36:39], v[136:139]
    ds_read_b64_tr_b16 a[12:13], v27 offset:0
    v_mfma_f32_16x16x32_bf16 v[172:175], a[20:23], a[40:43], v[172:175]
    ds_read_b64_tr_b16 a[14:15], v27 offset:4096
    s_waitcnt lgkmcnt(4)
    v_mfma_f32_16x16x32_bf16 v[140:143], a[0:3], a[36:39], v[140:143]
    ds_read_b64_tr_b16 a[16:17], v28 offset:0
    v_mfma_f32_16x16x32_bf16 v[176:179], a[0:3], a[40:43], v[176:179]
    ds_read_b64_tr_b16 a[18:19], v28 offset:4096
    v_mfma_f32_16x16x32_bf16 v[144:147], a[4:7], a[36:39], v[144:147]
    ds_read_b64_tr_b16 a[20:21], v29 offset:0
    v_mfma_f32_16x16x32_bf16 v[180:183], a[4:7], a[40:43], v[180:183]
    ds_read_b64_tr_b16 a[22:23], v29 offset:4096
    s_waitcnt lgkmcnt(4)
    v_mfma_f32_16x16x32_bf16 v[148:151], a[8:11], a[36:39], v[148:151]
    ds_read_b64_tr_b16 a[0:1], v30 offset:0
    v_mfma_f32_16x16x32_bf16 v[184:187], a[8:11], a[40:43], v[184:187]
    ds_read_b64_tr_b16 a[2:3], v30 offset:4096
    v_mfma_f32_16x16x32_bf16 v[152:155], a[36:39], a[12:15], v[152:155]
    ds_read_b64_tr_b16 a[4:5], v31 offset:0
    v_mfma_f32_16x16x32_bf16 v[188:191], a[40:43], a[12:15], v[188:191]
    ds_read_b64_tr_b16 a[6:7], v31 offset:4096
    s_waitcnt vmcnt(4)
    s_barrier
    ds_read_b128 a[24:27], v32 offset:18560
    ds_read_b128 a[28:31], v32 offset:19584
    ds_read_b128 a[32:35], v33 offset:18560
    s_add_u32 m0, s28, 0xc000
    s_nop 0
    buffer_load_dwordx4 v8, s[8:11], s23 offen lds
    s_waitcnt lgkmcnt(7)
    v_mfma_f32_16x16x32_bf16 v[156:159], a[36:39], a[16:19], v[156:159]
    ds_read_b64_tr_b16 a[8:9], v10 offset:0
    v_mfma_f32_16x16x32_bf16 v[192:195], a[40:43], a[16:19], v[192:195]
    ds_read_b64_tr_b16 a[10:11], v10 offset:4096
    v_mfma_f32_16x16x32_bf16 v[160:163], a[36:39], a[20:23], v[160:163]
    ds_read_b64_tr_b16 a[12:13], v11 offset:0
    v_mfma_f32_16x16x32_bf16 v[196:199], a[40:43], a[20:23], v[196:199]
    ds_read_b64_tr_b16 a[14:15], v11 offset:4096
    s_add_u32 m0, s28, 0xc400
    s_nop 0
    buffer_load_dwordx4 v9, s[8:11], s23 offen lds
    s_add_u32 s23, s23, 122880
    s_waitcnt lgkmcnt(7)
    v_mfma_f32_16x16x32_bf16 v[200:203], a[0:3], a[44:47], v[200:203]
    ds_read_b64_tr_b16 a[16:17], v12 offset:0
    ds_read_b64_tr_b16 a[18:19], v12 offset:4096
    v_mfma_f32_16x16x32_bf16 v[204:207], a[44:47], a[4:7], v[204:207]
    ds_read_b64_tr_b16 a[20:21], v13 offset:0
    ds_read_b64_tr_b16 a[22:23], v13 offset:4096
    s_waitcnt lgkmcnt(4)
    v_mfma_f32_16x16x32_bf16 v[128:131], a[8:11], a[24:27], v[128:131]
    ds_read_b64_tr_b16 a[0:1], v14 offset:0
    v_mfma_f32_16x16x32_bf16 v[164:167], a[8:11], a[28:31], v[164:167]
    ds_read_b64_tr_b16 a[2:3], v14 offset:4096
    v_mfma_f32_16x16x32_bf16 v[132:135], a[12:15], a[24:27], v[132:135]
    ds_read_b64_tr_b16 a[4:5], v15 offset:0
    v_mfma_f32_16x16x32_bf16 v[168:171], a[12:15], a[28:31], v[168:171]
    ds_read_b64_tr_b16 a[6:7], v15 offset:4096
    s_waitcnt lgkmcnt(4)
    v_mfma_f32_16x16x32_bf16 v[136:139], a[16:19], a[24:27], v[136:139]
    ds_read_b64_tr_b16 a[8:9], v16 offset:0
    v_mfma_f32_16x16x32_bf16 v[172:175], a[16:19], a[28:31], v[172:175]
    ds_read_b64_tr_b16 a[10:11], v16 offset:4096
    v_mfma_f32_16x16x32_bf16 v[140:143], a[20:23], a[24:27], v[140:143]
    ds_read_b64_tr_b16 a[12:13], v17 offset:0
    v_mfma_f32_16x16x32_bf16 v[176:179], a[20:23], a[28:31], v[176:179]
    ds_read_b64_tr_b16 a[14:15], v17 offset:4096
    s_waitcnt lgkmcnt(4)
    v_mfma_f32_16x16x32_bf16 v[144:147], a[0:3], a[24:27], v[144:147]
    ds_read_b64_tr_b16 a[16:17], v18 offset:0
    v_mfma_f32_16x16x32_bf16 v[180:183], a[0:3], a[28:31], v[180:183]
    ds_read_b64_tr_b16 a[18:19], v18 offset:4096
    v_mfma_f32_16x16x32_bf16 v[148:151], a[4:7], a[24:27], v[148:151]
    ds_read_b64_tr_b16 a[20:21], v19 offset:0
    v_mfma_f32_16x16x32_bf16 v[184:187], a[4:7], a[28:31], v[184:187]
    ds_read_b64_tr_b16 a[22:23], v19 offset:4096
    s_waitcnt lgkmcnt(4)
    v_mfma_f32_16x16x32_bf16 v[152:155], a[24:27], a[8:11], v[152:155]
    ds_read_b64_tr_b16 a[0:1], v20 offset:0
    v_mfma_f32_16x16x32_bf16 v[188:191], a[28:31], a[8:11], v[188:191]
    ds_read_b64_tr_b16 a[2:3], v20 offset:4096
    s_waitcnt vmcnt(4)
    s_barrier
    ds_read_b128 a[36:39], v32 offset:27840
    ds_read_b128 a[40:43], v32 offset:28864
    ds_read_b128 a[44:47], v33 offset:27840
    s_add_u32 m0, s28, 0x10000
    s_nop 0
    buffer_load_dwordx4 v8, s[8:11], s23 offen lds
    v_mfma_f32_16x16x32_bf16 v[156:159], a[24:27], a[12:15], v[156:159]
    ds_read_b64_tr_b16 a[4:5], v10 offset:16384
    v_mfma_f32_16x16x32_bf16 v[192:195], a[28:31], a[12:15], v[192:195]
    ds_read_b64_tr_b16 a[6:7], v10 offset:20480
    s_waitcnt lgkmcnt(7)
    v_mfma_f32_16x16x32_bf16 v[160:163], a[24:27], a[16:19], v[160:163]
    ds_read_b64_tr_b16 a[8:9], v11 offset:16384
    v_mfma_f32_16x16x32_bf16 v[196:199], a[28:31], a[16:19], v[196:199]
    ds_read_b64_tr_b16 a[10:11], v11 offset:20480
    s_add_u32 m0, s28, 0x10400
    s_nop 0
    buffer_load_dwordx4 v9, s[8:11], s23 offen lds
    s_add_u32 s23, s23, 122880
    v_mfma_f32_16x16x32_bf16 v[200:203], a[20:23], a[32:35], v[200:203]
    ds_read_b64_tr_b16 a[12:13], v12 offset:16384
    ds_read_b64_tr_b16 a[14:15], v12 offset:20480
    s_waitcnt lgkmcnt(4)
    v_mfma_f32_16x16x32_bf16 v[204:207], a[32:35], a[0:3], v[204:207]
    ds_read_b64_tr_b16 a[16:17], v13 offset:16384
    ds_read_b64_tr_b16 a[18:19], v13 offset:20480
    v_mfma_f32_16x16x32_bf16 v[128:131], a[4:7], a[36:39], v[128:131]
    ds_read_b64_tr_b16 a[20:21], v14 offset:16384
    v_mfma_f32_16x16x32_bf16 v[164:167], a[4:7], a[40:43], v[164:167]
    ds_read_b64_tr_b16 a[22:23], v14 offset:20480
    s_waitcnt lgkmcnt(4)
    v_mfma_f32_16x16x32_bf16 v[132:135], a[8:11], a[36:39], v[132:135]
    ds_read_b64_tr_b16 a[0:1], v15 offset:16384
    v_mfma_f32_16x16x32_bf16 v[168:171], a[8:11], a[40:43], v[168:171]
    ds_read_b64_tr_b16 a[2:3], v15 offset:20480
    v_mfma_f32_16x16x32_bf16 v[136:139], a[12:15], a[36:39], v[136:139]
    ds_read_b64_tr_b16 a[4:5], v16 offset:16384
    v_mfma_f32_16x16x32_bf16 v[172:175], a[12:15], a[40:43], v[172:175]
    ds_read_b64_tr_b16 a[6:7], v16 offset:20480
    s_waitcnt lgkmcnt(4)
    v_mfma_f32_16x16x32_bf16 v[140:143], a[16:19], a[36:39], v[140:143]
    ds_read_b64_tr_b16 a[8:9], v17 offset:16384
    v_mfma_f32_16x16x32_bf16 v[176:179], a[16:19], a[40:43], v[176:179]
    ds_read_b64_tr_b16 a[10:11], v17 offset:20480
    v_mfma_f32_16x16x32_bf16 v[144:147], a[20:23], a[36:39], v[144:147]
    ds_read_b64_tr_b16 a[12:13], v18 offset:16384
    v_mfma_f32_16x16x32_bf16 v[180:183], a[20:23], a[40:43], v[180:183]
    ds_read_b64_tr_b16 a[14:15], v18 offset:20480
    s_waitcnt lgkmcnt(4)
    v_mfma_f32_16x16x32_bf16 v[148:151], a[0:3], a[36:39], v[148:151]
    ds_read_b64_tr_b16 a[16:17], v19 offset:16384
    v_mfma_f32_16x16x32_bf16 v[184:187], a[0:3], a[40:43], v[184:187]
    ds_read_b64_tr_b16 a[18:19], v19 offset:20480
    v_mfma_f32_16x16x32_bf16 v[152:155], a[36:39], a[4:7], v[152:155]
    ds_read_b64_tr_b16 a[20:21], v20 offset:16384
    v_mfma_f32_16x16x32_bf16 v[188:191], a[40:43], a[4:7], v[188:191]
    ds_read_b64_tr_b16 a[22:23], v20 offset:20480
    s_waitcnt vmcnt(4)
    s_barrier
    ds_read_b128 a[24:27], v35 offset:0
    ds_read_b128 a[28:31], v35 offset:1024
    ds_read_b128 a[32:35], v33 offset:37120
    s_add_u32 m0, s28, 0x0
    s_nop 0
    buffer_load_dwordx4 v8, s[8:11], s23 offen lds
    s_waitcnt lgkmcnt(7)
    v_mfma_f32_16x16x32_bf16 v[156:159], a[36:39], a[8:11], v[156:159]
    ds_read_b64_tr_b16 a[0:1], v10 offset:32768
    v_mfma_f32_16x16x32_bf16 v[192:195], a[40:43], a[8:11], v[192:195]
    ds_read_b64_tr_b16 a[2:3], v10 offset:36864
    v_mfma_f32_16x16x32_bf16 v[160:163], a[36:39], a[12:15], v[160:163]
    ds_read_b64_tr_b16 a[4:5], v11 offset:32768
    v_mfma_f32_16x16x32_bf16 v[196:199], a[40:43], a[12:15], v[196:199]
    ds_read_b64_tr_b16 a[6:7], v11 offset:36864
    s_add_u32 m0, s28, 0x400
    s_nop 0
    buffer_load_dwordx4 v9, s[8:11], s23 offen lds
    s_add_u32 s23, s23, 122880
    s_waitcnt lgkmcnt(7)
    v_mfma_f32_16x16x32_bf16 v[200:203], a[16:19], a[44:47], v[200:203]
    ds_read_b64_tr_b16 a[8:9], v12 offset:32768
    ds_read_b64_tr_b16 a[10:11], v12 offset:36864
    v_mfma_f32_16x16x32_bf16 v[204:207], a[44:47], a[20:23], v[204:207]
    ds_read_b64_tr_b16 a[12:13], v13 offset:32768
    ds_read_b64_tr_b16 a[14:15], v13 offset:36864
    s_waitcnt lgkmcnt(4)
    v_mfma_f32_16x16x32_bf16 v[128:131], a[0:3], a[24:27], v[128:131]
    ds_read_b64_tr_b16 a[16:17], v14 offset:32768
    v_mfma_f32_16x16x32_bf16 v[164:167], a[0:3], a[28:31], v[164:167]
    ds_read_b64_tr_b16 a[18:19], v14 offset:36864
    v_mfma_f32_16x16x32_bf16 v[132:135], a[4:7], a[24:27], v[132:135]
    ds_read_b64_tr_b16 a[20:21], v15 offset:32768
    v_mfma_f32_16x16x32_bf16 v[168:171], a[4:7], a[28:31], v[168:171]
    ds_read_b64_tr_b16 a[22:23], v15 offset:36864
    s_waitcnt lgkmcnt(4)
    v_mfma_f32_16x16x32_bf16 v[136:139], a[8:11], a[24:27], v[136:139]
    ds_read_b64_tr_b16 a[0:1], v16 offset:32768
    v_mfma_f32_16x16x32_bf16 v[172:175], a[8:11], a[28:31], v[172:175]
    ds_read_b64_tr_b16 a[2:3], v16 offset:36864
    v_mfma_f32_16x16x32_bf16 v[140:143], a[12:15], a[24:27], v[140:143]
    ds_read_b64_tr_b16 a[4:5], v17 offset:32768
    v_mfma_f32_16x16x32_bf16 v[176:179], a[12:15], a[28:31], v[176:179]
    ds_read_b64_tr_b16 a[6:7], v17 offset:36864
    s_waitcnt lgkmcnt(4)
    v_mfma_f32_16x16x32_bf16 v[144:147], a[16:19], a[24:27], v[144:147]
    ds_read_b64_tr_b16 a[8:9], v18 offset:32768
    v_mfma_f32_16x16x32_bf16 v[180:183], a[16:19], a[28:31], v[180:183]
    ds_read_b64_tr_b16 a[10:11], v18 offset:36864
    v_mfma_f32_16x16x32_bf16 v[148:151], a[20:23], a[24:27], v[148:151]
    ds_read_b64_tr_b16 a[12:13], v19 offset:32768
    v_mfma_f32_16x16x32_bf16 v[184:187], a[20:23], a[28:31], v[184:187]
    ds_read_b64_tr_b16 a[14:15], v19 offset:36864
    s_waitcnt lgkmcnt(4)
    v_mfma_f32_16x16x32_bf16 v[152:155], a[24:27], a[0:3], v[152:155]
    ds_read_b64_tr_b16 a[16:17], v20 offset:32768
    v_mfma_f32_16x16x32_bf16 v[188:191], a[28:31], a[0:3], v[188:191]
    ds_read_b64_tr_b16 a[18:19], v20 offset:36864
    s_waitcnt vmcnt(4)
    s_barrier
    ds_write_b128 v4, v[52:55] offset:0
    ds_write_b128 v5, v[72:75] offset:0
    ds_write_b128 v6, v[92:95] offset:0
    ds_write_b128 v7, v[112:115] offset:0
    s_mov_b32 exec_lo, 0xffff
    s_mov_b32 exec_hi, 0xffff
    ds_write_b128 v34, v[124:127] offset:0
    s_mov_b64 exec, -1
    ds_read_b128 a[36:39], v35 offset:9280
    ds_read_b128 a[40:43], v35 offset:10304
    ds_read_b128 a[44:47], v33 offset:46400
    s_add_u32 m0, s28, 0x4000
    s_nop 0
    buffer_load_dwordx4 v8, s[8:11], s23 offen lds
    v_mfma_f32_16x16x32_bf16 v[156:159], a[24:27], a[4:7], v[156:159]
    ds_read_b64_tr_b16 a[20:21], v10 offset:49152
    v_mfma_f32_16x16x32_bf16 v[192:195], a[28:31], a[4:7], v[192:195]
    ds_read_b64_tr_b16 a[22:23], v10 offset:53248
    s_waitcnt lgkmcnt(12)
    v_mfma_f32_16x16x32_bf16 v[160:163], a[24:27], a[8:11], v[160:163]
    ds_read_b64_tr_b16 a[0:1], v11 offset:49152
    v_mfma_f32_16x16x32_bf16 v[196:199], a[28:31], a[8:11], v[196:199]
    ds_read_b64_tr_b16 a[2:3], v11 offset:53248
    s_add_u32 m0, s28, 0x4400
    s_nop 0
    buffer_load_dwordx4 v9, s[8:11], s23 offen lds
    s_add_u32 s23, s23, 122880
    v_mfma_f32_16x16x32_bf16 v[200:203], a[12:15], a[32:35], v[200:203]
    ds_read_b64_tr_b16 a[4:5], v12 offset:49152
    ds_read_b64_tr_b16 a[6:7], v12 offset:53248
    s_waitcnt lgkmcnt(4)
    v_mfma_f32_16x16x32_bf16 v[204:207], a[32:35], a[16:19], v[204:207]
    ds_read_b64_tr_b16 a[8:9], v13 offset:49152
    ds_read_b64_tr_b16 a[10:11], v13 offset:53248
    v_mfma_f32_16x16x32_bf16 v[128:131], a[20:23], a[36:39], v[128:131]
    ds_read_b64_tr_b16 a[12:13], v14 offset:49152
    v_mfma_f32_16x16x32_bf16 v[164:167], a[20:23], a[40:43], v[164:167]
    ds_read_b64_tr_b16 a[14:15], v14 offset:53248
    s_waitcnt lgkmcnt(4)
    v_mfma_f32_16x16x32_bf16 v[132:135], a[0:3], a[36:39], v[132:135]
    ds_read_b64_tr_b16 a[16:17], v15 offset:49152
    v_mfma_f32_16x16x32_bf16 v[168:171], a[0:3], a[40:43], v[168:171]
    ds_read_b64_tr_b16 a[18:19], v15 offset:53248
    v_mfma_f32_16x16x32_bf16 v[136:139], a[4:7], a[36:39], v[136:139]
    ds_read_b64_tr_b16 a[20:21], v16 offset:49152
    v_mfma_f32_16x16x32_bf16 v[172:175], a[4:7], a[40:43], v[172:175]
    ds_read_b64_tr_b16 a[22:23], v16 offset:53248
    s_waitcnt lgkmcnt(4)
    v_mfma_f32_16x16x32_bf16 v[140:143], a[8:11], a[36:39], v[140:143]
    ds_read_b64_tr_b16 a[0:1], v17 offset:49152
    v_mfma_f32_16x16x32_bf16 v[176:179], a[8:11], a[40:43], v[176:179]
    ds_read_b64_tr_b16 a[2:3], v17 offset:53248
    v_mfma_f32_16x16x32_bf16 v[144:147], a[12:15], a[36:39], v[144:147]
    ds_read_b64_tr_b16 a[4:5], v18 offset:49152
    v_mfma_f32_16x16x32_bf16 v[180:183], a[12:15], a[40:43], v[180:183]
    ds_read_b64_tr_b16 a[6:7], v18 offset:53248
    s_waitcnt lgkmcnt(4)
    v_mfma_f32_16x16x32_bf16 v[148:151], a[16:19], a[36:39], v[148:151]
    ds_read_b64_tr_b16 a[8:9], v19 offset:49152
    v_mfma_f32_16x16x32_bf16 v[184:187], a[16:19], a[40:43], v[184:187]
    ds_read_b64_tr_b16 a[10:11], v19 offset:53248
    v_mfma_f32_16x16x32_bf16 v[152:155], a[36:39], a[20:23], v[152:155]
    ds_read_b64_tr_b16 a[12:13], v20 offset:49152
    v_mfma_f32_16x16x32_bf16 v[188:191], a[40:43], a[20:23], v[188:191]
    ds_read_b64_tr_b16 a[14:15], v20 offset:53248
    s_waitcnt vmcnt(4)
    s_barrier
    ds_read_b128 a[24:27], v35 offset:18560
    ds_read_b128 a[28:31], v35 offset:19584
    ds_read_b128 a[32:35], v33 offset:55680
    s_add_u32 m0, s28, 0x8000
    s_nop 0
    buffer_load_dwordx4 v8, s[8:11], s23 offen lds
    s_waitcnt lgkmcnt(7)
    v_mfma_f32_16x16x32_bf16 v[156:159], a[36:39], a[0:3], v[156:159]
    ds_read_b64_tr_b16 a[16:17], v21 offset:0
    v_mfma_f32_16x16x32_bf16 v[192:195], a[40:43], a[0:3], v[192:195]
    ds_read_b64_tr_b16 a[18:19], v21 offset:4096
    v_mfma_f32_16x16x32_bf16 v[160:163], a[36:39], a[4:7], v[160:163]
    ds_read_b64_tr_b16 a[20:21], v22 offset:0
    v_mfma_f32_16x16x32_bf16 v[196:199], a[40:43], a[4:7], v[196:199]
    ds_read_b64_tr_b16 a[22:23], v22 offset:4096
    s_add_u32 m0, s28, 0x8400
    s_nop 0
    buffer_load_dwordx4 v9, s[8:11], s23 offen lds
    s_add_u32 s23, s23, 122880
    s_waitcnt lgkmcnt(7)
    v_mfma_f32_16x16x32_bf16 v[200:203], a[8:11], a[44:47], v[200:203]
    ds_read_b64_tr_b16 a[0:1], v23 offset:0
    ds_read_b64_tr_b16 a[2:3], v23 offset:4096
    v_mfma_f32_16x16x32_bf16 v[204:207], a[44:47], a[12:15], v[204:207]
    ds_read_b64_tr_b16 a[4:5], v24 offset:0
    ds_read_b64_tr_b16 a[6:7], v24 offset:4096
    s_waitcnt lgkmcnt(4)
    v_mfma_f32_16x16x32_bf16 v[128:131], a[16:19], a[24:27], v[128:131]
    ds_read_b64_tr_b16 a[8:9], v25 offset:0
    v_mfma_f32_16x16x32_bf16 v[164:167], a[16:19], a[28:31], v[164:167]
    ds_read_b64_tr_b16 a[10:11], v25 offset:4096
    v_mfma_f32_16x16x32_bf16 v[132:135], a[20:23], a[24:27], v[132:135]
    ds_read_b64_tr_b16 a[12:13], v26 offset:0
    v_mfma_f32_16x16x32_bf16 v[168:171], a[20:23], a[28:31], v[168:171]
    ds_read_b64_tr_b16 a[14:15], v26 offset:4096
    s_waitcnt lgkmcnt(4)
    v_mfma_f32_16x16x32_bf16 v[136:139], a[0:3], a[24:27], v[136:139]
    ds_read_b64_tr_b16 a[16:17], v27 offset:0
    v_mfma_f32_16x16x32_bf16 v[172:175], a[0:3], a[28:31], v[172:175]
    ds_read_b64_tr_b16 a[18:19], v27 offset:4096
    v_mfma_f32_16x16x32_bf16 v[140:143], a[4:7], a[24:27], v[140:143]
    ds_read_b64_tr_b16 a[20:21], v28 offset:0
    v_mfma_f32_16x16x32_bf16 v[176:179], a[4:7], a[28:31], v[176:179]
    ds_read_b64_tr_b16 a[22:23], v28 offset:4096
    s_waitcnt lgkmcnt(4)
    v_mfma_f32_16x16x32_bf16 v[144:147], a[8:11], a[24:27], v[144:147]
    ds_read_b64_tr_b16 a[0:1], v29 offset:0
    v_mfma_f32_16x16x32_bf16 v[180:183], a[8:11], a[28:31], v[180:183]
    ds_read_b64_tr_b16 a[2:3], v29 offset:4096
    v_mfma_f32_16x16x32_bf16 v[148:151], a[12:15], a[24:27], v[148:151]
    ds_read_b64_tr_b16 a[4:5], v30 offset:0
    v_mfma_f32_16x16x32_bf16 v[184:187], a[12:15], a[28:31], v[184:187]
    ds_read_b64_tr_b16 a[6:7], v30 offset:4096
    s_waitcnt lgkmcnt(4)
    v_mfma_f32_16x16x32_bf16 v[152:155], a[24:27], a[16:19], v[152:155]
    ds_read_b64_tr_b16 a[8:9], v31 offset:0
    v_mfma_f32_16x16x32_bf16 v[188:191], a[28:31], a[16:19], v[188:191]
    ds_read_b64_tr_b16 a[10:11], v31 offset:4096
    s_waitcnt vmcnt(4)
    s_barrier
    ds_read_b128 a[36:39], v35 offset:27840
    ds_read_b128 a[40:43], v35 offset:28864
    ds_read_b128 a[44:47], v33 offset:64960
    s_add_u32 m0, s28, 0xc000
    s_nop 0
    buffer_load_dwordx4 v8, s[8:11], s23 offen lds
    v_mfma_f32_16x16x32_bf16 v[156:159], a[24:27], a[20:23], v[156:159]
    ds_read_b64_tr_b16 a[12:13], v10 offset:0
    v_mfma_f32_16x16x32_bf16 v[192:195], a[28:31], a[20:23], v[192:195]
    ds_read_b64_tr_b16 a[14:15], v10 offset:4096
    s_waitcnt lgkmcnt(7)
    v_mfma_f32_16x16x32_bf16 v[160:163], a[24:27], a[0:3], v[160:163]
    ds_read_b64_tr_b16 a[16:17], v11 offset:0
    v_mfma_f32_16x16x32_bf16 v[196:199], a[28:31], a[0:3], v[196:199]
    ds_read_b64_tr_b16 a[18:19], v11 offset:4096
    s_add_u32 m0, s28, 0xc400
    s_nop 0
    buffer_load_dwordx4 v9, s[8:11], s23 offen lds
    s_add_u32 s23, s23, 122880
    v_mfma_f32_16x16x32_bf16 v[200:203], a[4:7], a[32:35], v[200:203]
    ds_read_b64_tr_b16 a[20:21], v12 offset:0
    ds_read_b64_tr_b16 a[22:23], v12 offset:4096
    s_waitcnt lgkmcnt(4)
    v_mfma_f32_16x16x32_bf16 v[204:207], a[32:35], a[8:11], v[204:207]
    ds_read_b64_tr_b16 a[0:1], v13 offset:0
    ds_read_b64_tr_b16 a[2:3], v13 offset:4096
    v_mfma_f32_16x16x32_bf16 v[128:131], a[12:15], a[36:39], v[128:131]
    ds_read_b64_tr_b16 a[4:5], v14 offset:0
    v_mfma_f32_16x16x32_bf16 v[164:167], a[12:15], a[40:43], v[164:167]
    ds_read_b64_tr_b16 a[6:7], v14 offset:4096
    s_waitcnt lgkmcnt(4)
    v_mfma_f32_16x16x32_bf16 v[132:135], a[16:19], a[36:39], v[132:135]
    ds_read_b64_tr_b16 a[8:9], v15 offset:0
    v_mfma_f32_16x16x32_bf16 v[168:171], a[16:19], a[40:43], v[168:171]
    ds_read_b64_tr_b16 a[10:11], v15 offset:4096
    v_mfma_f32_16x16x32_bf16 v[136:139], a[20:23], a[36:39], v[136:139]
    ds_read_b64_tr_b16 a[12:13], v16 offset:0
    v_mfma_f32_16x16x32_bf16 v[172:175], a[20:23], a[40:43], v[172:175]
    ds_read_b64_tr_b16 a[14:15], v16 offset:4096
    s_waitcnt lgkmcnt(4)
    v_mfma_f32_16x16x32_bf16 v[140:143], a[0:3], a[36:39], v[140:143]
    ds_read_b64_tr_b16 a[16:17], v17 offset:0
    v_mfma_f32_16x16x32_bf16 v[176:179], a[0:3], a[40:43], v[176:179]
    ds_read_b64_tr_b16 a[18:19], v17 offset:4096
    v_mfma_f32_16x16x32_bf16 v[144:147], a[4:7], a[36:39], v[144:147]
    ds_read_b64_tr_b16 a[20:21], v18 offset:0
    v_mfma_f32_16x16x32_bf16 v[180:183], a[4:7], a[40:43], v[180:183]
    ds_read_b64_tr_b16 a[22:23], v18 offset:4096
    s_waitcnt lgkmcnt(4)
    v_mfma_f32_16x16x32_bf16 v[148:151], a[8:11], a[36:39], v[148:151]
    ds_read_b64_tr_b16 a[0:1], v19 offset:0
    v_mfma_f32_16x16x32_bf16 v[184:187], a[8:11], a[40:43], v[184:187]
    ds_read_b64_tr_b16 a[2:3], v19 offset:4096
    v_mfma_f32_16x16x32_bf16 v[152:155], a[36:39], a[12:15], v[152:155]
    ds_read_b64_tr_b16 a[4:5], v20 offset:0
    v_mfma_f32_16x16x32_bf16 v[188:191], a[40:43], a[12:15], v[188:191]
    ds_read_b64_tr_b16 a[6:7], v20 offset:4096
    s_waitcnt vmcnt(4)
    s_barrier
    ds_read_b128 a[24:27], v32 offset:0
    ds_read_b128 a[28:31], v32 offset:1024
    ds_read_b128 a[32:35], v33 offset:0
    s_add_u32 m0, s28, 0x10000
    s_nop 0
    buffer_load_dwordx4 v8, s[8:11], s23 offen lds
    s_waitcnt lgkmcnt(7)
    v_mfma_f32_16x16x32_bf16 v[156:159], a[36:39], a[16:19], v[156:159]
    ds_read_b64_tr_b16 a[8:9], v10 offset:16384
    v_mfma_f32_16x16x32_bf16 v[192:195], a[40:43], a[16:19], v[192:195]
    ds_read_b64_tr_b16 a[10:11], v10 offset:20480
    v_mfma_f32_16x16x32_bf16 v[160:163], a[36:39], a[20:23], v[160:163]
    ds_read_b64_tr_b16 a[12:13], v11 offset:16384
    v_mfma_f32_16x16x32_bf16 v[196:199], a[40:43], a[20:23], v[196:199]
    ds_read_b64_tr_b16 a[14:15], v11 offset:20480
    s_add_u32 m0, s28, 0x10400
    s_nop 0
    buffer_load_dwordx4 v9, s[8:11], s23 offen lds
    s_add_u32 s23, s23, 122880
    s_waitcnt lgkmcnt(7)
    v_mfma_f32_16x16x32_bf16 v[200:203], a[0:3], a[44:47], v[200:203]
    ds_read_b64_tr_b16 a[16:17], v12 offset:16384
    ds_read_b64_tr_b16 a[18:19], v12 offset:20480
    v_mfma_f32_16x16x32_bf16 v[204:207], a[44:47], a[4:7], v[204:207]
    ds_read_b64_tr_b16 a[20:21], v13 offset:16384
    ds_read_b64_tr_b16 a[22:23], v13 offset:20480
    s_waitcnt lgkmcnt(4)
    v_mfma_f32_16x16x32_bf16 v[128:131], a[8:11], a[24:27], v[128:131]
    ds_read_b64_tr_b16 a[0:1], v14 offset:16384
    v_mfma_f32_16x16x32_bf16 v[164:167], a[8:11], a[28:31], v[164:167]
    ds_read_b64_tr_b16 a[2:3], v14 offset:20480
    v_mfma_f32_16x16x32_bf16 v[132:135], a[12:15], a[24:27], v[132:135]
    ds_read_b64_tr_b16 a[4:5], v15 offset:16384
    v_mfma_f32_16x16x32_bf16 v[168:171], a[12:15], a[28:31], v[168:171]
    ds_read_b64_tr_b16 a[6:7], v15 offset:20480
    s_waitcnt lgkmcnt(4)
    v_mfma_f32_16x16x32_bf16 v[136:139], a[16:19], a[24:27], v[136:139]
    ds_read_b64_tr_b16 a[8:9], v16 offset:16384
    v_mfma_f32_16x16x32_bf16 v[172:175], a[16:19], a[28:31], v[172:175]
    ds_read_b64_tr_b16 a[10:11], v16 offset:20480
    v_mfma_f32_16x16x32_bf16 v[140:143], a[20:23], a[24:27], v[140:143]
    ds_read_b64_tr_b16 a[12:13], v17 offset:16384
    v_mfma_f32_16x16x32_bf16 v[176:179], a[20:23], a[28:31], v[176:179]
    ds_read_b64_tr_b16 a[14:15], v17 offset:20480
    s_waitcnt lgkmcnt(4)
    v_mfma_f32_16x16x32_bf16 v[144:147], a[0:3], a[24:27], v[144:147]
    ds_read_b64_tr_b16 a[16:17], v18 offset:16384
    v_mfma_f32_16x16x32_bf16 v[180:183], a[0:3], a[28:31], v[180:183]
    ds_read_b64_tr_b16 a[18:19], v18 offset:20480
    v_mfma_f32_16x16x32_bf16 v[148:151], a[4:7], a[24:27], v[148:151]
    ds_read_b64_tr_b16 a[20:21], v19 offset:16384
    v_mfma_f32_16x16x32_bf16 v[184:187], a[4:7], a[28:31], v[184:187]
    ds_read_b64_tr_b16 a[22:23], v19 offset:20480
    s_waitcnt lgkmcnt(4)
    v_mfma_f32_16x16x32_bf16 v[152:155], a[24:27], a[8:11], v[152:155]
    ds_read_b64_tr_b16 a[0:1], v20 offset:16384
    v_mfma_f32_16x16x32_bf16 v[188:191], a[28:31], a[8:11], v[188:191]
    ds_read_b64_tr_b16 a[2:3], v20 offset:20480
    s_waitcnt vmcnt(4)
    s_barrier
    ds_read_b128 a[36:39], v32 offset:9280
    ds_read_b128 a[40:43], v32 offset:10304
    ds_read_b128 a[44:47], v33 offset:9280
    v_mfma_f32_16x16x32_bf16 v[156:159], a[24:27], a[12:15], v[156:159]
    ds_read_b64_tr_b16 a[4:5], v10 offset:32768
    v_mfma_f32_16x16x32_bf16 v[192:195], a[28:31], a[12:15], v[192:195]
    ds_read_b64_tr_b16 a[6:7], v10 offset:36864
    s_waitcnt lgkmcnt(7)
    v_mfma_f32_16x16x32_bf16 v[160:163], a[24:27], a[16:19], v[160:163]
    ds_read_b64_tr_b16 a[8:9], v11 offset:32768
    v_mfma_f32_16x16x32_bf16 v[196:199], a[28:31], a[16:19], v[196:199]
    ds_read_b64_tr_b16 a[10:11], v11 offset:36864
    v_mfma_f32_16x16x32_bf16 v[200:203], a[20:23], a[32:35], v[200:203]
    ds_read_b64_tr_b16 a[12:13], v12 offset:32768
    ds_read_b64_tr_b16 a[14:15], v12 offset:36864
    s_waitcnt lgkmcnt(4)
    v_mfma_f32_16x16x32_bf16 v[204:207], a[32:35], a[0:3], v[204:207]
    ds_read_b64_tr_b16 a[16:17], v13 offset:32768
    ds_read_b64_tr_b16 a[18:19], v13 offset:36864
    v_mfma_f32_16x16x32_bf16 v[128:131], a[4:7], a[36:39], v[128:131]
    ds_read_b64_tr_b16 a[20:21], v14 offset:32768
    v_mfma_f32_16x16x32_bf16 v[164:167], a[4:7], a[40:43], v[164:167]
    ds_read_b64_tr_b16 a[22:23], v14 offset:36864
    s_waitcnt lgkmcnt(4)
    v_mfma_f32_16x16x32_bf16 v[132:135], a[8:11], a[36:39], v[132:135]
    ds_read_b64_tr_b16 a[0:1], v15 offset:32768
    v_mfma_f32_16x16x32_bf16 v[168:171], a[8:11], a[40:43], v[168:171]
    ds_read_b64_tr_b16 a[2:3], v15 offset:36864
    v_mfma_f32_16x16x32_bf16 v[136:139], a[12:15], a[36:39], v[136:139]
    ds_read_b64_tr_b16 a[4:5], v16 offset:32768
    v_mfma_f32_16x16x32_bf16 v[172:175], a[12:15], a[40:43], v[172:175]
    ds_read_b64_tr_b16 a[6:7], v16 offset:36864
    s_waitcnt lgkmcnt(4)
    v_mfma_f32_16x16x32_bf16 v[140:143], a[16:19], a[36:39], v[140:143]
    ds_read_b64_tr_b16 a[8:9], v17 offset:32768
    v_mfma_f32_16x16x32_bf16 v[176:179], a[16:19], a[40:43], v[176:179]
    ds_read_b64_tr_b16 a[10:11], v17 offset:36864
    v_mfma_f32_16x16x32_bf16 v[144:147], a[20:23], a[36:39], v[144:147]
    ds_read_b64_tr_b16 a[12:13], v18 offset:32768
    v_mfma_f32_16x16x32_bf16 v[180:183], a[20:23], a[40:43], v[180:183]
    ds_read_b64_tr_b16 a[14:15], v18 offset:36864
    s_waitcnt lgkmcnt(4)
    v_mfma_f32_16x16x32_bf16 v[148:151], a[0:3], a[36:39], v[148:151]
    ds_read_b64_tr_b16 a[16:17], v19 offset:32768
    v_mfma_f32_16x16x32_bf16 v[184:187], a[0:3], a[40:43], v[184:187]
    ds_read_b64_tr_b16 a[18:19], v19 offset:36864
    v_mfma_f32_16x16x32_bf16 v[152:155], a[36:39], a[4:7], v[152:155]
    ds_read_b64_tr_b16 a[20:21], v20 offset:32768
    v_mfma_f32_16x16x32_bf16 v[188:191], a[40:43], a[4:7], v[188:191]
    ds_read_b64_tr_b16 a[22:23], v20 offset:36864
    s_waitcnt vmcnt(2)
    s_barrier
    ds_read_b128 a[24:27], v32 offset:18560
    ds_read_b128 a[28:31], v32 offset:19584
    ds_read_b128 a[32:35], v33 offset:18560
    s_waitcnt lgkmcnt(7)
    v_mfma_f32_16x16x32_bf16 v[156:159], a[36:39], a[8:11], v[156:159]
    ds_read_b64_tr_b16 a[0:1], v10 offset:49152
    v_mfma_f32_16x16x32_bf16 v[192:195], a[40:43], a[8:11], v[192:195]
    ds_read_b64_tr_b16 a[2:3], v10 offset:53248
    v_mfma_f32_16x16x32_bf16 v[160:163], a[36:39], a[12:15], v[160:163]
    ds_read_b64_tr_b16 a[4:5], v11 offset:49152
    v_mfma_f32_16x16x32_bf16 v[196:199], a[40:43], a[12:15], v[196:199]
    ds_read_b64_tr_b16 a[6:7], v11 offset:53248
    s_waitcnt lgkmcnt(7)
    v_mfma_f32_16x16x32_bf16 v[200:203], a[16:19], a[44:47], v[200:203]
    ds_read_b64_tr_b16 a[8:9], v12 offset:49152
    ds_read_b64_tr_b16 a[10:11], v12 offset:53248
    v_mfma_f32_16x16x32_bf16 v[204:207], a[44:47], a[20:23], v[204:207]
    ds_read_b64_tr_b16 a[12:13], v13 offset:49152
    ds_read_b64_tr_b16 a[14:15], v13 offset:53248
    s_waitcnt lgkmcnt(4)
    v_mfma_f32_16x16x32_bf16 v[128:131], a[0:3], a[24:27], v[128:131]
    ds_read_b64_tr_b16 a[16:17], v14 offset:49152
    v_mfma_f32_16x16x32_bf16 v[164:167], a[0:3], a[28:31], v[164:167]
    ds_read_b64_tr_b16 a[18:19], v14 offset:53248
    v_mfma_f32_16x16x32_bf16 v[132:135], a[4:7], a[24:27], v[132:135]
    ds_read_b64_tr_b16 a[20:21], v15 offset:49152
    v_mfma_f32_16x16x32_bf16 v[168:171], a[4:7], a[28:31], v[168:171]
    ds_read_b64_tr_b16 a[22:23], v15 offset:53248
    s_waitcnt lgkmcnt(4)
    v_mfma_f32_16x16x32_bf16 v[136:139], a[8:11], a[24:27], v[136:139]
    ds_read_b64_tr_b16 a[0:1], v16 offset:49152
    v_mfma_f32_16x16x32_bf16 v[172:175], a[8:11], a[28:31], v[172:175]
    ds_read_b64_tr_b16 a[2:3], v16 offset:53248
    v_mfma_f32_16x16x32_bf16 v[140:143], a[12:15], a[24:27], v[140:143]
    ds_read_b64_tr_b16 a[4:5], v17 offset:49152
    v_mfma_f32_16x16x32_bf16 v[176:179], a[12:15], a[28:31], v[176:179]
    ds_read_b64_tr_b16 a[6:7], v17 offset:53248
    s_waitcnt lgkmcnt(4)
    v_mfma_f32_16x16x32_bf16 v[144:147], a[16:19], a[24:27], v[144:147]
    ds_read_b64_tr_b16 a[8:9], v18 offset:49152
    v_mfma_f32_16x16x32_bf16 v[180:183], a[16:19], a[28:31], v[180:183]
    ds_read_b64_tr_b16 a[10:11], v18 offset:53248
    v_mfma_f32_16x16x32_bf16 v[148:151], a[20:23], a[24:27], v[148:151]
    ds_read_b64_tr_b16 a[12:13], v19 offset:49152
    v_mfma_f32_16x16x32_bf16 v[184:187], a[20:23], a[28:31], v[184:187]
    ds_read_b64_tr_b16 a[14:15], v19 offset:53248
    s_waitcnt lgkmcnt(4)
    v_mfma_f32_16x16x32_bf16 v[152:155], a[24:27], a[0:3], v[152:155]
    ds_read_b64_tr_b16 a[16:17], v20 offset:49152
    v_mfma_f32_16x16x32_bf16 v[188:191], a[28:31], a[0:3], v[188:191]
    ds_read_b64_tr_b16 a[18:19], v20 offset:53248
    s_waitcnt vmcnt(0)
    s_barrier
    ds_read_b128 a[36:39], v32 offset:27840
    ds_read_b128 a[40:43], v32 offset:28864
    ds_read_b128 a[44:47], v33 offset:27840
    v_mfma_f32_16x16x32_bf16 v[156:159], a[24:27], a[4:7], v[156:159]
    ds_read_b64_tr_b16 a[20:21], v21 offset:0
    v_mfma_f32_16x16x32_bf16 v[192:195], a[28:31], a[4:7], v[192:195]
    ds_read_b64_tr_b16 a[22:23], v21 offset:4096
    s_waitcnt lgkmcnt(7)
    v_mfma_f32_16x16x32_bf16 v[160:163], a[24:27], a[8:11], v[160:163]
    ds_read_b64_tr_b16 a[0:1], v22 offset:0
    v_mfma_f32_16x16x32_bf16 v[196:199], a[28:31], a[8:11], v[196:199]
    ds_read_b64_tr_b16 a[2:3], v22 offset:4096
    v_mfma_f32_16x16x32_bf16 v[200:203], a[12:15], a[32:35], v[200:203]
    ds_read_b64_tr_b16 a[4:5], v23 offset:0
    ds_read_b64_tr_b16 a[6:7], v23 offset:4096
    s_waitcnt lgkmcnt(4)
    v_mfma_f32_16x16x32_bf16 v[204:207], a[32:35], a[16:19], v[204:207]
    ds_read_b64_tr_b16 a[8:9], v24 offset:0
    ds_read_b64_tr_b16 a[10:11], v24 offset:4096
    v_mfma_f32_16x16x32_bf16 v[128:131], a[20:23], a[36:39], v[128:131]
    ds_read_b64_tr_b16 a[12:13], v25 offset:0
    v_mfma_f32_16x16x32_bf16 v[164:167], a[20:23], a[40:43], v[164:167]
    ds_read_b64_tr_b16 a[14:15], v25 offset:4096
    s_waitcnt lgkmcnt(4)
    v_mfma_f32_16x16x32_bf16 v[132:135], a[0:3], a[36:39], v[132:135]
    ds_read_b64_tr_b16 a[16:17], v26 offset:0
    v_mfma_f32_16x16x32_bf16 v[168:171], a[0:3], a[40:43], v[168:171]
    ds_read_b64_tr_b16 a[18:19], v26 offset:4096
    v_mfma_f32_16x16x32_bf16 v[136:139], a[4:7], a[36:39], v[136:139]
    ds_read_b64_tr_b16 a[20:21], v27 offset:0
    v_mfma_f32_16x16x32_bf16 v[172:175], a[4:7], a[40:43], v[172:175]
    ds_read_b64_tr_b16 a[22:23], v27 offset:4096
    s_waitcnt lgkmcnt(4)
    v_mfma_f32_16x16x32_bf16 v[140:143], a[8:11], a[36:39], v[140:143]
    ds_read_b64_tr_b16 a[0:1], v28 offset:0
    v_mfma_f32_16x16x32_bf16 v[176:179], a[8:11], a[40:43], v[176:179]
    ds_read_b64_tr_b16 a[2:3], v28 offset:4096
    v_mfma_f32_16x16x32_bf16 v[144:147], a[12:15], a[36:39], v[144:147]
    ds_read_b64_tr_b16 a[4:5], v29 offset:0
    v_mfma_f32_16x16x32_bf16 v[180:183], a[12:15], a[40:43], v[180:183]
    ds_read_b64_tr_b16 a[6:7], v29 offset:4096
    s_waitcnt lgkmcnt(4)
    v_mfma_f32_16x16x32_bf16 v[148:151], a[16:19], a[36:39], v[148:151]
    ds_read_b64_tr_b16 a[8:9], v30 offset:0
    v_mfma_f32_16x16x32_bf16 v[184:187], a[16:19], a[40:43], v[184:187]
    ds_read_b64_tr_b16 a[10:11], v30 offset:4096
    v_mfma_f32_16x16x32_bf16 v[152:155], a[36:39], a[20:23], v[152:155]
    ds_read_b64_tr_b16 a[12:13], v31 offset:0
    v_mfma_f32_16x16x32_bf16 v[188:191], a[40:43], a[20:23], v[188:191]
    ds_read_b64_tr_b16 a[14:15], v31 offset:4096
    s_waitcnt lgkmcnt(4)
    v_mfma_f32_16x16x32_bf16 v[156:159], a[36:39], a[0:3], v[156:159]
    v_mfma_f32_16x16x32_bf16 v[192:195], a[40:43], a[0:3], v[192:195]
    v_mfma_f32_16x16x32_bf16 v[160:163], a[36:39], a[4:7], v[160:163]
    v_mfma_f32_16x16x32_bf16 v[196:199], a[40:43], a[4:7], v[196:199]
    s_waitcnt lgkmcnt(0)
    v_mfma_f32_16x16x32_bf16 v[200:203], a[8:11], a[44:47], v[200:203]
    v_mfma_f32_16x16x32_bf16 v[204:207], a[44:47], a[12:15], v[204:207]
    s_branch L_k1_Q_done
L_k1_Q_ph1:
    s_waitcnt vmcnt(6)
    s_barrier
    ds_read_b128 a[24:27], v32 offset:0
    ds_read_b128 a[28:31], v32 offset:1024
    ds_read_b128 a[32:35], v33 offset:0
    ds_read_b64_tr_b16 a[0:1], v10 offset:0
    ds_read_b64_tr_b16 a[2:3], v10 offset:4096
    ds_read_b64_tr_b16 a[4:5], v11 offset:0
    ds_read_b64_tr_b16 a[6:7], v11 offset:4096
    ds_read_b64_tr_b16 a[8:9], v12 offset:0
    ds_read_b64_tr_b16 a[10:11], v12 offset:4096
    ds_read_b64_tr_b16 a[12:13], v13 offset:0
    ds_read_b64_tr_b16 a[14:15], v13 offset:4096
    s_waitcnt lgkmcnt(4)
    v_mfma_f32_16x16x32_bf16 v[128:131], a[0:3], a[24:27], 0
    ds_read_b64_tr_b16 a[16:17], v14 offset:0
    v_mfma_f32_16x16x32_bf16 v[164:167], a[0:3], a[28:31], 0
    ds_read_b64_tr_b16 a[18:19], v14 offset:4096
    v_mfma_f32_16x16x32_bf16 v[132:135], a[4:7], a[24:27], 0
    ds_read_b64_tr_b16 a[20:21], v15 offset:0
    v_mfma_f32_16x16x32_bf16 v[168:171], a[4:7], a[28:31], 0
    ds_read_b64_tr_b16 a[22:23], v15 offset:4096
    s_waitcnt lgkmcnt(4)
    v_mfma_f32_16x16x32_bf16 v[136:139], a[8:11], a[24:27], 0
    ds_read_b64_tr_b16 a[0:1], v16 offset:0
    v_mfma_f32_16x16x32_bf16 v[172:175], a[8:11], a[28:31], 0
    ds_read_b64_tr_b16 a[2:3], v16 offset:4096
    v_mfma_f32_16x16x32_bf16 v[140:143], a[12:15], a[24:27], 0
    ds_read_b64_tr_b16 a[4:5], v17 offset:0
    v_mfma_f32_16x16x32_bf16 v[176:179], a[12:15], a[28:31], 0
    ds_read_b64_tr_b16 a[6:7], v17 offset:4096
    s_waitcnt lgkmcnt(4)
    v_mfma_f32_16x16x32_bf16 v[144:147], a[16:19], a[24:27], 0
    ds_read_b64_tr_b16 a[8:9], v18 offset:0
    v_mfma_f32_16x16x32_bf16 v[180:183], a[16:19], a[28:31], 0
    ds_read_b64_tr_b16 a[10:11], v18 offset:4096
    v_mfma_f32_16x16x32_bf16 v[148:151], a[20:23], a[24:27], 0
    ds_read_b64_tr_b16 a[12:13], v19 offset:0
    v_mfma_f32_16x16x32_bf16 v[184:187], a[20:23], a[28:31], 0
    ds_read_b64_tr_b16 a[14:15], v19 offset:4096
    s_waitcnt lgkmcnt(4)
    v_mfma_f32_16x16x32_bf16 v[152:155], a[24:27], a[0:3], 0
    ds_read_b64_tr_b16 a[16:17], v20 offset:0
    v_mfma_f32_16x16x32_bf16 v[188:191], a[28:31], a[0:3], 0
    ds_read_b64_tr_b16 a[18:19], v20 offset:4096
    s_waitcnt vmcnt(4)
    s_barrier
    ds_write_b128 v4, v[40:43] offset:37120
    ds_write_b128 v5, v[60:63] offset:37120
    ds_write_b128 v6, v[80:83] offset:37120
    ds_write_b128 v7, v[100:103] offset:37120
    s_mov_b32 exec_lo, 0xffff0000
    s_mov_b32 exec_hi, 0xffff0000
    ds_write_b128 v34, v[116:119] offset:37120
    s_mov_b64 exec, -1
    ds_read_b128 a[36:39], v32 offset:9280
    ds_read_b128 a[40:43], v32 offset:10304
    ds_read_b128 a[44:47], v33 offset:9280
    v_mfma_f32_16x16x32_bf16 v[156:159], a[24:27], a[4:7], 0
    ds_read_b64_tr_b16 a[20:21], v10 offset:16384
    v_mfma_f32_16x16x32_bf16 v[192:195], a[28:31], a[4:7], 0
    ds_read_b64_tr_b16 a[22:23], v10 offset:20480
    s_waitcnt lgkmcnt(12)
    v_mfma_f32_16x16x32_bf16 v[160:163], a[24:27], a[8:11], 0
    ds_read_b64_tr_b16 a[0:1], v11 offset:16384
    v_mfma_f32_16x16x32_bf16 v[196:199], a[28:31], a[8:11], 0
    ds_read_b64_tr_b16 a[2:3], v11 offset:20480
    v_mfma_f32_16x16x32_bf16 v[200:203], a[12:15], a[32:35], 0
    ds_read_b64_tr_b16 a[4:5], v12 offset:16384
    ds_read_b64_tr_b16 a[6:7], v12 offset:20480
    s_waitcnt lgkmcnt(4)
    v_mfma_f32_16x16x32_bf16 v[204:207], a[32:35], a[16:19], 0
    ds_read_b64_tr_b16 a[8:9], v13 offset:16384
    ds_read_b64_tr_b16 a[10:11], v13 offset:20480
    v_mfma_f32_16x16x32_bf16 v[128:131], a[20:23], a[36:39], v[128:131]
    ds_read_b64_tr_b16 a[12:13], v14 offset:16384
    v_mfma_f32_16x16x32_bf16 v[164:167], a[20:23], a[40:43], v[164:167]
    ds_read_b64_tr_b16 a[14:15], v14 offset:20480
    s_add_u32 m0, s28, 0x10000
    s_nop 0
    buffer_load_dwordx4 v8, s[8:11], s23 offen lds
    s_waitcnt lgkmcnt(4)
    v_mfma_f32_16x16x32_bf16 v[132:135], a[0:3], a[36:39], v[132:135]
    ds_read_b64_tr_b16 a[16:17], v15 offset:16384
    v_mfma_f32_16x16x32_bf16 v[168:171], a[0:3], a[40:43], v[168:171]
    ds_read_b64_tr_b16 a[18:19], v15 offset:20480
    v_mfma_f32_16x16x32_bf16 v[136:139], a[4:7], a[36:39], v[136:139]
    ds_read_b64_tr_b16 a[20:21], v16 offset:16384
    v_mfma_f32_16x16x32_bf16 v[172:175], a[4:7], a[40:43], v[172:175]
    ds_read_b64_tr_b16 a[22:23], v16 offset:20480
    s_add_u32 m0, s28, 0x10400
    s_nop 0
    buffer_load_dwordx4 v9, s[8:11], s23 offen lds
    s_add_u32 s23, s23, 122880
    s_waitcnt lgkmcnt(4)
    v_mfma_f32_16x16x32_bf16 v[140:143], a[8:11], a[36:39], v[140:143]
    ds_read_b64_tr_b16 a[0:1], v17 offset:16384
    v_mfma_f32_16x16x32_bf16 v[176:179], a[8:11], a[40:43], v[176:179]
    ds_read_b64_tr_b16 a[2:3], v17 offset:20480
    v_mfma_f32_16x16x32_bf16 v[144:147], a[12:15], a[36:39], v[144:147]
    ds_read_b64_tr_b16 a[4:5], v18 offset:16384
    v_mfma_f32_16x16x32_bf16 v[180:183], a[12:15], a[40:43], v[180:183]
    ds_read_b64_tr_b16 a[6:7], v18 offset:20480
    s_waitcnt lgkmcnt(4)
    v_mfma_f32_16x16x32_bf16 v[148:151], a[16:19], a[36:39], v[148:151]
    ds_read_b64_tr_b16 a[8:9], v19 offset:16384
    v_mfma_f32_16x16x32_bf16 v[184:187], a[16:19], a[40:43], v[184:187]
    ds_read_b64_tr_b16 a[10:11], v19 offset:20480
    v_mfma_f32_16x16x32_bf16 v[152:155], a[36:39], a[20:23], v[152:155]
    ds_read_b64_tr_b16 a[12:13], v20 offset:16384
    v_mfma_f32_16x16x32_bf16 v[188:191], a[40:43], a[20:23], v[188:191]
    ds_read_b64_tr_b16 a[14:15], v20 offset:20480
    s_waitcnt vmcnt(4)
    s_barrier
    ds_read_b128 a[24:27], v32 offset:18560
    ds_read_b128 a[28:31], v32 offset:19584
    ds_read_b128 a[32:35], v33 offset:18560
    s_waitcnt lgkmcnt(7)
    v_mfma_f32_16x16x32_bf16 v[156:159], a[36:39], a[0:3], v[156:159]
    ds_read_b64_tr_b16 a[16:17], v10 offset:32768
    v_mfma_f32_16x16x32_bf16 v[192:195], a[40:43], a[0:3], v[192:195]
    ds_read_b64_tr_b16 a[18:19], v10 offset:36864
    v_mfma_f32_16x16x32_bf16 v[160:163], a[36:39], a[4:7], v[160:163]
    ds_read_b64_tr_b16 a[20:21], v11 offset:32768
    v_mfma_f32_16x16x32_bf16 v[196:199], a[40:43], a[4:7], v[196:199]
    ds_read_b64_tr_b16 a[22:23], v11 offset:36864
    s_waitcnt lgkmcnt(7)
    v_mfma_f32_16x16x32_bf16 v[200:203], a[8:11], a[44:47], v[200:203]
    ds_read_b64_tr_b16 a[0:1], v12 offset:32768
    ds_read_b64_tr_b16 a[2:3], v12 offset:36864
    v_mfma_f32_16x16x32_bf16 v[204:207], a[44:47], a[12:15], v[204:207]
    ds_read_b64_tr_b16 a[4:5], v13 offset:32768
    ds_read_b64_tr_b16 a[6:7], v13 offset:36864
    s_waitcnt lgkmcnt(4)
    v_mfma_f32_16x16x32_bf16 v[128:131], a[16:19], a[24:27], v[128:131]
    ds_read_b64_tr_b16 a[8:9], v14 offset:32768
    v_mfma_f32_16x16x32_bf16 v[164:167], a[16:19], a[28:31], v[164:167]
    ds_read_b64_tr_b16 a[10:11], v14 offset:36864
    s_add_u32 m0, s28, 0x0
    s_nop 0
    buffer_load_dwordx4 v8, s[8:11], s23 offen lds
    v_mfma_f32_16x16x32_bf16 v[132:135], a[20:23], a[24:27], v[132:135]
    ds_read_b64_tr_b16 a[12:13], v15 offset:32768
    v_mfma_f32_16x16x32_bf16 v[168:171], a[20:23], a[28:31], v[168:171]
    ds_read_b64_tr_b16 a[14:15], v15 offset:36864
    s_waitcnt lgkmcnt(4)
    v_mfma_f32_16x16x32_bf16 v[136:139], a[0:3], a[24:27], v[136:139]
    ds_read_b64_tr_b16 a[16:17], v16 offset:32768
    v_mfma_f32_16x16x32_bf16 v[172:175], a[0:3], a[28:31], v[172:175]
    ds_read_b64_tr_b16 a[18:19], v16 offset:36864
    s_add_u32 m0, s28, 0x400
    s_nop 0
    buffer_load_dwordx4 v9, s[8:11], s23 offen lds
    s_add_u32 s23, s23, 122880
    v_mfma_f32_16x16x32_bf16 v[140:143], a[4:7], a[24:27], v[140:143]
    ds_read_b64_tr_b16 a[20:21], v17 offset:32768
    v_mfma_f32_16x16x32_bf16 v[176:179], a[4:7], a[28:31], v[176:179]
    ds_read_b64_tr_b16 a[22:23], v17 offset:36864
    s_waitcnt lgkmcnt(4)
    v_mfma_f32_16x16x32_bf16 v[144:147], a[8:11], a[24:27], v[144:147]
    ds_read_b64_tr_b16 a[0:1], v18 offset:32768
    v_mfma_f32_16x16x32_bf16 v[180:183], a[8:11], a[28:31], v[180:183]
    ds_read_b64_tr_b16 a[2:3], v18 offset:36864
    v_mfma_f32_16x16x32_bf16 v[148:151], a[12:15], a[24:27], v[148:151]
    ds_read_b64_tr_b16 a[4:5], v19 offset:32768
    v_mfma_f32_16x16x32_bf16 v[184:187], a[12:15], a[28:31], v[184:187]
    ds_read_b64_tr_b16 a[6:7], v19 offset:36864
    s_waitcnt lgkmcnt(4)
    v_mfma_f32_16x16x32_bf16 v[152:155], a[24:27], a[16:19], v[152:155]
    ds_read_b64_tr_b16 a[8:9], v20 offset:32768
    v_mfma_f32_16x16x32_bf16 v[188:191], a[28:31], a[16:19], v[188:191]
    ds_read_b64_tr_b16 a[10:11], v20 offset:36864
    s_waitcnt vmcnt(4)
    s_barrier
    ds_read_b128 a[36:39], v32 offset:27840
    ds_read_b128 a[40:43], v32 offset:28864
    ds_read_b128 a[44:47], v33 offset:27840
    v_mfma_f32_16x16x32_bf16 v[156:159], a[24:27], a[20:23], v[156:159]
    ds_read_b64_tr_b16 a[12:13], v10 offset:49152
    v_mfma_f32_16x16x32_bf16 v[192:195], a[28:31], a[20:23], v[192:195]
    ds_read_b64_tr_b16 a[14:15], v10 offset:53248
    s_waitcnt lgkmcnt(7)
    v_mfma_f32_16x16x32_bf16 v[160:163], a[24:27], a[0:3], v[160:163]
    ds_read_b64_tr_b16 a[16:17], v11 offset:49152
    v_mfma_f32_16x16x32_bf16 v[196:199], a[28:31], a[0:3], v[196:199]
    ds_read_b64_tr_b16 a[18:19], v11 offset:53248
    v_mfma_f32_16x16x32_bf16 v[200:203], a[4:7], a[32:35], v[200:203]
    ds_read_b64_tr_b16 a[20:21], v12 offset:49152
    ds_read_b64_tr_b16 a[22:23], v12 offset:53248
    s_waitcnt lgkmcnt(4)
    v_mfma_f32_16x16x32_bf16 v[204:207], a[32:35], a[8:11], v[204:207]
    ds_read_b64_tr_b16 a[0:1], v13 offset:49152
    ds_read_b64_tr_b16 a[2:3], v13 offset:53248
    v_mfma_f32_16x16x32_bf16 v[128:131], a[12:15], a[36:39], v[128:131]
    ds_read_b64_tr_b16 a[4:5], v14 offset:49152
    v_mfma_f32_16x16x32_bf16 v[164:167], a[12:15], a[40:43], v[164:167]
    ds_read_b64_tr_b16 a[6:7], v14 offset:53248
    s_add_u32 m0, s28, 0x4000
    s_nop 0
    buffer_load_dwordx4 v8, s[8:11], s23 offen lds
    s_waitcnt lgkmcnt(4)
    v_mfma_f32_16x16x32_bf16 v[132:135], a[16:19], a[36:39], v[132:135]
    ds_read_b64_tr_b16 a[8:9], v15 offset:49152
    v_mfma_f32_16x16x32_bf16 v[168:171], a[16:19], a[40:43], v[168:171]
    ds_read_b64_tr_b16 a[10:11], v15 offset:53248
    v_mfma_f32_16x16x32_bf16 v[136:139], a[20:23], a[36:39], v[136:139]
    ds_read_b64_tr_b16 a[12:13], v16 offset:49152
    v_mfma_f32_16x16x32_bf16 v[172:175], a[20:23], a[40:43], v[172:175]
    ds_read_b64_tr_b16 a[14:15], v16 offset:53248
    s_add_u32 m0, s28, 0x4400
    s_nop 0
    buffer_load_dwordx4 v9, s[8:11], s23 offen lds
    s_add_u32 s23, s23, 122880
    s_waitcnt lgkmcnt(4)
    v_mfma_f32_16x16x32_bf16 v[140:143], a[0:3], a[36:39], v[140:143]
    ds_read_b64_tr_b16 a[16:17], v17 offset:49152
    v_mfma_f32_16x16x32_bf16 v[176:179], a[0:3], a[40:43], v[176:179]
    ds_read_b64_tr_b16 a[18:19], v17 offset:53248
    v_mfma_f32_16x16x32_bf16 v[144:147], a[4:7], a[36:39], v[144:147]
    ds_read_b64_tr_b16 a[20:21], v18 offset:49152
    v_mfma_f32_16x16x32_bf16 v[180:183], a[4:7], a[40:43], v[180:183]
    ds_read_b64_tr_b16 a[22:23], v18 offset:53248
    s_waitcnt lgkmcnt(4)
    v_mfma_f32_16x16x32_bf16 v[148:151], a[8:11], a[36:39], v[148:151]
    ds_read_b64_tr_b16 a[0:1], v19 offset:49152
    v_mfma_f32_16x16x32_bf16 v[184:187], a[8:11], a[40:43], v[184:187]
    ds_read_b64_tr_b16 a[2:3], v19 offset:53248
    v_mfma_f32_16x16x32_bf16 v[152:155], a[36:39], a[12:15], v[152:155]
    ds_read_b64_tr_b16 a[4:5], v20 offset:49152
    v_mfma_f32_16x16x32_bf16 v[188:191], a[40:43], a[12:15], v[188:191]
    ds_read_b64_tr_b16 a[6:7], v20 offset:53248
    s_waitcnt vmcnt(4)
    s_barrier
    ds_read_b128 a[24:27], v35 offset:0
    ds_read_b128 a[28:31], v35 offset:1024
    ds_read_b128 a[32:35], v33 offset:37120
    s_waitcnt lgkmcnt(7)
    v_mfma_f32_16x16x32_bf16 v[156:159], a[36:39], a[16:19], v[156:159]
    ds_read_b64_tr_b16 a[8:9], v21 offset:0
    v_mfma_f32_16x16x32_bf16 v[192:195], a[40:43], a[16:19], v[192:195]
    ds_read_b64_tr_b16 a[10:11], v21 offset:4096
    v_mfma_f32_16x16x32_bf16 v[160:163], a[36:39], a[20:23], v[160:163]
    ds_read_b64_tr_b16 a[12:13], v22 offset:0
    v_mfma_f32_16x16x32_bf16 v[196:199], a[40:43], a[20:23], v[196:199]
    ds_read_b64_tr_b16 a[14:15], v22 offset:4096
    s_waitcnt lgkmcnt(7)
    v_mfma_f32_16x16x32_bf16 v[200:203], a[0:3], a[44:47], v[200:203]
    ds_read_b64_tr_b16 a[16:17], v23 offset:0
    ds_read_b64_tr_b16 a[18:19], v23 offset:4096
    v_mfma_f32_16x16x32_bf16 v[204:207], a[44:47], a[4:7], v[204:207]
    ds_read_b64_tr_b16 a[20:21], v24 offset:0
    ds_read_b64_tr_b16 a[22:23], v24 offset:4096
    s_waitcnt lgkmcnt(4)
    v_mfma_f32_16x16x32_bf16 v[128:131], a[8:11], a[24:27], v[128:131]
    ds_read_b64_tr_b16 a[0:1], v25 offset:0
    v_mfma_f32_16x16x32_bf16 v[164:167], a[8:11], a[28:31], v[164:167]
    ds_read_b64_tr_b16 a[2:3], v25 offset:4096
    s_add_u32 m0, s28, 0x8000
    s_nop 0
    buffer_load_dwordx4 v8, s[8:11], s23 offen lds
    v_mfma_f32_16x16x32_bf16 v[132:135], a[12:15], a[24:27], v[132:135]
    ds_read_b64_tr_b16 a[4:5], v26 offset:0
    v_mfma_f32_16x16x32_bf16 v[168:171], a[12:15], a[28:31], v[168:171]
    ds_read_b64_tr_b16 a[6:7], v26 offset:4096
    s_waitcnt lgkmcnt(4)
    v_mfma_f32_16x16x32_bf16 v[136:139], a[16:19], a[24:27], v[136:139]
    ds_read_b64_tr_b16 a[8:9], v27 offset:0
    v_mfma_f32_16x16x32_bf16 v[172:175], a[16:19], a[28:31], v[172:175]
    ds_read_b64_tr_b16 a[10:11], v27 offset:4096
    s_add_u32 m0, s28, 0x8400
    s_nop 0
    buffer_load_dwordx4 v9, s[8:11], s23 offen lds
    s_add_u32 s23, s23, 122880
    v_mfma_f32_16x16x32_bf16 v[140:143], a[20:23], a[24:27], v[140:143]
    ds_read_b64_tr_b16 a[12:13], v28 offset:0
    v_mfma_f32_16x16x32_bf16 v[176:179], a[20:23], a[28:31], v[176:179]
    ds_read_b64_tr_b16 a[14:15], v28 offset:4096
    s_waitcnt lgkmcnt(4)
    v_mfma_f32_16x16x32_bf16 v[144:147], a[0:3], a[24:27], v[144:147]
    ds_read_b64_tr_b16 a[16:17], v29 offset:0
    v_mfma_f32_16x16x32_bf16 v[180:183], a[0:3], a[28:31], v[180:183]
    ds_read_b64_tr_b16 a[18:19], v29 offset:4096
    v_mfma_f32_16x16x32_bf16 v[148:151], a[4:7], a[24:27], v[148:151]
    ds_read_b64_tr_b16 a[20:21], v30 offset:0
    v_mfma_f32_16x16x32_bf16 v[184:187], a[4:7], a[28:31], v[184:187]
    ds_read_b64_tr_b16 a[22:23], v30 offset:4096
    s_waitcnt lgkmcnt(4)
    v_mfma_f32_16x16x32_bf16 v[152:155], a[24:27], a[8:11], v[152:155]
    ds_read_b64_tr_b16 a[0:1], v31 offset:0
    v_mfma_f32_16x16x32_bf16 v[188:191], a[28:31], a[8:11], v[188:191]
    ds_read_b64_tr_b16 a[2:3], v31 offset:4096
    s_waitcnt vmcnt(4)
    s_barrier
    ds_write_b128 v4, v[44:47] offset:0
    ds_write_b128 v5, v[64:67] offset:0
    ds_write_b128 v6, v[84:87] offset:0
    ds_write_b128 v7, v[104:107] offset:0
    s_mov_b32 exec_lo, 0xffff
    s_mov_b32 exec_hi, 0xffff
    ds_write_b128 v34, v[120:123] offset:0
    s_mov_b64 exec, -1
    ds_read_b128 a[36:39], v35 offset:9280
    ds_read_b128 a[40:43], v35 offset:10304
    ds_read_b128 a[44:47], v33 offset:46400
    v_mfma_f32_16x16x32_bf16 v[156:159], a[24:27], a[12:15], v[156:159]
    ds_read_b64_tr_b16 a[4:5], v10 offset:0
    v_mfma_f32_16x16x32_bf16 v[192:195], a[28:31], a[12:15], v[192:195]
    ds_read_b64_tr_b16 a[6:7], v10 offset:4096
    s_waitcnt lgkmcnt(12)
    v_mfma_f32_16x16x32_bf16 v[160:163], a[24:27], a[16:19], v[160:163]
    ds_read_b64_tr_b16 a[8:9], v11 offset:0
    v_mfma_f32_16x16x32_bf16 v[196:199], a[28:31], a[16:19], v[196:199]
    ds_read_b64_tr_b16 a[10:11], v11 offset:4096
    v_mfma_f32_16x16x32_bf16 v[200:203], a[20:23], a[32:35], v[200:203]
    ds_read_b64_tr_b16 a[12:13], v12 offset:0
    ds_read_b64_tr_b16 a[14:15], v12 offset:4096
    s_waitcnt lgkmcnt(4)
    v_mfma_f32_16x16x32_bf16 v[204:207], a[32:35], a[0:3], v[204:207]
    ds_read_b64_tr_b16 a[16:17], v13 offset:0
    ds_read_b64_tr_b16 a[18:19], v13 offset:4096
    v_mfma_f32_16x16x32_bf16 v[128:131], a[4:7], a[36:39], v[128:131]
    ds_read_b64_tr_b16 a[20:21], v14 offset:0
    v_mfma_f32_16x16x32_bf16 v[164:167], a[4:7], a[40:43], v[164:167]
    ds_read_b64_tr_b16 a[22:23], v14 offset:4096
    s_add_u32 m0, s28, 0xc000
    s_nop 0
    buffer_load_dwordx4 v8, s[8:11], s23 offen lds
    s_waitcnt lgkmcnt(4)
    v_mfma_f32_16x16x32_bf16 v[132:135], a[8:11], a[36:39], v[132:135]
    ds_read_b64_tr_b16 a[0:1], v15 offset:0
    v_mfma_f32_16x16x32_bf16 v[168:171], a[8:11], a[40:43], v[168:171]
    ds_read_b64_tr_b16 a[2:3], v15 offset:4096
    v_mfma_f32_16x16x32_bf16 v[136:139], a[12:15], a[36:39], v[136:139]
    ds_read_b64_tr_b16 a[4:5], v16 offset:0
    v_mfma_f32_16x16x32_bf16 v[172:175], a[12:15], a[40:43], v[172:175]
    ds_read_b64_tr_b16 a[6:7], v16 offset:4096
    s_add_u32 m0, s28, 0xc400
    s_nop 0
    buffer_load_dwordx4 v9, s[8:11], s23 offen lds
    s_add_u32 s23, s23, 122880
    s_waitcnt lgkmcnt(4)
    v_mfma_f32_16x16x32_bf16 v[140:143], a[16:19], a[36:39], v[140:143]
    ds_read_b64_tr_b16 a[8:9], v17 offset:0
    v_mfma_f32_16x16x32_bf16 v[176:179], a[16:19], a[40:43], v[176:179]
    ds_read_b64_tr_b16 a[10:11], v17 offset:4096
    v_mfma_f32_16x16x32_bf16 v[144:147], a[20:23], a[36:39], v[144:147]
    ds_read_b64_tr_b16 a[12:13], v18 offset:0
    v_mfma_f32_16x16x32_bf16 v[180:183], a[20:23], a[40:43], v[180:183]
    ds_read_b64_tr_b16 a[14:15], v18 offset:4096
    s_waitcnt lgkmcnt(4)
    v_mfma_f32_16x16x32_bf16 v[148:151], a[0:3], a[36:39], v[148:151]
    ds_read_b64_tr_b16 a[16:17], v19 offset:0
    v_mfma_f32_16x16x32_bf16 v[184:187], a[0:3], a[40:43], v[184:187]
    ds_read_b64_tr_b16 a[18:19], v19 offset:4096
    v_mfma_f32_16x16x32_bf16 v[152:155], a[36:39], a[4:7], v[152:155]
    ds_read_b64_tr_b16 a[20:21], v20 offset:0
    v_mfma_f32_16x16x32_bf16 v[188:191], a[40:43], a[4:7], v[188:191]
    ds_read_b64_tr_b16 a[22:23], v20 offset:4096
    s_waitcnt vmcnt(4)
    s_barrier
    ds_read_b128 a[24:27], v35 offset:18560
    ds_read_b128 a[28:31], v35 offset:19584
    ds_read_b128 a[32:35], v33 offset:55680
    s_waitcnt lgkmcnt(7)
    v_mfma_f32_16x16x32_bf16 v[156:159], a[36:39], a[8:11], v[156:159]
    ds_read_b64_tr_b16 a[0:1], v10 offset:16384
    v_mfma_f32_16x16x32_bf16 v[192:195], a[40:43], a[8:11], v[192:195]
    ds_read_b64_tr_b16 a[2:3], v10 offset:20480
    v_mfma_f32_16x16x32_bf16 v[160:163], a[36:39], a[12:15], v[160:163]
    ds_read_b64_tr_b16 a[4:5], v11 offset:16384
    v_mfma_f32_16x16x32_bf16 v[196:199], a[40:43], a[12:15], v[196:199]
    ds_read_b64_tr_b16 a[6:7], v11 offset:20480
    s_waitcnt lgkmcnt(7)
    v_mfma_f32_16x16x32_bf16 v[200:203], a[16:19], a[44:47], v[200:203]
    ds_read_b64_tr_b16 a[8:9], v12 offset:16384
    ds_read_b64_tr_b16 a[10:11], v12 offset:20480
    v_mfma_f32_16x16x32_bf16 v[204:207], a[44:47], a[20:23], v[204:207]
    ds_read_b64_tr_b16 a[12:13], v13 offset:16384
    ds_read_b64_tr_b16 a[14:15], v13 offset:20480
    s_waitcnt lgkmcnt(4)
    v_mfma_f32_16x16x32_bf16 v[128:131], a[0:3], a[24:27], v[128:131]
    ds_read_b64_tr_b16 a[16:17], v14 offset:16384
    v_mfma_f32_16x16x32_bf16 v[164:167], a[0:3], a[28:31], v[164:167]
    ds_read_b64_tr_b16 a[18:19], v14 offset:20480
    s_add_u32 m0, s28, 0x10000
    s_nop 0
    buffer_load_dwordx4 v8, s[8:11], s23 offen lds
    v_mfma_f32_16x16x32_bf16 v[132:135], a[4:7], a[24:27], v[132:135]
    ds_read_b64_tr_b16 a[20:21], v15 offset:16384
    v_mfma_f32_16x16x32_bf16 v[168:171], a[4:7], a[28:31], v[168:171]
    ds_read_b64_tr_b16 a[22:23], v15 offset:20480
    s_waitcnt lgkmcnt(4)
    v_mfma_f32_16x16x32_bf16 v[136:139], a[8:11], a[24:27], v[136:139]
    ds_read_b64_tr_b16 a[0:1], v16 offset:16384
    v_mfma_f32_16x16x32_bf16 v[172:175], a[8:11], a[28:31], v[172:175]
    ds_read_b64_tr_b16 a[2:3], v16 offset:20480
    s_add_u32 m0, s28, 0x10400
    s_nop 0
    buffer_load_dwordx4 v9, s[8:11], s23 offen lds
    s_add_u32 s23, s23, 122880
    v_mfma_f32_16x16x32_bf16 v[140:143], a[12:15], a[24:27], v[140:143]
    ds_read_b64_tr_b16 a[4:5], v17 offset:16384
    v_mfma_f32_16x16x32_bf16 v[176:179], a[12:15], a[28:31], v[176:179]
    ds_read_b64_tr_b16 a[6:7], v17 offset:20480
    s_waitcnt lgkmcnt(4)
    v_mfma_f32_16x16x32_bf16 v[144:147], a[16:19], a[24:27], v[144:147]
    ds_read_b64_tr_b16 a[8:9], v18 offset:16384
    v_mfma_f32_16x16x32_bf16 v[180:183], a[16:19], a[28:31], v[180:183]
    ds_read_b64_tr_b16 a[10:11], v18 offset:20480
    v_mfma_f32_16x16x32_bf16 v[148:151], a[20:23], a[24:27], v[148:151]
    ds_read_b64_tr_b16 a[12:13], v19 offset:16384
    v_mfma_f32_16x16x32_bf16 v[184:187], a[20:23], a[28:31], v[184:187]
    ds_read_b64_tr_b16 a[14:15], v19 offset:20480
    s_waitcnt lgkmcnt(4)
    v_mfma_f32_16x16x32_bf16 v[152:155], a[24:27], a[0:3], v[152:155]
    ds_read_b64_tr_b16 a[16:17], v20 offset:16384
    v_mfma_f32_16x16x32_bf16 v[188:191], a[28:31], a[0:3], v[188:191]
    ds_read_b64_tr_b16 a[18:19], v20 offset:20480
    s_waitcnt vmcnt(4)
    s_barrier
    ds_read_b128 a[36:39], v35 offset:27840
    ds_read_b128 a[40:43], v35 offset:28864
    ds_read_b128 a[44:47], v33 offset:64960
    v_mfma_f32_16x16x32_bf16 v[156:159], a[24:27], a[4:7], v[156:159]
    ds_read_b64_tr_b16 a[20:21], v10 offset:32768
    v_mfma_f32_16x16x32_bf16 v[192:195], a[28:31], a[4:7], v[192:195]
    ds_read_b64_tr_b16 a[22:23], v10 offset:36864
    s_waitcnt lgkmcnt(7)
    v_mfma_f32_16x16x32_bf16 v[160:163], a[24:27], a[8:11], v[160:163]
    ds_read_b64_tr_b16 a[0:1], v11 offset:32768
    v_mfma_f32_16x16x32_bf16 v[196:199], a[28:31], a[8:11], v[196:199]
    ds_read_b64_tr_b16 a[2:3], v11 offset:36864
    v_mfma_f32_16x16x32_bf16 v[200:203], a[12:15], a[32:35], v[200:203]
    ds_read_b64_tr_b16 a[4:5], v12 offset:32768
    ds_read_b64_tr_b16 a[6:7], v12 offset:36864
    s_waitcnt lgkmcnt(4)
    v_mfma_f32_16x16x32_bf16 v[204:207], a[32:35], a[16:19], v[204:207]
    ds_read_b64_tr_b16 a[8:9], v13 offset:32768
    ds_read_b64_tr_b16 a[10:11], v13 offset:36864
    v_mfma_f32_16x16x32_bf16 v[128:131], a[20:23], a[36:39], v[128:131]
    ds_read_b64_tr_b16 a[12:13], v14 offset:32768
    v_mfma_f32_16x16x32_bf16 v[164:167], a[20:23], a[40:43], v[164:167]
    ds_read_b64_tr_b16 a[14:15], v14 offset:36864
    s_add_u32 m0, s28, 0x0
    s_nop 0
    buffer_load_dwordx4 v8, s[8:11], s23 offen lds
    s_waitcnt lgkmcnt(4)
    v_mfma_f32_16x16x32_bf16 v[132:135], a[0:3], a[36:39], v[132:135]
    ds_read_b64_tr_b16 a[16:17], v15 offset:32768
    v_mfma_f32_16x16x32_bf16 v[168:171], a[0:3], a[40:43], v[168:171]
    ds_read_b64_tr_b16 a[18:19], v15 offset:36864
    v_mfma_f32_16x16x32_bf16 v[136:139], a[4:7], a[36:39], v[136:139]
    ds_read_b64_tr_b16 a[20:21], v16 offset:32768
    v_mfma_f32_16x16x32_bf16 v[172:175], a[4:7], a[40:43], v[172:175]
    ds_read_b64_tr_b16 a[22:23], v16 offset:36864
    s_add_u32 m0, s28, 0x400
    s_nop 0
    buffer_load_dwordx4 v9, s[8:11], s23 offen lds
    s_add_u32 s23, s23, 122880
    s_waitcnt lgkmcnt(4)
    v_mfma_f32_16x16x32_bf16 v[140:143], a[8:11], a[36:39], v[140:143]
    ds_read_b64_tr_b16 a[0:1], v17 offset:32768
    v_mfma_f32_16x16x32_bf16 v[176:179], a[8:11], a[40:43], v[176:179]
    ds_read_b64_tr_b16 a[2:3], v17 offset:36864
    v_mfma_f32_16x16x32_bf16 v[144:147], a[12:15], a[36:39], v[144:147]
    ds_read_b64_tr_b16 a[4:5], v18 offset:32768
    v_mfma_f32_16x16x32_bf16 v[180:183], a[12:15], a[40:43], v[180:183]
    ds_read_b64_tr_b16 a[6:7], v18 offset:36864
    s_waitcnt lgkmcnt(4)
    v_mfma_f32_16x16x32_bf16 v[148:151], a[16:19], a[36:39], v[148:151]
    ds_read_b64_tr_b16 a[8:9], v19 offset:32768
    v_mfma_f32_16x16x32_bf16 v[184:187], a[16:19], a[40:43], v[184:187]
    ds_read_b64_tr_b16 a[10:11], v19 offset:36864
    v_mfma_f32_16x16x32_bf16 v[152:155], a[36:39], a[20:23], v[152:155]
    ds_read_b64_tr_b16 a[12:13], v20 offset:32768
    v_mfma_f32_16x16x32_bf16 v[188:191], a[40:43], a[20:23], v[188:191]
    ds_read_b64_tr_b16 a[14:15], v20 offset:36864
    s_waitcnt vmcnt(4)
    s_barrier
    ds_read_b128 a[24:27], v32 offset:0
    ds_read_b128 a[28:31], v32 offset:1024
    ds_read_b128 a[32:35], v33 offset:0
    s_waitcnt lgkmcnt(7)
    v_mfma_f32_16x16x32_bf16 v[156:159], a[36:39], a[0:3], v[156:159]
    ds_read_b64_tr_b16 a[16:17], v10 offset:49152
    v_mfma_f32_16x16x32_bf16 v[192:195], a[40:43], a[0:3], v[192:195]
    ds_read_b64_tr_b16 a[18:19], v10 offset:53248
    v_mfma_f32_16x16x32_bf16 v[160:163], a[36:39], a[4:7], v[160:163]
    ds_read_b64_tr_b16 a[20:21], v11 offset:49152
    v_mfma_f32_16x16x32_bf16 v[196:199], a[40:43], a[4:7], v[196:199]
    ds_read_b64_tr_b16 a[22:23], v11 offset:53248
    s_waitcnt lgkmcnt(7)
    v_mfma_f32_16x16x32_bf16 v[200:203], a[8:11], a[44:47], v[200:203]
    ds_read_b64_tr_b16 a[0:1], v12 offset:49152
    ds_read_b64_tr_b16 a[2:3], v12 offset:53248
    v_mfma_f32_16x16x32_bf16 v[204:207], a[44:47], a[12:15], v[204:207]
    ds_read_b64_tr_b16 a[4:5], v13 offset:49152
    ds_read_b64_tr_b16 a[6:7], v13 offset:53248
    s_waitcnt lgkmcnt(4)
    v_mfma_f32_16x16x32_bf16 v[128:131], a[16:19], a[24:27], v[128:131]
    ds_read_b64_tr_b16 a[8:9], v14 offset:49152
    v_mfma_f32_16x16x32_bf16 v[164:167], a[16:19], a[28:31], v[164:167]
    ds_read_b64_tr_b16 a[10:11], v14 offset:53248
    s_add_u32 m0, s28, 0x4000
    s_nop 0
    buffer_load_dwordx4 v8, s[8:11], s23 offen lds
    v_mfma_f32_16x16x32_bf16 v[132:135], a[20:23], a[24:27], v[132:135]
    ds_read_b64_tr_b16 a[12:13], v15 offset:49152
    v_mfma_f32_16x16x32_bf16 v[168:171], a[20:23], a[28:31], v[168:171]
    ds_read_b64_tr_b16 a[14:15], v15 offset:53248
    s_waitcnt lgkmcnt(4)
    v_mfma_f32_16x16x32_bf16 v[136:139], a[0:3], a[24:27], v[136:139]
    ds_read_b64_tr_b16 a[16:17], v16 offset:49152
    v_mfma_f32_16x16x32_bf16 v[172:175], a[0:3], a[28:31], v[172:175]
    ds_read_b64_tr_b16 a[18:19], v16 offset:53248
    s_add_u32 m0, s28, 0x4400
    s_nop 0
    buffer_load_dwordx4 v9, s[8:11], s23 offen lds
    s_add_u32 s23, s23, 122880
    v_mfma_f32_16x16x32_bf16 v[140:143], a[4:7], a[24:27], v[140:143]
    ds_read_b64_tr_b16 a[20:21], v17 offset:49152
    v_mfma_f32_16x16x32_bf16 v[176:179], a[4:7], a[28:31], v[176:179]
    ds_read_b64_tr_b16 a[22:23], v17 offset:53248
    s_waitcnt lgkmcnt(4)
    v_mfma_f32_16x16x32_bf16 v[144:147], a[8:11], a[24:27], v[144:147]
    ds_read_b64_tr_b16 a[0:1], v18 offset:49152
    v_mfma_f32_16x16x32_bf16 v[180:183], a[8:11], a[28:31], v[180:183]
    ds_read_b64_tr_b16 a[2:3], v18 offset:53248
    v_mfma_f32_16x16x32_bf16 v[148:151], a[12:15], a[24:27], v[148:151]
    ds_read_b64_tr_b16 a[4:5], v19 offset:49152
    v_mfma_f32_16x16x32_bf16 v[184:187], a[12:15], a[28:31], v[184:187]
    ds_read_b64_tr_b16 a[6:7], v19 offset:53248
    s_waitcnt lgkmcnt(4)
    v_mfma_f32_16x16x32_bf16 v[152:155], a[24:27], a[16:19], v[152:155]
    ds_read_b64_tr_b16 a[8:9], v20 offset:49152
    v_mfma_f32_16x16x32_bf16 v[188:191], a[28:31], a[16:19], v[188:191]
    ds_read_b64_tr_b16 a[10:11], v20 offset:53248
    s_waitcnt vmcnt(4)
    s_barrier
    ds_write_b128 v4, v[48:51] offset:37120
    ds_write_b128 v5, v[68:71] offset:37120
    ds_write_b128 v6, v[88:91] offset:37120
    ds_write_b128 v7, v[108:111] offset:37120
    s_mov_b32 exec_lo, 0xffff0000
    s_mov_b32 exec_hi, 0xffff0000
    ds_write_b128 v34, v[120:123] offset:37120
    s_mov_b64 exec, -1
    ds_read_b128 a[36:39], v32 offset:9280
    ds_read_b128 a[40:43], v32 offset:10304
    ds_read_b128 a[44:47], v33 offset:9280
    v_mfma_f32_16x16x32_bf16 v[156:159], a[24:27], a[20:23], v[156:159]
    ds_read_b64_tr_b16 a[12:13], v21 offset:0
    v_mfma_f32_16x16x32_bf16 v[192:195], a[28:31], a[20:23], v[192:195]
    ds_read_b64_tr_b16 a[14:15], v21 offset:4096
    s_waitcnt lgkmcnt(12)
    v_mfma_f32_16x16x32_bf16 v[160:163], a[24:27], a[0:3], v[160:163]
    ds_read_b64_tr_b16 a[16:17], v22 offset:0
    v_mfma_f32_16x16x32_bf16 v[196:199], a[28:31], a[0:3], v[196:199]
    ds_read_b64_tr_b16 a[18:19], v22 offset:4096
    v_mfma_f32_16x16x32_bf16 v[200:203], a[4:7], a[32:35], v[200:203]
    ds_read_b64_tr_b16 a[20:21], v23 offset:0
    ds_read_b64_tr_b16 a[22:23], v23 offset:4096
    s_waitcnt lgkmcnt(4)
    v_mfma_f32_16x16x32_bf16 v[204:207], a[32:35], a[8:11], v[204:207]
    ds_read_b64_tr_b16 a[0:1], v24 offset:0
    ds_read_b64_tr_b16 a[2:3], v24 offset:4096
    v_mfma_f32_16x16x32_bf16 v[128:131], a[12:15], a[36:39], v[128:131]
    ds_read_b64_tr_b16 a[4:5], v25 offset:0
    v_mfma_f32_16x16x32_bf16 v[164:167], a[12:15], a[40:43], v[164:167]
    ds_read_b64_tr_b16 a[6:7], v25 offset:4096
    s_add_u32 m0, s28, 0x8000
    s_nop 0
    buffer_load_dwordx4 v8, s[8:11], s23 offen lds
    s_waitcnt lgkmcnt(4)
    v_mfma_f32_16x16x32_bf16 v[132:135], a[16:19], a[36:39], v[132:135]
    ds_read_b64_tr_b16 a[8:9], v26 offset:0
    v_mfma_f32_16x16x32_bf16 v[168:171], a[16:19], a[40:43], v[168:171]
    ds_read_b64_tr_b16 a[10:11], v26 offset:4096
    v_mfma_f32_16x16x32_bf16 v[136:139], a[20:23], a[36:39], v[136:139]
    ds_read_b64_tr_b16 a[12:13], v27 offset:0
    v_mfma_f32_16x16x32_bf16 v[172:175], a[20:23], a[40:43], v[172:175]
    ds_read_b64_tr_b16 a[14:15], v27 offset:4096
    s_add_u32 m0, s28, 0x8400
    s_nop 0
    buffer_load_dwordx4 v9, s[8:11], s23 offen lds
    s_add_u32 s23, s23, 122880
    s_waitcnt lgkmcnt(4)
    v_mfma_f32_16x16x32_bf16 v[140:143], a[0:3], a[36:39], v[140:143]
    ds_read_b64_tr_b16 a[16:17], v28 offset:0
    v_mfma_f32_16x16x32_bf16 v[176:179], a[0:3], a[40:43], v[176:179]
    ds_read_b64_tr_b16 a[18:19], v28 offset:4096
    v_mfma_f32_16x16x32_bf16 v[144:147], a[4:7], a[36:39], v[144:147]
    ds_read_b64_tr_b16 a[20:21], v29 offset:0
    v_mfma_f32_16x16x32_bf16 v[180:183], a[4:7], a[40:43], v[180:183]
    ds_read_b64_tr_b16 a[22:23], v29 offset:4096
    s_waitcnt lgkmcnt(4)
    v_mfma_f32_16x16x32_bf16 v[148:151], a[8:11], a[36:39], v[148:151]
    ds_read_b64_tr_b16 a[0:1], v30 offset:0
    v_mfma_f32_16x16x32_bf16 v[184:187], a[8:11], a[40:43], v[184:187]
    ds_read_b64_tr_b16 a[2:3], v30 offset:4096
    v_mfma_f32_16x16x32_bf16 v[152:155], a[36:39], a[12:15], v[152:155]
    ds_read_b64_tr_b16 a[4:5], v31 offset:0
    v_mfma_f32_16x16x32_bf16 v[188:191], a[40:43], a[12:15], v[188:191]
    ds_read_b64_tr_b16 a[6:7], v31 offset:4096
    s_waitcnt vmcnt(4)
    s_barrier
    ds_read_b128 a[24:27], v32 offset:18560
    ds_read_b128 a[28:31], v32 offset:19584
    ds_read_b128 a[32:35], v33 offset:18560
    s_waitcnt lgkmcnt(7)
    v_mfma_f32_16x16x32_bf16 v[156:159], a[36:39], a[16:19], v[156:159]
    ds_read_b64_tr_b16 a[8:9], v10 offset:0
    v_mfma_f32_16x16x32_bf16 v[192:195], a[40:43], a[16:19], v[192:195]
    ds_read_b64_tr_b16 a[10:11], v10 offset:4096
    v_mfma_f32_16x16x32_bf16 v[160:163], a[36:39], a[20:23], v[160:163]
    ds_read_b64_tr_b16 a[12:13], v11 offset:0
    v_mfma_f32_16x16x32_bf16 v[196:199], a[40:43], a[20:23], v[196:199]
    ds_read_b64_tr_b16 a[14:15], v11 offset:4096
    s_waitcnt lgkmcnt(7)
    v_mfma_f32_16x16x32_bf16 v[200:203], a[0:3], a[44:47], v[200:203]
    ds_read_b64_tr_b16 a[16:17], v12 offset:0
    ds_read_b64_tr_b16 a[18:19], v12 offset:4096
    v_mfma_f32_16x16x32_bf16 v[204:207], a[44:47], a[4:7], v[204:207]
    ds_read_b64_tr_b16 a[20:21], v13 offset:0
    ds_read_b64_tr_b16 a[22:23], v13 offset:4096
    s_waitcnt lgkmcnt(4)
    v_mfma_f32_16x16x32_bf16 v[128:131], a[8:11], a[24:27], v[128:131]
    ds_read_b64_tr_b16 a[0:1], v14 offset:0
    v_mfma_f32_16x16x32_bf16 v[164:167], a[8:11], a[28:31], v[164:167]
    ds_read_b64_tr_b16 a[2:3], v14 offset:4096
    s_add_u32 m0, s28, 0xc000
    s_nop 0
    buffer_load_dwordx4 v8, s[8:11], s23 offen lds
    v_mfma_f32_16x16x32_bf16 v[132:135], a[12:15], a[24:27], v[132:135]
    ds_read_b64_tr_b16 a[4:5], v15 offset:0
    v_mfma_f32_16x16x32_bf16 v[168:171], a[12:15], a[28:31], v[168:171]
    ds_read_b64_tr_b16 a[6:7], v15 offset:4096
    s_waitcnt lgkmcnt(4)
    v_mfma_f32_16x16x32_bf16 v[136:139], a[16:19], a[24:27], v[136:139]
    ds_read_b64_tr_b16 a[8:9], v16 offset:0
    v_mfma_f32_16x16x32_bf16 v[172:175], a[16:19], a[28:31], v[172:175]
    ds_read_b64_tr_b16 a[10:11], v16 offset:4096
    s_add_u32 m0, s28, 0xc400
    s_nop 0
    buffer_load_dwordx4 v9, s[8:11], s23 offen lds
    s_add_u32 s23, s23, 122880
    v_mfma_f32_16x16x32_bf16 v[140:143], a[20:23], a[24:27], v[140:143]
    ds_read_b64_tr_b16 a[12:13], v17 offset:0
    v_mfma_f32_16x16x32_bf16 v[176:179], a[20:23], a[28:31], v[176:179]
    ds_read_b64_tr_b16 a[14:15], v17 offset:4096
    s_waitcnt lgkmcnt(4)
    v_mfma_f32_16x16x32_bf16 v[144:147], a[0:3], a[24:27], v[144:147]
    ds_read_b64_tr_b16 a[16:17], v18 offset:0
    v_mfma_f32_16x16x32_bf16 v[180:183], a[0:3], a[28:31], v[180:183]
    ds_read_b64_tr_b16 a[18:19], v18 offset:4096
    v_mfma_f32_16x16x32_bf16 v[148:151], a[4:7], a[24:27], v[148:151]
    ds_read_b64_tr_b16 a[20:21], v19 offset:0
    v_mfma_f32_16x16x32_bf16 v[184:187], a[4:7], a[28:31], v[184:187]
    ds_read_b64_tr_b16 a[22:23], v19 offset:4096
    s_waitcnt lgkmcnt(4)
    v_mfma_f32_16x16x32_bf16 v[152:155], a[24:27], a[8:11], v[152:155]
    ds_read_b64_tr_b16 a[0:1], v20 offset:0
    v_mfma_f32_16x16x32_bf16 v[188:191], a[28:31], a[8:11], v[188:191]
    ds_read_b64_tr_b16 a[2:3], v20 offset:4096
    s_waitcnt vmcnt(4)
    s_barrier
    ds_read_b128 a[36:39], v32 offset:27840
    ds_read_b128 a[40:43], v32 offset:28864
    ds_read_b128 a[44:47], v33 offset:27840
    v_mfma_f32_16x16x32_bf16 v[156:159], a[24:27], a[12:15], v[156:159]
    ds_read_b64_tr_b16 a[4:5], v10 offset:16384
    v_mfma_f32_16x16x32_bf16 v[192:195], a[28:31], a[12:15], v[192:195]
    ds_read_b64_tr_b16 a[6:7], v10 offset:20480
    s_waitcnt lgkmcnt(7)
    v_mfma_f32_16x16x32_bf16 v[160:163], a[24:27], a[16:19], v[160:163]
    ds_read_b64_tr_b16 a[8:9], v11 offset:16384
    v_mfma_f32_16x16x32_bf16 v[196:199], a[28:31], a[16:19], v[196:199]
    ds_read_b64_tr_b16 a[10:11], v11 offset:20480
    v_mfma_f32_16x16x32_bf16 v[200:203], a[20:23], a[32:35], v[200:203]
    ds_read_b64_tr_b16 a[12:13], v12 offset:16384
    ds_read_b64_tr_b16 a[14:15], v12 offset:20480
    s_waitcnt lgkmcnt(4)
    v_mfma_f32_16x16x32_bf16 v[204:207], a[32:35], a[0:3], v[204:207]
    ds_read_b64_tr_b16 a[16:17], v13 offset:16384
    ds_read_b64_tr_b16 a[18:19], v13 offset:20480
    v_mfma_f32_16x16x32_bf16 v[128:131], a[4:7], a[36:39], v[128:131]
    ds_read_b64_tr_b16 a[20:21], v14 offset:16384
    v_mfma_f32_16x16x32_bf16 v[164:167], a[4:7], a[40:43], v[164:167]
    ds_read_b64_tr_b16 a[22:23], v14 offset:20480
    s_add_u32 m0, s28, 0x10000
    s_nop 0
    buffer_load_dwordx4 v8, s[8:11], s23 offen lds
    s_waitcnt lgkmcnt(4)
    v_mfma_f32_16x16x32_bf16 v[132:135], a[8:11], a[36:39], v[132:135]
    ds_read_b64_tr_b16 a[0:1], v15 offset:16384
    v_mfma_f32_16x16x32_bf16 v[168:171], a[8:11], a[40:43], v[168:171]
    ds_read_b64_tr_b16 a[2:3], v15 offset:20480
    v_mfma_f32_16x16x32_bf16 v[136:139], a[12:15], a[36:39], v[136:139]
    ds_read_b64_tr_b16 a[4:5], v16 offset:16384
    v_mfma_f32_16x16x32_bf16 v[172:175], a[12:15], a[40:43], v[172:175]
    ds_read_b64_tr_b16 a[6:7], v16 offset:20480
    s_add_u32 m0, s28, 0x10400
    s_nop 0
    buffer_load_dwordx4 v9, s[8:11], s23 offen lds
    s_add_u32 s23, s23, 122880
    s_waitcnt lgkmcnt(4)
    v_mfma_f32_16x16x32_bf16 v[140:143], a[16:19], a[36:39], v[140:143]
    ds_read_b64_tr_b16 a[8:9], v17 offset:16384
    v_mfma_f32_16x16x32_bf16 v[176:179], a[16:19], a[40:43], v[176:179]
    ds_read_b64_tr_b16 a[10:11], v17 offset:20480
    v_mfma_f32_16x16x32_bf16 v[144:147], a[20:23], a[36:39], v[144:147]
    ds_read_b64_tr_b16 a[12:13], v18 offset:16384
    v_mfma_f32_16x16x32_bf16 v[180:183], a[20:23], a[40:43], v[180:183]
    ds_read_b64_tr_b16 a[14:15], v18 offset:20480
    s_waitcnt lgkmcnt(4)
    v_mfma_f32_16x16x32_bf16 v[148:151], a[0:3], a[36:39], v[148:151]
    ds_read_b64_tr_b16 a[16:17], v19 offset:16384
    v_mfma_f32_16x16x32_bf16 v[184:187], a[0:3], a[40:43], v[184:187]
    ds_read_b64_tr_b16 a[18:19], v19 offset:20480
    v_mfma_f32_16x16x32_bf16 v[152:155], a[36:39], a[4:7], v[152:155]
    ds_read_b64_tr_b16 a[20:21], v20 offset:16384
    v_mfma_f32_16x16x32_bf16 v[188:191], a[40:43], a[4:7], v[188:191]
    ds_read_b64_tr_b16 a[22:23], v20 offset:20480
    s_waitcnt vmcnt(4)
    s_barrier
    ds_read_b128 a[24:27], v35 offset:0
    ds_read_b128 a[28:31], v35 offset:1024
    ds_read_b128 a[32:35], v33 offset:37120
    s_waitcnt lgkmcnt(7)
    v_mfma_f32_16x16x32_bf16 v[156:159], a[36:39], a[8:11], v[156:159]
    ds_read_b64_tr_b16 a[0:1], v10 offset:32768
    v_mfma_f32_16x16x32_bf16 v[192:195], a[40:43], a[8:11], v[192:195]
    ds_read_b64_tr_b16 a[2:3], v10 offset:36864
    v_mfma_f32_16x16x32_bf16 v[160:163], a[36:39], a[12:15], v[160:163]
    ds_read_b64_tr_b16 a[4:5], v11 offset:32768
    v_mfma_f32_16x16x32_bf16 v[196:199], a[40:43], a[12:15], v[196:199]
    ds_read_b64_tr_b16 a[6:7], v11 offset:36864
    s_waitcnt lgkmcnt(7)
    v_mfma_f32_16x16x32_bf16 v[200:203], a[16:19], a[44:47], v[200:203]
    ds_read_b64_tr_b16 a[8:9], v12 offset:32768
    ds_read_b64_tr_b16 a[10:11], v12 offset:36864
    v_mfma_f32_16x16x32_bf16 v[204:207], a[44:47], a[20:23], v[204:207]
    ds_read_b64_tr_b16 a[12:13], v13 offset:32768
    ds_read_b64_tr_b16 a[14:15], v13 offset:36864
    s_waitcnt lgkmcnt(4)
    v_mfma_f32_16x16x32_bf16 v[128:131], a[0:3], a[24:27], v[128:131]
    ds_read_b64_tr_b16 a[16:17], v14 offset:32768
    v_mfma_f32_16x16x32_bf16 v[164:167], a[0:3], a[28:31], v[164:167]
    ds_read_b64_tr_b16 a[18:19], v14 offset:36864
    s_add_u32 m0, s28, 0x0
    s_nop 0
    buffer_load_dwordx4 v8, s[8:11], s23 offen lds
    v_mfma_f32_16x16x32_bf16 v[132:135], a[4:7], a[24:27], v[132:135]
    ds_read_b64_tr_b16 a[20:21], v15 offset:32768
    v_mfma_f32_16x16x32_bf16 v[168:171], a[4:7], a[28:31], v[168:171]
    ds_read_b64_tr_b16 a[22:23], v15 offset:36864
    s_waitcnt lgkmcnt(4)
    v_mfma_f32_16x16x32_bf16 v[136:139], a[8:11], a[24:27], v[136:139]
    ds_read_b64_tr_b16 a[0:1], v16 offset:32768
    v_mfma_f32_16x16x32_bf16 v[172:175], a[8:11], a[28:31], v[172:175]
    ds_read_b64_tr_b16 a[2:3], v16 offset:36864
    s_add_u32 m0, s28, 0x400
    s_nop 0
    buffer_load_dwordx4 v9, s[8:11], s23 offen lds
    s_add_u32 s23, s23, 122880
    v_mfma_f32_16x16x32_bf16 v[140:143], a[12:15], a[24:27], v[140:143]
    ds_read_b64_tr_b16 a[4:5], v17 offset:32768
    v_mfma_f32_16x16x32_bf16 v[176:179], a[12:15], a[28:31], v[176:179]
    ds_read_b64_tr_b16 a[6:7], v17 offset:36864
    s_waitcnt lgkmcnt(4)
    v_mfma_f32_16x16x32_bf16 v[144:147], a[16:19], a[24:27], v[144:147]
    ds_read_b64_tr_b16 a[8:9], v18 offset:32768
    v_mfma_f32_16x16x32_bf16 v[180:183], a[16:19], a[28:31], v[180:183]
    ds_read_b64_tr_b16 a[10:11], v18 offset:36864
    v_mfma_f32_16x16x32_bf16 v[148:151], a[20:23], a[24:27], v[148:151]
    ds_read_b64_tr_b16 a[12:13], v19 offset:32768
    v_mfma_f32_16x16x32_bf16 v[184:187], a[20:23], a[28:31], v[184:187]
    ds_read_b64_tr_b16 a[14:15], v19 offset:36864
    s_waitcnt lgkmcnt(4)
    v_mfma_f32_16x16x32_bf16 v[152:155], a[24:27], a[0:3], v[152:155]
    ds_read_b64_tr_b16 a[16:17], v20 offset:32768
    v_mfma_f32_16x16x32_bf16 v[188:191], a[28:31], a[0:3], v[188:191]
    ds_read_b64_tr_b16 a[18:19], v20 offset:36864
    s_waitcnt vmcnt(4)
    s_barrier
    ds_write_b128 v4, v[52:55] offset:0
    ds_write_b128 v5, v[72:75] offset:0
    ds_write_b128 v6, v[92:95] offset:0
    ds_write_b128 v7, v[112:115] offset:0
    s_mov_b32 exec_lo, 0xffff
    s_mov_b32 exec_hi, 0xffff
    ds_write_b128 v34, v[124:127] offset:0
    s_mov_b64 exec, -1
    ds_read_b128 a[36:39], v35 offset:9280
    ds_read_b128 a[40:43], v35 offset:10304
    ds_read_b128 a[44:47], v33 offset:46400
    v_mfma_f32_16x16x32_bf16 v[156:159], a[24:27], a[4:7], v[156:159]
    ds_read_b64_tr_b16 a[20:21], v10 offset:49152
    v_mfma_f32_16x16x32_bf16 v[192:195], a[28:31], a[4:7], v[192:195]
    ds_read_b64_tr_b16 a[22:23], v10 offset:53248
    s_waitcnt lgkmcnt(12)
    v_mfma_f32_16x16x32_bf16 v[160:163], a[24:27], a[8:11], v[160:163]
    ds_read_b64_tr_b16 a[0:1], v11 offset:49152
    v_mfma_f32_16x16x32_bf16 v[196:199], a[28:31], a[8:11], v[196:199]
    ds_read_b64_tr_b16 a[2:3], v11 offset:53248
    v_mfma_f32_16x16x32_bf16 v[200:203], a[12:15], a[32:35], v[200:203]
    ds_read_b64_tr_b16 a[4:5], v12 offset:49152
    ds_read_b64_tr_b16 a[6:7], v12 offset:53248
    s_waitcnt lgkmcnt(4)
    v_mfma_f32_16x16x32_bf16 v[204:207], a[32:35], a[16:19], v[204:207]
    ds_read_b64_tr_b16 a[8:9], v13 offset:49152
    ds_read_b64_tr_b16 a[10:11], v13 offset:53248
    v_mfma_f32_16x16x32_bf16 v[128:131], a[20:23], a[36:39], v[128:131]
    ds_read_b64_tr_b16 a[12:13], v14 offset:49152
    v_mfma_f32_16x16x32_bf16 v[164:167], a[20:23], a[40:43], v[164:167]
    ds_read_b64_tr_b16 a[14:15], v14 offset:53248
    s_add_u32 m0, s28, 0x4000
    s_nop 0
    buffer_load_dwordx4 v8, s[8:11], s23 offen lds
    s_waitcnt lgkmcnt(4)
    v_mfma_f32_16x16x32_bf16 v[132:135], a[0:3], a[36:39], v[132:135]
    ds_read_b64_tr_b16 a[16:17], v15 offset:49152
    v_mfma_f32_16x16x32_bf16 v[168:171], a[0:3], a[40:43], v[168:171]
    ds_read_b64_tr_b16 a[18:19], v15 offset:53248
    v_mfma_f32_16x16x32_bf16 v[136:139], a[4:7], a[36:39], v[136:139]
    ds_read_b64_tr_b16 a[20:21], v16 offset:49152
    v_mfma_f32_16x16x32_bf16 v[172:175], a[4:7], a[40:43], v[172:175]
    ds_read_b64_tr_b16 a[22:23], v16 offset:53248
    s_add_u32 m0, s28, 0x4400
    s_nop 0
    buffer_load_dwordx4 v9, s[8:11], s23 offen lds
    s_add_u32 s23, s23, 122880
    s_waitcnt lgkmcnt(4)
    v_mfma_f32_16x16x32_bf16 v[140:143], a[8:11], a[36:39], v[140:143]
    ds_read_b64_tr_b16 a[0:1], v17 offset:49152
    v_mfma_f32_16x16x32_bf16 v[176:179], a[8:11], a[40:43], v[176:179]
    ds_read_b64_tr_b16 a[2:3], v17 offset:53248
    v_mfma_f32_16x16x32_bf16 v[144:147], a[12:15], a[36:39], v[144:147]
    ds_read_b64_tr_b16 a[4:5], v18 offset:49152
    v_mfma_f32_16x16x32_bf16 v[180:183], a[12:15], a[40:43], v[180:183]
    ds_read_b64_tr_b16 a[6:7], v18 offset:53248
    s_waitcnt lgkmcnt(4)
    v_mfma_f32_16x16x32_bf16 v[148:151], a[16:19], a[36:39], v[148:151]
    ds_read_b64_tr_b16 a[8:9], v19 offset:49152
    v_mfma_f32_16x16x32_bf16 v[184:187], a[16:19], a[40:43], v[184:187]
    ds_read_b64_tr_b16 a[10:11], v19 offset:53248
    v_mfma_f32_16x16x32_bf16 v[152:155], a[36:39], a[20:23], v[152:155]
    ds_read_b64_tr_b16 a[12:13], v20 offset:49152
    v_mfma_f32_16x16x32_bf16 v[188:191], a[40:43], a[20:23], v[188:191]
    ds_read_b64_tr_b16 a[14:15], v20 offset:53248
    s_waitcnt vmcnt(4)
    s_barrier
    ds_read_b128 a[24:27], v35 offset:18560
    ds_read_b128 a[28:31], v35 offset:19584
    ds_read_b128 a[32:35], v33 offset:55680
    s_waitcnt lgkmcnt(7)
    v_mfma_f32_16x16x32_bf16 v[156:159], a[36:39], a[0:3], v[156:159]
    ds_read_b64_tr_b16 a[16:17], v21 offset:0
    v_mfma_f32_16x16x32_bf16 v[192:195], a[40:43], a[0:3], v[192:195]
    ds_read_b64_tr_b16 a[18:19], v21 offset:4096
    v_mfma_f32_16x16x32_bf16 v[160:163], a[36:39], a[4:7], v[160:163]
    ds_read_b64_tr_b16 a[20:21], v22 offset:0
    v_mfma_f32_16x16x32_bf16 v[196:199], a[40:43], a[4:7], v[196:199]
    ds_read_b64_tr_b16 a[22:23], v22 offset:4096
    s_waitcnt lgkmcnt(7)
    v_mfma_f32_16x16x32_bf16 v[200:203], a[8:11], a[44:47], v[200:203]
    ds_read_b64_tr_b16 a[0:1], v23 offset:0
    ds_read_b64_tr_b16 a[2:3], v23 offset:4096
    v_mfma_f32_16x16x32_bf16 v[204:207], a[44:47], a[12:15], v[204:207]
    ds_read_b64_tr_b16 a[4:5], v24 offset:0
    ds_read_b64_tr_b16 a[6:7], v24 offset:4096
    s_waitcnt lgkmcnt(4)
    v_mfma_f32_16x16x32_bf16 v[128:131], a[16:19], a[24:27], v[128:131]
    ds_read_b64_tr_b16 a[8:9], v25 offset:0
    v_mfma_f32_16x16x32_bf16 v[164:167], a[16:19], a[28:31], v[164:167]
    ds_read_b64_tr_b16 a[10:11], v25 offset:4096
    s_add_u32 m0, s28, 0x8000
    s_nop 0
    buffer_load_dwordx4 v8, s[8:11], s23 offen lds
    v_mfma_f32_16x16x32_bf16 v[132:135], a[20:23], a[24:27], v[132:135]
    ds_read_b64_tr_b16 a[12:13], v26 offset:0
    v_mfma_f32_16x16x32_bf16 v[168:171], a[20:23], a[28:31], v[168:171]
    ds_read_b64_tr_b16 a[14:15], v26 offset:4096
    s_waitcnt lgkmcnt(4)
    v_mfma_f32_16x16x32_bf16 v[136:139], a[0:3], a[24:27], v[136:139]
    ds_read_b64_tr_b16 a[16:17], v27 offset:0
    v_mfma_f32_16x16x32_bf16 v[172:175], a[0:3], a[28:31], v[172:175]
    ds_read_b64_tr_b16 a[18:19], v27 offset:4096
    s_add_u32 m0, s28, 0x8400
    s_nop 0
    buffer_load_dwordx4 v9, s[8:11], s23 offen lds
    s_add_u32 s23, s23, 122880
    v_mfma_f32_16x16x32_bf16 v[140:143], a[4:7], a[24:27], v[140:143]
    ds_read_b64_tr_b16 a[20:21], v28 offset:0
    v_mfma_f32_16x16x32_bf16 v[176:179], a[4:7], a[28:31], v[176:179]
    ds_read_b64_tr_b16 a[22:23], v28 offset:4096
    s_waitcnt lgkmcnt(4)
    v_mfma_f32_16x16x32_bf16 v[144:147], a[8:11], a[24:27], v[144:147]
    ds_read_b64_tr_b16 a[0:1], v29 offset:0
    v_mfma_f32_16x16x32_bf16 v[180:183], a[8:11], a[28:31], v[180:183]
    ds_read_b64_tr_b16 a[2:3], v29 offset:4096
    v_mfma_f32_16x16x32_bf16 v[148:151], a[12:15], a[24:27], v[148:151]
    ds_read_b64_tr_b16 a[4:5], v30 offset:0
    v_mfma_f32_16x16x32_bf16 v[184:187], a[12:15], a[28:31], v[184:187]
    ds_read_b64_tr_b16 a[6:7], v30 offset:4096
    s_waitcnt lgkmcnt(4)
    v_mfma_f32_16x16x32_bf16 v[152:155], a[24:27], a[16:19], v[152:155]
    ds_read_b64_tr_b16 a[8:9], v31 offset:0
    v_mfma_f32_16x16x32_bf16 v[188:191], a[28:31], a[16:19], v[188:191]
    ds_read_b64_tr_b16 a[10:11], v31 offset:4096
    s_waitcnt vmcnt(4)
    s_barrier
    ds_read_b128 a[36:39], v35 offset:27840
    ds_read_b128 a[40:43], v35 offset:28864
    ds_read_b128 a[44:47], v33 offset:64960
    v_mfma_f32_16x16x32_bf16 v[156:159], a[24:27], a[20:23], v[156:159]
    ds_read_b64_tr_b16 a[12:13], v10 offset:0
    v_mfma_f32_16x16x32_bf16 v[192:195], a[28:31], a[20:23], v[192:195]
    ds_read_b64_tr_b16 a[14:15], v10 offset:4096
    s_waitcnt lgkmcnt(7)
    v_mfma_f32_16x16x32_bf16 v[160:163], a[24:27], a[0:3], v[160:163]
    ds_read_b64_tr_b16 a[16:17], v11 offset:0
    v_mfma_f32_16x16x32_bf16 v[196:199], a[28:31], a[0:3], v[196:199]
    ds_read_b64_tr_b16 a[18:19], v11 offset:4096
    v_mfma_f32_16x16x32_bf16 v[200:203], a[4:7], a[32:35], v[200:203]
    ds_read_b64_tr_b16 a[20:21], v12 offset:0
    ds_read_b64_tr_b16 a[22:23], v12 offset:4096
    s_waitcnt lgkmcnt(4)
    v_mfma_f32_16x16x32_bf16 v[204:207], a[32:35], a[8:11], v[204:207]
    ds_read_b64_tr_b16 a[0:1], v13 offset:0
    ds_read_b64_tr_b16 a[2:3], v13 offset:4096
    v_mfma_f32_16x16x32_bf16 v[128:131], a[12:15], a[36:39], v[128:131]
    ds_read_b64_tr_b16 a[4:5], v14 offset:0
    v_mfma_f32_16x16x32_bf16 v[164:167], a[12:15], a[40:43], v[164:167]
    ds_read_b64_tr_b16 a[6:7], v14 offset:4096
    s_add_u32 m0, s28, 0xc000
    s_nop 0
    buffer_load_dwordx4 v8, s[8:11], s23 offen lds
    s_waitcnt lgkmcnt(4)
    v_mfma_f32_16x16x32_bf16 v[132:135], a[16:19], a[36:39], v[132:135]
    ds_read_b64_tr_b16 a[8:9], v15 offset:0
    v_mfma_f32_16x16x32_bf16 v[168:171], a[16:19], a[40:43], v[168:171]
    ds_read_b64_tr_b16 a[10:11], v15 offset:4096
    v_mfma_f32_16x16x32_bf16 v[136:139], a[20:23], a[36:39], v[136:139]
    ds_read_b64_tr_b16 a[12:13], v16 offset:0
    v_mfma_f32_16x16x32_bf16 v[172:175], a[20:23], a[40:43], v[172:175]
    ds_read_b64_tr_b16 a[14:15], v16 offset:4096
    s_add_u32 m0, s28, 0xc400
    s_nop 0
    buffer_load_dwordx4 v9, s[8:11], s23 offen lds
    s_add_u32 s23, s23, 122880
    s_waitcnt lgkmcnt(4)
    v_mfma_f32_16x16x32_bf16 v[140:143], a[0:3], a[36:39], v[140:143]
    ds_read_b64_tr_b16 a[16:17], v17 offset:0
    v_mfma_f32_16x16x32_bf16 v[176:179], a[0:3], a[40:43], v[176:179]
    ds_read_b64_tr_b16 a[18:19], v17 offset:4096
    v_mfma_f32_16x16x32_bf16 v[144:147], a[4:7], a[36:39], v[144:147]
    ds_read_b64_tr_b16 a[20:21], v18 offset:0
    v_mfma_f32_16x16x32_bf16 v[180:183], a[4:7], a[40:43], v[180:183]
    ds_read_b64_tr_b16 a[22:23], v18 offset:4096
    s_waitcnt lgkmcnt(4)
    v_mfma_f32_16x16x32_bf16 v[148:151], a[8:11], a[36:39], v[148:151]
    ds_read_b64_tr_b16 a[0:1], v19 offset:0
    v_mfma_f32_16x16x32_bf16 v[184:187], a[8:11], a[40:43], v[184:187]
    ds_read_b64_tr_b16 a[2:3], v19 offset:4096
    v_mfma_f32_16x16x32_bf16 v[152:155], a[36:39], a[12:15], v[152:155]
    ds_read_b64_tr_b16 a[4:5], v20 offset:0
    v_mfma_f32_16x16x32_bf16 v[188:191], a[40:43], a[12:15], v[188:191]
    ds_read_b64_tr_b16 a[6:7], v20 offset:4096
    s_waitcnt vmcnt(4)
    s_barrier
    ds_read_b128 a[24:27], v32 offset:0
    ds_read_b128 a[28:31], v32 offset:1024
    ds_read_b128 a[32:35], v33 offset:0
    s_waitcnt lgkmcnt(7)
    v_mfma_f32_16x16x32_bf16 v[156:159], a[36:39], a[16:19], v[156:159]
    ds_read_b64_tr_b16 a[8:9], v10 offset:16384
    v_mfma_f32_16x16x32_bf16 v[192:195], a[40:43], a[16:19], v[192:195]
    ds_read_b64_tr_b16 a[10:11], v10 offset:20480
    v_mfma_f32_16x16x32_bf16 v[160:163], a[36:39], a[20:23], v[160:163]
    ds_read_b64_tr_b16 a[12:13], v11 offset:16384
    v_mfma_f32_16x16x32_bf16 v[196:199], a[40:43], a[20:23], v[196:199]
    ds_read_b64_tr_b16 a[14:15], v11 offset:20480
    s_waitcnt lgkmcnt(7)
    v_mfma_f32_16x16x32_bf16 v[200:203], a[0:3], a[44:47], v[200:203]
    ds_read_b64_tr_b16 a[16:17], v12 offset:16384
    ds_read_b64_tr_b16 a[18:19], v12 offset:20480
    v_mfma_f32_16x16x32_bf16 v[204:207], a[44:47], a[4:7], v[204:207]
    ds_read_b64_tr_b16 a[20:21], v13 offset:16384
    ds_read_b64_tr_b16 a[22:23], v13 offset:20480
    s_waitcnt lgkmcnt(4)
    v_mfma_f32_16x16x32_bf16 v[128:131], a[8:11], a[24:27], v[128:131]
    ds_read_b64_tr_b16 a[0:1], v14 offset:16384
    v_mfma_f32_16x16x32_bf16 v[164:167], a[8:11], a[28:31], v[164:167]
    ds_read_b64_tr_b16 a[2:3], v14 offset:20480
    s_add_u32 m0, s28, 0x10000
    s_nop 0
    buffer_load_dwordx4 v8, s[8:11], s23 offen lds
    v_mfma_f32_16x16x32_bf16 v[132:135], a[12:15], a[24:27], v[132:135]
    ds_read_b64_tr_b16 a[4:5], v15 offset:16384
    v_mfma_f32_16x16x32_bf16 v[168:171], a[12:15], a[28:31], v[168:171]
    ds_read_b64_tr_b16 a[6:7], v15 offset:20480
    s_waitcnt lgkmcnt(4)
    v_mfma_f32_16x16x32_bf16 v[136:139], a[16:19], a[24:27], v[136:139]
    ds_read_b64_tr_b16 a[8:9], v16 offset:16384
    v_mfma_f32_16x16x32_bf16 v[172:175], a[16:19], a[28:31], v[172:175]
    ds_read_b64_tr_b16 a[10:11], v16 offset:20480
    s_add_u32 m0, s28, 0x10400
    s_nop 0
    buffer_load_dwordx4 v9, s[8:11], s23 offen lds
    s_add_u32 s23, s23, 122880
    v_mfma_f32_16x16x32_bf16 v[140:143], a[20:23], a[24:27], v[140:143]
    ds_read_b64_tr_b16 a[12:13], v17 offset:16384
    v_mfma_f32_16x16x32_bf16 v[176:179], a[20:23], a[28:31], v[176:179]
    ds_read_b64_tr_b16 a[14:15], v17 offset:20480
    s_waitcnt lgkmcnt(4)
    v_mfma_f32_16x16x32_bf16 v[144:147], a[0:3], a[24:27], v[144:147]
    ds_read_b64_tr_b16 a[16:17], v18 offset:16384
    v_mfma_f32_16x16x32_bf16 v[180:183], a[0:3], a[28:31], v[180:183]
    ds_read_b64_tr_b16 a[18:19], v18 offset:20480
    v_mfma_f32_16x16x32_bf16 v[148:151], a[4:7], a[24:27], v[148:151]
    ds_read_b64_tr_b16 a[20:21], v19 offset:16384
    v_mfma_f32_16x16x32_bf16 v[184:187], a[4:7], a[28:31], v[184:187]
    ds_read_b64_tr_b16 a[22:23], v19 offset:20480
    s_waitcnt lgkmcnt(4)
    v_mfma_f32_16x16x32_bf16 v[152:155], a[24:27], a[8:11], v[152:155]
    ds_read_b64_tr_b16 a[0:1], v20 offset:16384
    v_mfma_f32_16x16x32_bf16 v[188:191], a[28:31], a[8:11], v[188:191]
    ds_read_b64_tr_b16 a[2:3], v20 offset:20480
    s_waitcnt vmcnt(4)
    s_barrier
    ds_read_b128 a[36:39], v32 offset:9280
    ds_read_b128 a[40:43], v32 offset:10304
    ds_read_b128 a[44:47], v33 offset:9280
    v_mfma_f32_16x16x32_bf16 v[156:159], a[24:27], a[12:15], v[156:159]
    ds_read_b64_tr_b16 a[4:5], v10 offset:32768
    v_mfma_f32_16x16x32_bf16 v[192:195], a[28:31], a[12:15], v[192:195]
    ds_read_b64_tr_b16 a[6:7], v10 offset:36864
    s_waitcnt lgkmcnt(7)
    v_mfma_f32_16x16x32_bf16 v[160:163], a[24:27], a[16:19], v[160:163]
    ds_read_b64_tr_b16 a[8:9], v11 offset:32768
    v_mfma_f32_16x16x32_bf16 v[196:199], a[28:31], a[16:19], v[196:199]
    ds_read_b64_tr_b16 a[10:11], v11 offset:36864
    v_mfma_f32_16x16x32_bf16 v[200:203], a[20:23], a[32:35], v[200:203]
    ds_read_b64_tr_b16 a[12:13], v12 offset:32768
    ds_read_b64_tr_b16 a[14:15], v12 offset:36864
    s_waitcnt lgkmcnt(4)
    v_mfma_f32_16x16x32_bf16 v[204:207], a[32:35], a[0:3], v[204:207]
    ds_read_b64_tr_b16 a[16:17], v13 offset:32768
    ds_read_b64_tr_b16 a[18:19], v13 offset:36864
    v_mfma_f32_16x16x32_bf16 v[128:131], a[4:7], a[36:39], v[128:131]
    ds_read_b64_tr_b16 a[20:21], v14 offset:32768
    v_mfma_f32_16x16x32_bf16 v[164:167], a[4:7], a[40:43], v[164:167]
    ds_read_b64_tr_b16 a[22:23], v14 offset:36864
    s_waitcnt lgkmcnt(4)
    v_mfma_f32_16x16x32_bf16 v[132:135], a[8:11], a[36:39], v[132:135]
    ds_read_b64_tr_b16 a[0:1], v15 offset:32768
    v_mfma_f32_16x16x32_bf16 v[168:171], a[8:11], a[40:43], v[168:171]
    ds_read_b64_tr_b16 a[2:3], v15 offset:36864
    v_mfma_f32_16x16x32_bf16 v[136:139], a[12:15], a[36:39], v[136:139]
    ds_read_b64_tr_b16 a[4:5], v16 offset:32768
    v_mfma_f32_16x16x32_bf16 v[172:175], a[12:15], a[40:43], v[172:175]
    ds_read_b64_tr_b16 a[6:7], v16 offset:36864
    s_waitcnt lgkmcnt(4)
    v_mfma_f32_16x16x32_bf16 v[140:143], a[16:19], a[36:39], v[140:143]
    ds_read_b64_tr_b16 a[8:9], v17 offset:32768
    v_mfma_f32_16x16x32_bf16 v[176:179], a[16:19], a[40:43], v[176:179]
    ds_read_b64_tr_b16 a[10:11], v17 offset:36864
    v_mfma_f32_16x16x32_bf16 v[144:147], a[20:23], a[36:39], v[144:147]
    ds_read_b64_tr_b16 a[12:13], v18 offset:32768
    v_mfma_f32_16x16x32_bf16 v[180:183], a[20:23], a[40:43], v[180:183]
    ds_read_b64_tr_b16 a[14:15], v18 offset:36864
    s_waitcnt lgkmcnt(4)
    v_mfma_f32_16x16x32_bf16 v[148:151], a[0:3], a[36:39], v[148:151]
    ds_read_b64_tr_b16 a[16:17], v19 offset:32768
    v_mfma_f32_16x16x32_bf16 v[184:187], a[0:3], a[40:43], v[184:187]
    ds_read_b64_tr_b16 a[18:19], v19 offset:36864
    v_mfma_f32_16x16x32_bf16 v[152:155], a[36:39], a[4:7], v[152:155]
    ds_read_b64_tr_b16 a[20:21], v20 offset:32768
    v_mfma_f32_16x16x32_bf16 v[188:191], a[40:43], a[4:7], v[188:191]
    ds_read_b64_tr_b16 a[22:23], v20 offset:36864
    s_waitcnt vmcnt(2)
    s_barrier
    ds_read_b128 a[24:27], v32 offset:18560
    ds_read_b128 a[28:31], v32 offset:19584
    ds_read_b128 a[32:35], v33 offset:18560
    s_waitcnt lgkmcnt(7)
    v_mfma_f32_16x16x32_bf16 v[156:159], a[36:39], a[8:11], v[156:159]
    ds_read_b64_tr_b16 a[0:1], v10 offset:49152
    v_mfma_f32_16x16x32_bf16 v[192:195], a[40:43], a[8:11], v[192:195]
    ds_read_b64_tr_b16 a[2:3], v10 offset:53248
    v_mfma_f32_16x16x32_bf16 v[160:163], a[36:39], a[12:15], v[160:163]
    ds_read_b64_tr_b16 a[4:5], v11 offset:49152
    v_mfma_f32_16x16x32_bf16 v[196:199], a[40:43], a[12:15], v[196:199]
    ds_read_b64_tr_b16 a[6:7], v11 offset:53248
    s_waitcnt lgkmcnt(7)
    v_mfma_f32_16x16x32_bf16 v[200:203], a[16:19], a[44:47], v[200:203]
    ds_read_b64_tr_b16 a[8:9], v12 offset:49152
    ds_read_b64_tr_b16 a[10:11], v12 offset:53248
    v_mfma_f32_16x16x32_bf16 v[204:207], a[44:47], a[20:23], v[204:207]
    ds_read_b64_tr_b16 a[12:13], v13 offset:49152
    ds_read_b64_tr_b16 a[14:15], v13 offset:53248
    s_waitcnt lgkmcnt(4)
    v_mfma_f32_16x16x32_bf16 v[128:131], a[0:3], a[24:27], v[128:131]
    ds_read_b64_tr_b16 a[16:17], v14 offset:49152
    v_mfma_f32_16x16x32_bf16 v[164:167], a[0:3], a[28:31], v[164:167]
    ds_read_b64_tr_b16 a[18:19], v14 offset:53248
    v_mfma_f32_16x16x32_bf16 v[132:135], a[4:7], a[24:27], v[132:135]
    ds_read_b64_tr_b16 a[20:21], v15 offset:49152
    v_mfma_f32_16x16x32_bf16 v[168:171], a[4:7], a[28:31], v[168:171]
    ds_read_b64_tr_b16 a[22:23], v15 offset:53248
    s_waitcnt lgkmcnt(4)
    v_mfma_f32_16x16x32_bf16 v[136:139], a[8:11], a[24:27], v[136:139]
    ds_read_b64_tr_b16 a[0:1], v16 offset:49152
    v_mfma_f32_16x16x32_bf16 v[172:175], a[8:11], a[28:31], v[172:175]
    ds_read_b64_tr_b16 a[2:3], v16 offset:53248
    v_mfma_f32_16x16x32_bf16 v[140:143], a[12:15], a[24:27], v[140:143]
    ds_read_b64_tr_b16 a[4:5], v17 offset:49152
    v_mfma_f32_16x16x32_bf16 v[176:179], a[12:15], a[28:31], v[176:179]
    ds_read_b64_tr_b16 a[6:7], v17 offset:53248
    s_waitcnt lgkmcnt(4)
    v_mfma_f32_16x16x32_bf16 v[144:147], a[16:19], a[24:27], v[144:147]
    ds_read_b64_tr_b16 a[8:9], v18 offset:49152
    v_mfma_f32_16x16x32_bf16 v[180:183], a[16:19], a[28:31], v[180:183]
    ds_read_b64_tr_b16 a[10:11], v18 offset:53248
    v_mfma_f32_16x16x32_bf16 v[148:151], a[20:23], a[24:27], v[148:151]
    ds_read_b64_tr_b16 a[12:13], v19 offset:49152
    v_mfma_f32_16x16x32_bf16 v[184:187], a[20:23], a[28:31], v[184:187]
    ds_read_b64_tr_b16 a[14:15], v19 offset:53248
    s_waitcnt lgkmcnt(4)
    v_mfma_f32_16x16x32_bf16 v[152:155], a[24:27], a[0:3], v[152:155]
    ds_read_b64_tr_b16 a[16:17], v20 offset:49152
    v_mfma_f32_16x16x32_bf16 v[188:191], a[28:31], a[0:3], v[188:191]
    ds_read_b64_tr_b16 a[18:19], v20 offset:53248
    s_waitcnt vmcnt(0)
    s_barrier
    ds_read_b128 a[36:39], v32 offset:27840
    ds_read_b128 a[40:43], v32 offset:28864
    ds_read_b128 a[44:47], v33 offset:27840
    v_mfma_f32_16x16x32_bf16 v[156:159], a[24:27], a[4:7], v[156:159]
    ds_read_b64_tr_b16 a[20:21], v21 offset:0
    v_mfma_f32_16x16x32_bf16 v[192:195], a[28:31], a[4:7], v[192:195]
    ds_read_b64_tr_b16 a[22:23], v21 offset:4096
    s_waitcnt lgkmcnt(7)
    v_mfma_f32_16x16x32_bf16 v[160:163], a[24:27], a[8:11], v[160:163]
    ds_read_b64_tr_b16 a[0:1], v22 offset:0
    v_mfma_f32_16x16x32_bf16 v[196:199], a[28:31], a[8:11], v[196:199]
    ds_read_b64_tr_b16 a[2:3], v22 offset:4096
    v_mfma_f32_16x16x32_bf16 v[200:203], a[12:15], a[32:35], v[200:203]
    ds_read_b64_tr_b16 a[4:5], v23 offset:0
    ds_read_b64_tr_b16 a[6:7], v23 offset:4096
    s_waitcnt lgkmcnt(4)
    v_mfma_f32_16x16x32_bf16 v[204:207], a[32:35], a[16:19], v[204:207]
    ds_read_b64_tr_b16 a[8:9], v24 offset:0
    ds_read_b64_tr_b16 a[10:11], v24 offset:4096
    v_mfma_f32_16x16x32_bf16 v[128:131], a[20:23], a[36:39], v[128:131]
    ds_read_b64_tr_b16 a[12:13], v25 offset:0
    v_mfma_f32_16x16x32_bf16 v[164:167], a[20:23], a[40:43], v[164:167]
    ds_read_b64_tr_b16 a[14:15], v25 offset:4096
    s_waitcnt lgkmcnt(4)
    v_mfma_f32_16x16x32_bf16 v[132:135], a[0:3], a[36:39], v[132:135]
    ds_read_b64_tr_b16 a[16:17], v26 offset:0
    v_mfma_f32_16x16x32_bf16 v[168:171], a[0:3], a[40:43], v[168:171]
    ds_read_b64_tr_b16 a[18:19], v26 offset:4096
    v_mfma_f32_16x16x32_bf16 v[136:139], a[4:7], a[36:39], v[136:139]
    ds_read_b64_tr_b16 a[20:21], v27 offset:0
    v_mfma_f32_16x16x32_bf16 v[172:175], a[4:7], a[40:43], v[172:175]
    ds_read_b64_tr_b16 a[22:23], v27 offset:4096
    s_waitcnt lgkmcnt(4)
    v_mfma_f32_16x16x32_bf16 v[140:143], a[8:11], a[36:39], v[140:143]
    ds_read_b64_tr_b16 a[0:1], v28 offset:0
    v_mfma_f32_16x16x32_bf16 v[176:179], a[8:11], a[40:43], v[176:179]
    ds_read_b64_tr_b16 a[2:3], v28 offset:4096
    v_mfma_f32_16x16x32_bf16 v[144:147], a[12:15], a[36:39], v[144:147]
    ds_read_b64_tr_b16 a[4:5], v29 offset:0
    v_mfma_f32_16x16x32_bf16 v[180:183], a[12:15], a[40:43], v[180:183]
    ds_read_b64_tr_b16 a[6:7], v29 offset:4096
    s_waitcnt lgkmcnt(4)
    v_mfma_f32_16x16x32_bf16 v[148:151], a[16:19], a[36:39], v[148:151]
    ds_read_b64_tr_b16 a[8:9], v30 offset:0
    v_mfma_f32_16x16x32_bf16 v[184:187], a[16:19], a[40:43], v[184:187]
    ds_read_b64_tr_b16 a[10:11], v30 offset:4096
    v_mfma_f32_16x16x32_bf16 v[152:155], a[36:39], a[20:23], v[152:155]
    ds_read_b64_tr_b16 a[12:13], v31 offset:0
    v_mfma_f32_16x16x32_bf16 v[188:191], a[40:43], a[20:23], v[188:191]
    ds_read_b64_tr_b16 a[14:15], v31 offset:4096
    s_waitcnt lgkmcnt(4)
    v_mfma_f32_16x16x32_bf16 v[156:159], a[36:39], a[0:3], v[156:159]
    v_mfma_f32_16x16x32_bf16 v[192:195], a[40:43], a[0:3], v[192:195]
    v_mfma_f32_16x16x32_bf16 v[160:163], a[36:39], a[4:7], v[160:163]
    v_mfma_f32_16x16x32_bf16 v[196:199], a[40:43], a[4:7], v[196:199]
    s_waitcnt lgkmcnt(0)
    v_mfma_f32_16x16x32_bf16 v[200:203], a[8:11], a[44:47], v[200:203]
    v_mfma_f32_16x16x32_bf16 v[204:207], a[44:47], a[12:15], v[204:207]
L_k1_Q_done:
    s_nop 15
    v_cvt_pk_bf16_f32 v36, v128, v129
    v_cvt_pk_bf16_f32 v37, v130, v131
    v_cvt_pk_bf16_f32 v54, v140, v141
    v_cvt_pk_bf16_f32 v55, v142, v143
    v_cvt_pk_bf16_f32 v68, v152, v153
    v_cvt_pk_bf16_f32 v69, v154, v155
    v_cvt_pk_bf16_f32 v38, v132, v133
    v_cvt_pk_bf16_f32 v39, v134, v135
    v_cvt_pk_bf16_f32 v56, v144, v145
    v_cvt_pk_bf16_f32 v57, v146, v147
    v_cvt_pk_bf16_f32 v74, v156, v157
    v_cvt_pk_bf16_f32 v75, v158, v159
    v_cvt_pk_bf16_f32 v40, v136, v137
    v_cvt_pk_bf16_f32 v41, v138, v139
    v_cvt_pk_bf16_f32 v58, v148, v149
    v_cvt_pk_bf16_f32 v59, v150, v151
    v_cvt_pk_bf16_f32 v80, v160, v161
    v_cvt_pk_bf16_f32 v81, v162, v163
    v_cvt_pk_bf16_f32 v42, v164, v165
    v_cvt_pk_bf16_f32 v43, v166, v167
    v_cvt_pk_bf16_f32 v60, v176, v177
    v_cvt_pk_bf16_f32 v61, v178, v179
    v_cvt_pk_bf16_f32 v70, v188, v189
    v_cvt_pk_bf16_f32 v71, v190, v191
    v_cvt_pk_bf16_f32 v44, v168, v169
    v_cvt_pk_bf16_f32 v45, v170, v171
    v_cvt_pk_bf16_f32 v62, v180, v181
    v_cvt_pk_bf16_f32 v63, v182, v183
    v_cvt_pk_bf16_f32 v76, v192, v193
    v_cvt_pk_bf16_f32 v77, v194, v195
    v_cvt_pk_bf16_f32 v46, v172, v173
    v_cvt_pk_bf16_f32 v47, v174, v175
    v_cvt_pk_bf16_f32 v64, v184, v185
    v_cvt_pk_bf16_f32 v65, v186, v187
    v_cvt_pk_bf16_f32 v82, v196, v197
    v_cvt_pk_bf16_f32 v83, v198, v199
    v_cvt_pk_bf16_f32 v84, v200, v201
    v_cvt_pk_bf16_f32 v85, v202, v203
    v_cvt_pk_bf16_f32 v86, v204, v205
    v_cvt_pk_bf16_f32 v87, v206, v207
    v_lshlrev_b32 v88, 3, v1
    s_mul_i32 s26, s22, 15360
    s_add_u32 s26, s26, 0x0
    v_add_u32 v88, s26, v88
    s_mul_i32 s26, s21, 3072
    v_add_u32 v89, s26, v88
    v_add_u32 v90, 3072, v89
    ds_write_b64 v90, v[60:61] offset:0
    ds_write_b64 v90, v[70:71] offset:1536
    ds_write_b64 v90, v[62:63] offset:512
    ds_write_b64 v90, v[76:77] offset:2048
    ds_write_b64 v90, v[64:65] offset:1024
    ds_write_b64 v90, v[82:83] offset:2560
    s_min_u32 s26, s21, 2
    s_lshl_b32 s26, s26, 9
    v_add_u32 v91, s26, v88
    ds_write_b64 v91, v[84:85]
    ds_write_b64 v91, v[86:87] offset:1536
    s_waitcnt lgkmcnt(0)
    s_barrier
    ds_read_b64 v[48:49], v89 offset:0
    ds_read_b64 v[66:67], v89 offset:1536
    ds_read_b64 v[50:51], v89 offset:512
    ds_read_b64 v[72:73], v89 offset:2048
    ds_read_b64 v[52:53], v89 offset:1024
    ds_read_b64 v[78:79], v89 offset:2560
    v_and_b32 v92, 15, v1
    v_lshrrev_b32 v93, 4, v1
    v_lshlrev_b32 v94, 2, v93
    v_sub_u32 v94, v92, v94
    v_mov_b32 v92, v94
    v_mov_b32 v95, 0xf149f2ca
    v_subrev_u32 v94, 0, v92
    v_and_b32 v94, 0x80000001, v94
    v_cmp_eq_u32 vcc, 0, v94
    s_nop 1
    v_cndmask_b32 v104, v95, 0, vcc
    v_add_u32 v94, 16, v92
    v_and_b32 v96, 1, v94
    v_cmp_eq_u32 vcc, 0, v96
    v_cmp_ge_i32 s[30:31], 14, v94
    s_nop 1
    s_and_b64 vcc, vcc, s[30:31]
    s_nop 1
    v_cndmask_b32 v100, v95, 0, vcc
    v_subrev_u32 v94, 1, v92
    v_and_b32 v94, 0x80000001, v94
    v_cmp_eq_u32 vcc, 0, v94
    s_nop 1
    v_cndmask_b32 v105, v95, 0, vcc
    v_add_u32 v94, 15, v92
    v_and_b32 v96, 1, v94
    v_cmp_eq_u32 vcc, 0, v96
    v_cmp_ge_i32 s[30:31], 14, v94
    s_nop 1
    s_and_b64 vcc, vcc, s[30:31]
    s_nop 1
    v_cndmask_b32 v101, v95, 0, vcc
    v_subrev_u32 v94, 2, v92
    v_and_b32 v94, 0x80000001, v94
    v_cmp_eq_u32 vcc, 0, v94
    s_nop 1
    v_cndmask_b32 v106, v95, 0, vcc
    v_add_u32 v94, 14, v92
    v_and_b32 v96, 1, v94
    v_cmp_eq_u32 vcc, 0, v96
    v_cmp_ge_i32 s[30:31], 14, v94
    s_nop 1
    s_and_b64 vcc, vcc, s[30:31]
    s_nop 1
    v_cndmask_b32 v102, v95, 0, vcc
    v_subrev_u32 v94, 3, v92
    v_and_b32 v94, 0x80000001, v94
    v_cmp_eq_u32 vcc, 0, v94
    s_nop 1
    v_cndmask_b32 v107, v95, 0, vcc
    v_add_u32 v94, 13, v92
    v_and_b32 v96, 1, v94
    v_cmp_eq_u32 vcc, 0, v96
    v_cmp_ge_i32 s[30:31], 14, v94
    s_nop 1
    s_and_b64 vcc, vcc, s[30:31]
    s_nop 1
    v_cndmask_b32 v103, v95, 0, vcc
    s_or_b32 s26, s24, s21
    s_cmp_eq_u32 s26, 0
    s_cselect_b64 vcc, -1, 0
    s_nop 1
    v_cndmask_b32 v108, v100, v95, vcc
    v_cndmask_b32 v109, v101, v95, vcc
    v_cndmask_b32 v110, v102, v95, vcc
    v_cndmask_b32 v111, v103, v95, vcc
    s_mov_b32 s32, 0xaaaaaaaa
    s_mov_b32 s33, 0xaaaaaaaa
    s_mov_b32 s34, 0xffff0000
    s_mov_b32 s35, 0xffffffff
    s_mov_b32 s40, 0x0000ffff
    s_mov_b32 s41, 0
    s_mov_b32 s42, 0xffffffff
    s_mov_b32 s43, 0
    s_mov_b32 s46, 0x3e64f92e
    s_mov_b32 s47, 0x3fb8aa3b
    v_mov_b32 v97, 0x0000ffff
    v_mov_b32 v98, 0xffff0000
    v_cndmask_b32 v97, v97, v98, s[32:33]
    v_mov_b32 v112, v36
    v_cndmask_b32 v114, 0, v38, s[40:41]
    v_mov_b32 v113, v37
    v_cndmask_b32 v115, 0, v39, s[40:41]
    v_cndmask_b32 v116, 0, v38, s[34:35]
    v_cndmask_b32 v118, 0, v40, s[42:43]
    v_cndmask_b32 v117, 0, v39, s[34:35]
    v_cndmask_b32 v119, 0, v41, s[42:43]
    v_mov_b32 v120, v42
    v_cndmask_b32 v122, 0, v44, s[40:41]
    v_mov_b32 v121, v43
    v_cndmask_b32 v123, 0, v45, s[40:41]
    v_cndmask_b32 v124, 0, v44, s[34:35]
    v_cndmask_b32 v126, 0, v46, s[42:43]
    v_cndmask_b32 v125, 0, v45, s[34:35]
    v_cndmask_b32 v127, 0, v47, s[42:43]
    s_waitcnt lgkmcnt(0)
    s_nop 1
    v_mfma_f32_16x16x32_bf16 v[128:131], v[48:51], v[112:115], v[108:111]
    v_mfma_f32_16x16x32_bf16 v[132:135], v[54:57], v[112:115], v[104:107]
    v_mfma_f32_16x16x32_bf16 v[136:139], v[50:53], v[116:119], v[108:111]
    v_mfma_f32_16x16x32_bf16 v[140:143], v[56:59], v[116:119], v[104:107]
    v_mfma_f32_16x16x32_bf16 v[144:147], v[54:57], v[120:123], v[100:103]
    v_mfma_f32_16x16x32_bf16 v[148:151], v[60:63], v[120:123], v[104:107]
    v_mfma_f32_16x16x32_bf16 v[152:155], v[56:59], v[124:127], v[100:103]
    v_mfma_f32_16x16x32_bf16 v[156:159], v[62:65], v[124:127], v[104:107]
    s_nop 11
    v_cndmask_b32 v128, v128, v129, s[32:33]
    v_cndmask_b32 v136, v136, v137, s[32:33]
    v_cndmask_b32 v144, v144, v145, s[32:33]
    v_cndmask_b32 v152, v152, v153, s[32:33]
    v_cndmask_b32 v130, v130, v131, s[32:33]
    v_cndmask_b32 v138, v138, v139, s[32:33]
    v_cndmask_b32 v146, v146, v147, s[32:33]
    v_cndmask_b32 v154, v154, v155, s[32:33]
    v_cndmask_b32 v132, v132, v133, s[32:33]
    v_cndmask_b32 v140, v140, v141, s[32:33]
    v_cndmask_b32 v148, v148, v149, s[32:33]
    v_cndmask_b32 v156, v156, v157, s[32:33]
    v_cndmask_b32 v134, v134, v135, s[32:33]
    v_cndmask_b32 v142, v142, v143, s[32:33]
    v_cndmask_b32 v150, v150, v151, s[32:33]
    v_cndmask_b32 v158, v158, v159, s[32:33]
    v_cvt_pk_bf16_f32 v128, 0, v128
    v_cvt_pk_bf16_f32 v136, 0, v136
    v_cvt_pk_bf16_f32 v144, 0, v144
    v_cvt_pk_bf16_f32 v152, 0, v152
    v_cvt_pk_bf16_f32 v130, 0, v130
    v_cvt_pk_bf16_f32 v138, 0, v138
    v_cvt_pk_bf16_f32 v146, 0, v146
    v_cvt_pk_bf16_f32 v154, 0, v154
    v_cvt_pk_bf16_f32 v132, 0, v132
    v_cvt_pk_bf16_f32 v140, 0, v140
    v_cvt_pk_bf16_f32 v148, 0, v148
    v_cvt_pk_bf16_f32 v156, 0, v156
    v_cvt_pk_bf16_f32 v134, 0, v134
    v_cvt_pk_bf16_f32 v142, 0, v142
    v_cvt_pk_bf16_f32 v150, 0, v150
    v_cvt_pk_bf16_f32 v158, 0, v158
    v_mul_f32 v128, s46, v128
    v_mul_f32 v136, s46, v136
    v_mul_f32 v144, s46, v144
    v_mul_f32 v152, s46, v152
    v_mul_f32 v130, s46, v130
    v_mul_f32 v138, s46, v138
    v_mul_f32 v146, s46, v146
    v_mul_f32 v154, s46, v154
    v_mul_f32 v132, s46, v132
    v_mul_f32 v140, s46, v140
    v_mul_f32 v148, s46, v148
    v_mul_f32 v156, s46, v156
    v_mul_f32 v134, s46, v134
    v_mul_f32 v142, s46, v142
    v_mul_f32 v150, s46, v150
    v_mul_f32 v158, s46, v158
    v_cvt_pk_bf16_f32 v128, 0, v128
    v_cvt_pk_bf16_f32 v136, 0, v136
    v_cvt_pk_bf16_f32 v144, 0, v144
    v_cvt_pk_bf16_f32 v152, 0, v152
    v_cvt_pk_bf16_f32 v130, 0, v130
    v_cvt_pk_bf16_f32 v138, 0, v138
    v_cvt_pk_bf16_f32 v146, 0, v146
    v_cvt_pk_bf16_f32 v154, 0, v154
    v_cvt_pk_bf16_f32 v132, 0, v132
    v_cvt_pk_bf16_f32 v140, 0, v140
    v_cvt_pk_bf16_f32 v148, 0, v148
    v_cvt_pk_bf16_f32 v156, 0, v156
    v_cvt_pk_bf16_f32 v134, 0, v134
    v_cvt_pk_bf16_f32 v142, 0, v142
    v_cvt_pk_bf16_f32 v150, 0, v150
    v_cvt_pk_bf16_f32 v158, 0, v158
    v_max3_f32 v129, v128, v130, v132
    v_max3_f32 v137, v136, v138, v140
    v_max3_f32 v145, v144, v146, v148
    v_max3_f32 v153, v152, v154, v156
    v_max_f32 v129, v129, v134
    v_max_f32 v137, v137, v142
    v_max_f32 v145, v145, v150
    v_max_f32 v153, v153, v158
    v_mov_b32 v131, v129
    v_mov_b32 v139, v137
    v_mov_b32 v147, v145
    v_mov_b32 v155, v153
    s_nop 0
    s_nop 0
    s_nop 0
    s_nop 0
    v_permlane16_swap_b32 v129, v131
    v_permlane16_swap_b32 v137, v139
    v_permlane16_swap_b32 v145, v147
    v_permlane16_swap_b32 v153, v155
    s_nop 0
    s_nop 0
    s_nop 0
    s_nop 0
    v_max_f32 v129, v129, v131
    v_max_f32 v137, v137, v139
    v_max_f32 v145, v145, v147
    v_max_f32 v153, v153, v155
    v_mov_b32 v131, v129
    v_mov_b32 v139, v137
    v_mov_b32 v147, v145
    v_mov_b32 v155, v153
    s_nop 0
    s_nop 0
    s_nop 0
    s_nop 0
    v_permlane32_swap_b32 v129, v131
    v_permlane32_swap_b32 v137, v139
    v_permlane32_swap_b32 v145, v147
    v_permlane32_swap_b32 v153, v155
    s_nop 0
    s_nop 0
    s_nop 0
    s_nop 0
    v_max_f32 v129, v129, v131
    v_max_f32 v137, v137, v139
    v_max_f32 v145, v145, v147
    v_max_f32 v153, v153, v155
    v_sub_f32 v128, v128, v129
    v_sub_f32 v136, v136, v137
    v_sub_f32 v144, v144, v145
    v_sub_f32 v152, v152, v153
    v_sub_f32 v130, v130, v129
    v_sub_f32 v138, v138, v137
    v_sub_f32 v146, v146, v145
    v_sub_f32 v154, v154, v153
    v_sub_f32 v132, v132, v129
    v_sub_f32 v140, v140, v137
    v_sub_f32 v148, v148, v145
    v_sub_f32 v156, v156, v153
    v_sub_f32 v134, v134, v129
    v_sub_f32 v142, v142, v137
    v_sub_f32 v150, v150, v145
    v_sub_f32 v158, v158, v153
    v_mul_f32 v128, s47, v128
    v_mul_f32 v136, s47, v136
    v_mul_f32 v144, s47, v144
    v_mul_f32 v152, s47, v152
    v_mul_f32 v130, s47, v130
    v_mul_f32 v138, s47, v138
    v_mul_f32 v146, s47, v146
    v_mul_f32 v154, s47, v154
    v_mul_f32 v132, s47, v132
    v_mul_f32 v140, s47, v140
    v_mul_f32 v148, s47, v148
    v_mul_f32 v156, s47, v156
    v_mul_f32 v134, s47, v134
    v_mul_f32 v142, s47, v142
    v_mul_f32 v150, s47, v150
    v_mul_f32 v158, s47, v158
    v_exp_f32 v128, v128
    v_exp_f32 v136, v136
    v_exp_f32 v144, v144
    v_exp_f32 v152, v152
    v_exp_f32 v130, v130
    v_exp_f32 v138, v138
    v_exp_f32 v146, v146
    v_exp_f32 v154, v154
    v_exp_f32 v132, v132
    v_exp_f32 v140, v140
    v_exp_f32 v148, v148
    v_exp_f32 v156, v156
    v_exp_f32 v134, v134
    v_exp_f32 v142, v142
    v_exp_f32 v150, v150
    v_exp_f32 v158, v158
    v_add_f32 v129, v128, v130
    v_add_f32 v137, v136, v138
    v_add_f32 v145, v144, v146
    v_add_f32 v153, v152, v154
    v_add_f32 v131, v132, v134
    v_add_f32 v139, v140, v142
    v_add_f32 v147, v148, v150
    v_add_f32 v155, v156, v158
    v_add_f32 v129, v129, v131
    v_add_f32 v137, v137, v139
    v_add_f32 v145, v145, v147
    v_add_f32 v153, v153, v155
    v_mov_b32 v131, v129
    v_mov_b32 v139, v137
    v_mov_b32 v147, v145
    v_mov_b32 v155, v153
    s_nop 0
    s_nop 0
    s_nop 0
    s_nop 0
    v_permlane16_swap_b32 v129, v131
    v_permlane16_swap_b32 v137, v139
    v_permlane16_swap_b32 v145, v147
    v_permlane16_swap_b32 v153, v155
    s_nop 0
    s_nop 0
    s_nop 0
    s_nop 0
    v_add_f32 v129, v129, v131
    v_add_f32 v137, v137, v139
    v_add_f32 v145, v145, v147
    v_add_f32 v153, v153, v155
    v_mov_b32 v131, v129
    v_mov_b32 v139, v137
    v_mov_b32 v147, v145
    v_mov_b32 v155, v153
    s_nop 0
    s_nop 0
    s_nop 0
    s_nop 0
    v_permlane32_swap_b32 v129, v131
    v_permlane32_swap_b32 v137, v139
    v_permlane32_swap_b32 v145, v147
    v_permlane32_swap_b32 v153, v155
    s_nop 0
    s_nop 0
    s_nop 0
    s_nop 0
    v_add_f32 v129, v129, v131
    v_add_f32 v137, v137, v139
    v_add_f32 v145, v145, v147
    v_add_f32 v153, v153, v155
    v_rcp_f32 v129, v129
    v_rcp_f32 v137, v137
    v_rcp_f32 v145, v145
    v_rcp_f32 v153, v153
    s_nop 0
    s_nop 0
    s_nop 0
    s_nop 0
    v_mul_f32 v128, v128, v129
    v_mul_f32 v136, v136, v137
    v_mul_f32 v144, v144, v145
    v_mul_f32 v152, v152, v153
    v_mul_f32 v130, v130, v129
    v_mul_f32 v138, v138, v137
    v_mul_f32 v146, v146, v145
    v_mul_f32 v154, v154, v153
    v_mul_f32 v132, v132, v129
    v_mul_f32 v140, v140, v137
    v_mul_f32 v148, v148, v145
    v_mul_f32 v156, v156, v153
    v_mul_f32 v134, v134, v129
    v_mul_f32 v142, v142, v137
    v_mul_f32 v150, v150, v145
    v_mul_f32 v158, v158, v153
    v_cvt_pk_bf16_f32 v128, v128, v128
    v_cvt_pk_bf16_f32 v136, v136, v136
    v_cvt_pk_bf16_f32 v144, v144, v144
    v_cvt_pk_bf16_f32 v152, v152, v152
    v_cvt_pk_bf16_f32 v130, v130, v130
    v_cvt_pk_bf16_f32 v138, v138, v138
    v_cvt_pk_bf16_f32 v146, v146, v146
    v_cvt_pk_bf16_f32 v154, v154, v154
    v_cvt_pk_bf16_f32 v132, v132, v132
    v_cvt_pk_bf16_f32 v140, v140, v140
    v_cvt_pk_bf16_f32 v148, v148, v148
    v_cvt_pk_bf16_f32 v156, v156, v156
    v_cvt_pk_bf16_f32 v134, v134, v134
    v_cvt_pk_bf16_f32 v142, v142, v142
    v_cvt_pk_bf16_f32 v150, v150, v150
    v_cvt_pk_bf16_f32 v158, v158, v158
    v_and_b32 v112, v128, v97
    v_and_b32 v116, v136, v97
    v_and_b32 v120, v144, v97
    v_and_b32 v124, v152, v97
    v_and_b32 v113, v130, v97
    v_and_b32 v117, v138, v97
    v_and_b32 v121, v146, v97
    v_and_b32 v125, v154, v97
    v_and_b32 v114, v132, v97
    v_and_b32 v118, v140, v97
    v_and_b32 v122, v148, v97
    v_and_b32 v126, v156, v97
    v_and_b32 v115, v134, v97
    v_and_b32 v119, v142, v97
    v_and_b32 v123, v150, v97
    v_and_b32 v127, v158, v97
    s_nop 1
    v_mfma_f32_16x16x32_bf16 v[128:131], v[66:69], v[112:115], 0
    v_mfma_f32_16x16x32_bf16 v[132:135], v[72:75], v[112:115], 0
    v_mfma_f32_16x16x32_bf16 v[136:139], v[72:75], v[116:119], 0
    v_mfma_f32_16x16x32_bf16 v[140:143], v[78:81], v[116:119], 0
    v_mfma_f32_16x16x32_bf16 v[144:147], v[68:71], v[120:123], 0
    v_mfma_f32_16x16x32_bf16 v[148:151], v[74:77], v[120:123], 0
    v_mfma_f32_16x16x32_bf16 v[152:155], v[74:77], v[124:127], 0
    v_mfma_f32_16x16x32_bf16 v[156:159], v[80:83], v[124:127], 0
    s_mul_i32 s26, s25, 20
    s_mul_i32 s27, s22, 10
    s_add_u32 s26, s26, s27
    v_and_b32 v92, 15, v1
    v_lshlrev_b32 v92, 4, v92
    v_add_u32 v88, s26, v93
    v_add_u32 v88, 0, v88
    v_lshrrev_b32 v89, 3, v88
    v_lshl_add_u32 v84, v89, 12, v92
    v_and_b32 v89, 3, v88
    v_lshl_add_u32 v84, v89, 8, v84
    v_bfe_u32 v89, v88, 2, 1
    v_lshl_add_u32 v84, v89, 3, v84
    v_add_u32 v88, s26, v93
    v_add_u32 v88, 4, v88
    v_lshrrev_b32 v89, 3, v88
    v_lshl_add_u32 v85, v89, 12, v92
    v_and_b32 v89, 3, v88
    v_lshl_add_u32 v85, v89, 8, v85
    v_bfe_u32 v89, v88, 2, 1
    v_lshl_add_u32 v85, v89, 3, v85
    v_add_u32 v88, s26, v93
    v_add_u32 v88, 8, v88
    v_lshrrev_b32 v89, 3, v88
    v_lshl_add_u32 v86, v89, 12, v92
    v_and_b32 v89, 3, v88
    v_lshl_add_u32 v86, v89, 8, v86
    v_bfe_u32 v89, v88, 2, 1
    v_lshl_add_u32 v86, v89, 3, v86
    s_nop 7
    v_cvt_pk_bf16_f32 v128, v128, v129
    v_cvt_pk_bf16_f32 v129, v130, v131
    v_cvt_pk_bf16_f32 v132, v132, v133
    v_cvt_pk_bf16_f32 v133, v134, v135
    v_cvt_pk_bf16_f32 v136, v136, v137
    v_cvt_pk_bf16_f32 v137, v138, v139
    v_cvt_pk_bf16_f32 v140, v140, v141
    v_cvt_pk_bf16_f32 v141, v142, v143
    v_cvt_pk_bf16_f32 v144, v144, v145
    v_cvt_pk_bf16_f32 v145, v146, v147
    v_cvt_pk_bf16_f32 v148, v148, v149
    v_cvt_pk_bf16_f32 v149, v150, v151
    v_cvt_pk_bf16_f32 v152, v152, v153
    v_cvt_pk_bf16_f32 v153, v154, v155
    v_cvt_pk_bf16_f32 v156, v156, v157
    v_cvt_pk_bf16_f32 v157, v158, v159
    s_lshl_b32 s26, s24, 3
    s_lshl_b32 s27, s21, 1
    s_add_u32 s26, s26, s27
    s_add_u32 s26, s26, 0
    s_lshr_b32 s27, s26, 2
    s_mul_i32 s27, s27, 303104
    s_and_b32 s26, s26, 3
    s_lshl_b32 s26, s26, 10
    s_add_u32 s48, s26, s27
    buffer_store_dwordx2 v[128:129], v84, s[16:19], s48 offen
    v_cndmask_b32 v136, v136, v132, s[40:41]
    v_cndmask_b32 v137, v137, v133, s[40:41]
    buffer_store_dwordx2 v[136:137], v85, s[16:19], s48 offen
    s_mov_b32 exec_hi, 0
    buffer_store_dwordx2 v[140:141], v86, s[16:19], s48 offen
    s_mov_b32 exec_hi, -1
    s_lshl_b32 s26, s24, 3
    s_lshl_b32 s27, s21, 1
    s_add_u32 s26, s26, s27
    s_add_u32 s26, s26, 1
    s_lshr_b32 s27, s26, 2
    s_mul_i32 s27, s27, 303104
    s_and_b32 s26, s26, 3
    s_lshl_b32 s26, s26, 10
    s_add_u32 s48, s26, s27
    buffer_store_dwordx2 v[144:145], v84, s[16:19], s48 offen
    v_cndmask_b32 v152, v152, v148, s[40:41]
    v_cndmask_b32 v153, v153, v149, s[40:41]
    buffer_store_dwordx2 v[152:153], v85, s[16:19], s48 offen
    s_mov_b32 exec_hi, 0
    buffer_store_dwordx2 v[156:157], v86, s[16:19], s48 offen
    s_mov_b32 exec_hi, -1
    s_endpgm
L_k1_h:
    s_mul_i32 s7, s6, 14
    s_add_u32 s7, s7, s4
    s_sub_u32 s7, s7, 16
    s_lshr_b32 s25, s7, 3
    s_and_b32 s7, s7, 7
    s_lshl_b32 s24, s5, 3
    s_add_u32 s24, s24, s7
    s_lshl_b32 s25, s25, 9
    s_min_u32 s25, s25, 2944
    s_mov_b32 s8, s56
    s_and_b32 s9, s57, 0xffff
    s_mov_b32 s10, 0x21c000
    s_mov_b32 s11, 0x00020000
    s_mov_b32 s23, 0
    v_and_b32 v1, 63, v0
    s_lshl_b32 s26, s24, 3
    s_add_u32 s26, s26, s20
    s_mul_i32 s26, s26, 20480
    v_lshrrev_b32 v204, 4, v1
    v_mul_u32_u24 v204, 1280, v204
    v_and_b32 v205, 15, v1
    v_lshl_add_u32 v204, v205, 4, v204
    v_add_u32 v204, s26, v204
    s_movk_i32 s27, 0
    buffer_load_dwordx4 v[36:39], v204, s[12:15], s27 offen offset:0
    buffer_load_dwordx4 v[40:43], v204, s[12:15], s27 offen offset:256
    buffer_load_dwordx4 v[44:47], v204, s[12:15], s27 offen offset:512
    buffer_load_dwordx4 v[48:51], v204, s[12:15], s27 offen offset:768
    buffer_load_dwordx4 v[52:55], v204, s[12:15], s27 offen offset:1024
    s_movk_i32 s27, 5120
    buffer_load_dwordx4 v[56:59], v204, s[12:15], s27 offen offset:0
    buffer_load_dwordx4 v[60:63], v204, s[12:15], s27 offen offset:256
    buffer_load_dwordx4 v[64:67], v204, s[12:15], s27 offen offset:512
    buffer_load_dwordx4 v[68:71], v204, s[12:15], s27 offen offset:768
    buffer_load_dwordx4 v[72:75], v204, s[12:15], s27 offen offset:1024
    v_and_b32 v1, 63, v0
    v_lshlrev_b32 v2, 4, v1
    s_and_b32 s21, s20, 3
    s_lshr_b32 s22, s20, 2
    s_lshl_b32 s28, s20, 11
    v_lshrrev_b32 v128, 5, v1
    v_and_b32 v129, 31, v1
    s_lshl_b32 s26, s20, 2
    v_add_u32 v130, s26, v128
    v_add_u32 v130, 0, v130
    v_and_b32 v131, 7, v130
    v_lshlrev_b32 v131, 1, v131
    v_xor_b32 v131, v131, v129
    v_and_b32 v132, 0x13, v130
    v_and_b32 v133, 4, v130
    v_lshl_or_b32 v132, v133, 1, v132
    v_and_b32 v133, 8, v130
    v_lshrrev_b32 v133, 1, v133
    v_or_b32 v132, v132, v133
    s_movk_i32 s26, 3456
    v_mul_lo_u32 v132, v132, s26
    v_lshl_add_u32 v132, v131, 4, v132
    v_add_u32 v8, s25, v132
    s_lshl_b32 s26, s20, 2
    v_add_u32 v130, s26, v128
    v_add_u32 v130, 2, v130
    v_and_b32 v131, 7, v130
    v_lshlrev_b32 v131, 1, v131
    v_xor_b32 v131, v131, v129
    v_and_b32 v132, 0x13, v130
    v_and_b32 v133, 4, v130
    v_lshl_or_b32 v132, v133, 1, v132
    v_and_b32 v133, 8, v130
    v_lshrrev_b32 v133, 1, v133
    v_or_b32 v132, v132, v133
    s_movk_i32 s26, 3456
    v_mul_lo_u32 v132, v132, s26
    v_lshl_add_u32 v132, v131, 4, v132
    v_add_u32 v9, s25, v132
    v_lshrrev_b32 v128, 4, v1
    v_bfe_u32 v129, v1, 2, 2
    v_and_b32 v130, 1, v128
    v_lshl_add_u32 v130, v130, 2, v129
    v_lshlrev_b32 v130, 1, v130
    v_lshrrev_b32 v131, 1, v128
    v_lshlrev_b32 v131, 4, v131
    v_lshrrev_b32 v132, 1, v130
    v_add_u32 v131, v131, v132
    v_lshlrev_b32 v131, 9, v131
    v_and_b32 v132, 3, v1
    v_lshlrev_b32 v132, 3, v132
    s_lshl_b32 s26, s22, 8
    s_add_u32 s26, s26, 0
    v_add_u32 v133, s26, v132
    v_lshrrev_b32 v134, 4, v133
    v_xor_b32 v134, v134, v130
    v_and_b32 v133, 8, v133
    v_lshl_add_u32 v133, v134, 4, v133
    v_add_u32 v10, v133, v131
    v_add_u32 v21, 0x10000, v10
    s_lshl_b32 s26, s22, 8
    s_add_u32 s26, s26, 32
    v_add_u32 v133, s26, v132
    v_lshrrev_b32 v134, 4, v133
    v_xor_b32 v134, v134, v130
    v_and_b32 v133, 8, v133
    v_lshl_add_u32 v133, v134, 4, v133
    v_add_u32 v11, v133, v131
    v_add_u32 v22, 0x10000, v11
    s_lshl_b32 s26, s22, 8
    s_add_u32 s26, s26, 64
    v_add_u32 v133, s26, v132
    v_lshrrev_b32 v134, 4, v133
    v_xor_b32 v134, v134, v130
    v_and_b32 v133, 8, v133
    v_lshl_add_u32 v133, v134, 4, v133
    v_add_u32 v12, v133, v131
    v_add_u32 v23, 0x10000, v12
    s_lshl_b32 s26, s22, 8
    s_add_u32 s26, s26, 96
    v_add_u32 v133, s26, v132
    v_lshrrev_b32 v134, 4, v133
    v_xor_b32 v134, v134, v130
    v_and_b32 v133, 8, v133
    v_lshl_add_u32 v133, v134, 4, v133
    v_add_u32 v13, v133, v131
    v_add_u32 v24, 0x10000, v13
    s_lshl_b32 s26, s22, 8
    s_add_u32 s26, s26, 128
    v_add_u32 v133, s26, v132
    v_lshrrev_b32 v134, 4, v133
    v_xor_b32 v134, v134, v130
    v_and_b32 v133, 8, v133
    v_lshl_add_u32 v133, v134, 4, v133
    v_add_u32 v14, v133, v131
    v_add_u32 v25, 0x10000, v14
    s_lshl_b32 s26, s22, 8
    s_add_u32 s26, s26, 160
    v_add_u32 v133, s26, v132
    v_lshrrev_b32 v134, 4, v133
    v_xor_b32 v134, v134, v130
    v_and_b32 v133, 8, v133
    v_lshl_add_u32 v133, v134, 4, v133
    v_add_u32 v15, v133, v131
    v_add_u32 v26, 0x10000, v15
    s_lshl_b32 s26, s22, 8
    s_add_u32 s26, s26, 192
    v_add_u32 v133, s26, v132
    v_lshrrev_b32 v134, 4, v133
    v_xor_b32 v134, v134, v130
    v_and_b32 v133, 8, v133
    v_lshl_add_u32 v133, v134, 4, v133
    v_add_u32 v16, v133, v131
    v_add_u32 v27, 0x10000, v16
    s_lshl_b32 s26, s22, 8
    s_add_u32 s26, s26, 224
    v_add_u32 v133, s26, v132
    v_lshrrev_b32 v134, 4, v133
    v_xor_b32 v134, v134, v130
    v_and_b32 v133, 8, v133
    v_lshl_add_u32 v133, v134, 4, v133
    v_add_u32 v17, v133, v131
    v_add_u32 v28, 0x10000, v17
    v_and_b32 v128, 15, v1
    v_lshrrev_b32 v129, 4, v1
    v_lshrrev_b32 v130, 2, v128
    v_sub_u32 v130, 4, v130
    v_and_b32 v130, 3, v130
    v_xor_b32 v129, v129, v130
    v_lshlrev_b32 v128, 6, v128
    v_lshl_add_u32 v128, v129, 4, v128
    v_add_u32 v33, 0x14000, v128
    s_lshl_b32 s26, s21, 11
    s_add_u32 s26, s26, 0
    v_add_u32 v32, s26, v33
    v_add_u32 v35, 33024, v32
    v_lshrrev_b32 v128, 4, v1
    v_lshlrev_b32 v128, 6, v128
    v_bfe_u32 v129, v1, 2, 2
    v_mul_u32_u24 v129, 8256, v129
    v_add_u32 v128, v128, v129
    s_lshl_b32 s26, s20, 10
    s_add_u32 s26, s26, 0x14000
    v_add_u32 v128, s26, v128
    v_and_b32 v129, 3, v1
    v_xor_b32 v130, 0, v129
    v_lshl_add_u32 v4, v130, 4, v128
    v_add_u32 v4, 0, v4
    v_xor_b32 v130, 3, v129
    v_lshl_add_u32 v5, v130, 4, v128
    v_add_u32 v5, 256, v5
    v_xor_b32 v130, 2, v129
    v_lshl_add_u32 v6, v130, 4, v128
    v_add_u32 v6, 512, v6
    v_xor_b32 v130, 1, v129
    v_lshl_add_u32 v7, v130, 4, v128
    v_add_u32 v7, 768, v7
    s_mov_b32 s64, 0xf000f
    s_mov_b32 s65, 0xf000f
    s_mov_b32 s66, 0xf000f0
    s_mov_b32 s67, 0xf000f0
    s_mov_b32 s68, 0xf000f00
    s_mov_b32 s69, 0xf000f00
    s_mov_b32 s70, 0xf000f000
    s_mov_b32 s71, 0xf000f000
    v_mov_b32 v198, 0x3f803f80
    s_movk_i32 s27, 10240
    buffer_load_dwordx4 v[76:79], v204, s[12:15], s27 offen offset:0
    buffer_load_dwordx4 v[80:83], v204, s[12:15], s27 offen offset:256
    buffer_load_dwordx4 v[84:87], v204, s[12:15], s27 offen offset:512
    buffer_load_dwordx4 v[88:91], v204, s[12:15], s27 offen offset:768
    buffer_load_dwordx4 v[92:95], v204, s[12:15], s27 offen offset:1024
    s_waitcnt vmcnt(10)
    v_dot2_f32_bf16 v128, v36, v198, 0
    v_dot2_f32_bf16 v129, v36, v36, 0
    v_dot2_f32_bf16 v130, v37, v198, 0
    v_dot2_f32_bf16 v131, v37, v37, 0
    v_dot2_f32_bf16 v128, v38, v198, v128
    v_dot2_f32_bf16 v129, v38, v38, v129
    v_dot2_f32_bf16 v130, v39, v198, v130
    v_dot2_f32_bf16 v131, v39, v39, v131
    v_dot2_f32_bf16 v128, v40, v198, v128
    v_dot2_f32_bf16 v129, v40, v40, v129
    v_dot2_f32_bf16 v130, v41, v198, v130
    v_dot2_f32_bf16 v131, v41, v41, v131
    v_dot2_f32_bf16 v128, v42, v198, v128
    v_dot2_f32_bf16 v129, v42, v42, v129
    v_dot2_f32_bf16 v130, v43, v198, v130
    v_dot2_f32_bf16 v131, v43, v43, v131
    v_dot2_f32_bf16 v128, v44, v198, v128
    v_dot2_f32_bf16 v129, v44, v44, v129
    v_dot2_f32_bf16 v130, v45, v198, v130
    v_dot2_f32_bf16 v131, v45, v45, v131
    v_dot2_f32_bf16 v128, v46, v198, v128
    v_dot2_f32_bf16 v129, v46, v46, v129
    v_dot2_f32_bf16 v130, v47, v198, v130
    v_dot2_f32_bf16 v131, v47, v47, v131
    v_dot2_f32_bf16 v128, v48, v198, v128
    v_dot2_f32_bf16 v129, v48, v48, v129
    v_dot2_f32_bf16 v130, v49, v198, v130
    v_dot2_f32_bf16 v131, v49, v49, v131
    v_dot2_f32_bf16 v128, v50, v198, v128
    v_dot2_f32_bf16 v129, v50, v50, v129
    v_dot2_f32_bf16 v130, v51, v198, v130
    v_dot2_f32_bf16 v131, v51, v51, v131
    v_dot2_f32_bf16 v128, v52, v198, v128
    v_dot2_f32_bf16 v129, v52, v52, v129
    v_dot2_f32_bf16 v130, v53, v198, v130
    v_dot2_f32_bf16 v131, v53, v53, v131
    v_dot2_f32_bf16 v128, v54, v198, v128
    v_dot2_f32_bf16 v129, v54, v54, v129
    v_dot2_f32_bf16 v130, v55, v198, v130
    v_dot2_f32_bf16 v131, v55, v55, v131
    s_nop 3
    v_add_f32 v128, v128, v130
    v_add_f32 v129, v129, v131
    s_nop 1
    v_add_f32_dpp v128, v128, v128 row_ror:8 row_mask:0xf bank_mask:0xf
    v_add_f32_dpp v129, v129, v129 row_ror:8 row_mask:0xf bank_mask:0xf
    s_nop 1
    v_add_f32_dpp v128, v128, v128 row_ror:4 row_mask:0xf bank_mask:0xf
    v_add_f32_dpp v129, v129, v129 row_ror:4 row_mask:0xf bank_mask:0xf
    s_nop 1
    v_add_f32_dpp v128, v128, v128 row_ror:2 row_mask:0xf bank_mask:0xf
    v_add_f32_dpp v129, v129, v129 row_ror:2 row_mask:0xf bank_mask:0xf
    s_nop 1
    v_add_f32_dpp v128, v128, v128 row_ror:1 row_mask:0xf bank_mask:0xf
    v_add_f32_dpp v129, v129, v129 row_ror:1 row_mask:0xf bank_mask:0xf
    s_nop 1
    s_mov_b32 s26, 0x3acccccd
    s_mov_b32 s27, 0x3727c5ac
    v_mul_f32 v128, s26, v128
    v_mul_f32 v129, s26, v129
    v_fma_f32 v129, -v128, v128, v129
    v_max_f32 v129, 0, v129
    v_cvt_pk_bf16_f32 v128, 0, v128
    v_cvt_pk_bf16_f32 v129, 0, v129
    v_add_f32 v129, s27, v129
    v_cvt_pk_bf16_f32 v129, 0, v129
    v_sqrt_f32 v129, v129
    s_nop 0
    v_xor_b32 v128, 0x80000000, v128
    v_cvt_pk_bf16_f32 v129, 0, v129
    v_rcp_f32 v140, v129
    s_nop 0
    v_fma_f32 v129, -v129, v140, 2.0
    v_mul_f32 v129, v140, v129
    v_lshlrev_b32 v148, 16, v36
    v_and_b32 v149, 0xffff0000, v36
    v_lshlrev_b32 v150, 16, v37
    v_and_b32 v151, 0xffff0000, v37
    v_lshlrev_b32 v152, 16, v38
    v_and_b32 v153, 0xffff0000, v38
    v_lshlrev_b32 v154, 16, v39
    v_and_b32 v155, 0xffff0000, v39
    v_pk_add_f32 v[148:149], v[148:149], v[128:129] op_sel_hi:[1,0]
    v_pk_add_f32 v[150:151], v[150:151], v[128:129] op_sel_hi:[1,0]
    v_pk_add_f32 v[152:153], v[152:153], v[128:129] op_sel_hi:[1,0]
    v_pk_add_f32 v[154:155], v[154:155], v[128:129] op_sel_hi:[1,0]
    v_cvt_pk_bf16_f32 v148, 0, v148
    v_cvt_pk_bf16_f32 v149, 0, v149
    v_cvt_pk_bf16_f32 v150, 0, v150
    v_cvt_pk_bf16_f32 v151, 0, v151
    v_cvt_pk_bf16_f32 v152, 0, v152
    v_cvt_pk_bf16_f32 v153, 0, v153
    v_cvt_pk_bf16_f32 v154, 0, v154
    v_cvt_pk_bf16_f32 v155, 0, v155
    v_pk_mul_f32 v[148:149], v[148:149], v[128:129] op_sel:[0,1] op_sel_hi:[1,1]
    v_pk_mul_f32 v[150:151], v[150:151], v[128:129] op_sel:[0,1] op_sel_hi:[1,1]
    v_pk_mul_f32 v[152:153], v[152:153], v[128:129] op_sel:[0,1] op_sel_hi:[1,1]
    v_pk_mul_f32 v[154:155], v[154:155], v[128:129] op_sel:[0,1] op_sel_hi:[1,1]
    v_cvt_pk_bf16_f32 v36, v148, v149
    v_cvt_pk_bf16_f32 v37, v150, v151
    v_cvt_pk_bf16_f32 v38, v152, v153
    v_cvt_pk_bf16_f32 v39, v154, v155
    v_lshlrev_b32 v148, 16, v40
    v_and_b32 v149, 0xffff0000, v40
    v_lshlrev_b32 v150, 16, v41
    v_and_b32 v151, 0xffff0000, v41
    v_lshlrev_b32 v152, 16, v42
    v_and_b32 v153, 0xffff0000, v42
    v_lshlrev_b32 v154, 16, v43
    v_and_b32 v155, 0xffff0000, v43
    v_pk_add_f32 v[148:149], v[148:149], v[128:129] op_sel_hi:[1,0]
    v_pk_add_f32 v[150:151], v[150:151], v[128:129] op_sel_hi:[1,0]
    v_pk_add_f32 v[152:153], v[152:153], v[128:129] op_sel_hi:[1,0]
    v_pk_add_f32 v[154:155], v[154:155], v[128:129] op_sel_hi:[1,0]
    v_cvt_pk_bf16_f32 v148, 0, v148
    v_cvt_pk_bf16_f32 v149, 0, v149
    v_cvt_pk_bf16_f32 v150, 0, v150
    v_cvt_pk_bf16_f32 v151, 0, v151
    v_cvt_pk_bf16_f32 v152, 0, v152
    v_cvt_pk_bf16_f32 v153, 0, v153
    v_cvt_pk_bf16_f32 v154, 0, v154
    v_cvt_pk_bf16_f32 v155, 0, v155
    v_pk_mul_f32 v[148:149], v[148:149], v[128:129] op_sel:[0,1] op_sel_hi:[1,1]
    v_pk_mul_f32 v[150:151], v[150:151], v[128:129] op_sel:[0,1] op_sel_hi:[1,1]
    v_pk_mul_f32 v[152:153], v[152:153], v[128:129] op_sel:[0,1] op_sel_hi:[1,1]
    v_pk_mul_f32 v[154:155], v[154:155], v[128:129] op_sel:[0,1] op_sel_hi:[1,1]
    v_cvt_pk_bf16_f32 v40, v148, v149
    v_cvt_pk_bf16_f32 v41, v150, v151
    v_cvt_pk_bf16_f32 v42, v152, v153
    v_cvt_pk_bf16_f32 v43, v154, v155
    v_lshlrev_b32 v148, 16, v44
    v_and_b32 v149, 0xffff0000, v44
    v_lshlrev_b32 v150, 16, v45
    v_and_b32 v151, 0xffff0000, v45
    v_lshlrev_b32 v152, 16, v46
    v_and_b32 v153, 0xffff0000, v46
    v_lshlrev_b32 v154, 16, v47
    v_and_b32 v155, 0xffff0000, v47
    v_pk_add_f32 v[148:149], v[148:149], v[128:129] op_sel_hi:[1,0]
    v_pk_add_f32 v[150:151], v[150:151], v[128:129] op_sel_hi:[1,0]
    v_pk_add_f32 v[152:153], v[152:153], v[128:129] op_sel_hi:[1,0]
    v_pk_add_f32 v[154:155], v[154:155], v[128:129] op_sel_hi:[1,0]
    v_cvt_pk_bf16_f32 v148, 0, v148
    v_cvt_pk_bf16_f32 v149, 0, v149
    v_cvt_pk_bf16_f32 v150, 0, v150
    v_cvt_pk_bf16_f32 v151, 0, v151
    v_cvt_pk_bf16_f32 v152, 0, v152
    v_cvt_pk_bf16_f32 v153, 0, v153
    v_cvt_pk_bf16_f32 v154, 0, v154
    v_cvt_pk_bf16_f32 v155, 0, v155
    v_pk_mul_f32 v[148:149], v[148:149], v[128:129] op_sel:[0,1] op_sel_hi:[1,1]
    v_pk_mul_f32 v[150:151], v[150:151], v[128:129] op_sel:[0,1] op_sel_hi:[1,1]
    v_pk_mul_f32 v[152:153], v[152:153], v[128:129] op_sel:[0,1] op_sel_hi:[1,1]
    v_pk_mul_f32 v[154:155], v[154:155], v[128:129] op_sel:[0,1] op_sel_hi:[1,1]
    v_cvt_pk_bf16_f32 v44, v148, v149
    v_cvt_pk_bf16_f32 v45, v150, v151
    v_cvt_pk_bf16_f32 v46, v152, v153
    v_cvt_pk_bf16_f32 v47, v154, v155
    v_lshlrev_b32 v148, 16, v48
    v_and_b32 v149, 0xffff0000, v48
    v_lshlrev_b32 v150, 16, v49
    v_and_b32 v151, 0xffff0000, v49
    v_lshlrev_b32 v152, 16, v50
    v_and_b32 v153, 0xffff0000, v50
    v_lshlrev_b32 v154, 16, v51
    v_and_b32 v155, 0xffff0000, v51
    v_pk_add_f32 v[148:149], v[148:149], v[128:129] op_sel_hi:[1,0]
    v_pk_add_f32 v[150:151], v[150:151], v[128:129] op_sel_hi:[1,0]
    v_pk_add_f32 v[152:153], v[152:153], v[128:129] op_sel_hi:[1,0]
    v_pk_add_f32 v[154:155], v[154:155], v[128:129] op_sel_hi:[1,0]
    v_cvt_pk_bf16_f32 v148, 0, v148
    v_cvt_pk_bf16_f32 v149, 0, v149
    v_cvt_pk_bf16_f32 v150, 0, v150
    v_cvt_pk_bf16_f32 v151, 0, v151
    v_cvt_pk_bf16_f32 v152, 0, v152
    v_cvt_pk_bf16_f32 v153, 0, v153
    v_cvt_pk_bf16_f32 v154, 0, v154
    v_cvt_pk_bf16_f32 v155, 0, v155
    v_pk_mul_f32 v[148:149], v[148:149], v[128:129] op_sel:[0,1] op_sel_hi:[1,1]
    v_pk_mul_f32 v[150:151], v[150:151], v[128:129] op_sel:[0,1] op_sel_hi:[1,1]
    v_pk_mul_f32 v[152:153], v[152:153], v[128:129] op_sel:[0,1] op_sel_hi:[1,1]
    v_pk_mul_f32 v[154:155], v[154:155], v[128:129] op_sel:[0,1] op_sel_hi:[1,1]
    v_cvt_pk_bf16_f32 v48, v148, v149
    v_cvt_pk_bf16_f32 v49, v150, v151
    v_cvt_pk_bf16_f32 v50, v152, v153
    v_cvt_pk_bf16_f32 v51, v154, v155
    v_lshlrev_b32 v148, 16, v52
    v_and_b32 v149, 0xffff0000, v52
    v_lshlrev_b32 v150, 16, v53
    v_and_b32 v151, 0xffff0000, v53
    v_lshlrev_b32 v152, 16, v54
    v_and_b32 v153, 0xffff0000, v54
    v_lshlrev_b32 v154, 16, v55
    v_and_b32 v155, 0xffff0000, v55
    v_pk_add_f32 v[148:149], v[148:149], v[128:129] op_sel_hi:[1,0]
    v_pk_add_f32 v[150:151], v[150:151], v[128:129] op_sel_hi:[1,0]
    v_pk_add_f32 v[152:153], v[152:153], v[128:129] op_sel_hi:[1,0]
    v_pk_add_f32 v[154:155], v[154:155], v[128:129] op_sel_hi:[1,0]
    v_cvt_pk_bf16_f32 v148, 0, v148
    v_cvt_pk_bf16_f32 v149, 0, v149
    v_cvt_pk_bf16_f32 v150, 0, v150
    v_cvt_pk_bf16_f32 v151, 0, v151
    v_cvt_pk_bf16_f32 v152, 0, v152
    v_cvt_pk_bf16_f32 v153, 0, v153
    v_cvt_pk_bf16_f32 v154, 0, v154
    v_cvt_pk_bf16_f32 v155, 0, v155
    v_pk_mul_f32 v[148:149], v[148:149], v[128:129] op_sel:[0,1] op_sel_hi:[1,1]
    v_pk_mul_f32 v[150:151], v[150:151], v[128:129] op_sel:[0,1] op_sel_hi:[1,1]
    v_pk_mul_f32 v[152:153], v[152:153], v[128:129] op_sel:[0,1] op_sel_hi:[1,1]
    v_pk_mul_f32 v[154:155], v[154:155], v[128:129] op_sel:[0,1] op_sel_hi:[1,1]
    v_cvt_pk_bf16_f32 v52, v148, v149
    v_cvt_pk_bf16_f32 v53, v150, v151
    v_cvt_pk_bf16_f32 v54, v152, v153
    v_cvt_pk_bf16_f32 v55, v154, v155
    s_movk_i32 s27, 15360
    buffer_load_dwordx4 v[96:99], v204, s[12:15], s27 offen offset:0
    buffer_load_dwordx4 v[100:103], v204, s[12:15], s27 offen offset:256
    buffer_load_dwordx4 v[104:107], v204, s[12:15], s27 offen offset:512
    buffer_load_dwordx4 v[108:111], v204, s[12:15], s27 offen offset:768
    buffer_load_dwordx4 v[112:115], v204, s[12:15], s27 offen offset:1024
    s_waitcnt vmcnt(10)
    v_dot2_f32_bf16 v128, v56, v198, 0
    v_dot2_f32_bf16 v129, v56, v56, 0
    v_dot2_f32_bf16 v130, v57, v198, 0
    v_dot2_f32_bf16 v131, v57, v57, 0
    v_dot2_f32_bf16 v128, v58, v198, v128
    v_dot2_f32_bf16 v129, v58, v58, v129
    v_dot2_f32_bf16 v130, v59, v198, v130
    v_dot2_f32_bf16 v131, v59, v59, v131
    v_dot2_f32_bf16 v128, v60, v198, v128
    v_dot2_f32_bf16 v129, v60, v60, v129
    v_dot2_f32_bf16 v130, v61, v198, v130
    v_dot2_f32_bf16 v131, v61, v61, v131
    v_dot2_f32_bf16 v128, v62, v198, v128
    v_dot2_f32_bf16 v129, v62, v62, v129
    v_dot2_f32_bf16 v130, v63, v198, v130
    v_dot2_f32_bf16 v131, v63, v63, v131
    v_dot2_f32_bf16 v128, v64, v198, v128
    v_dot2_f32_bf16 v129, v64, v64, v129
    v_dot2_f32_bf16 v130, v65, v198, v130
    v_dot2_f32_bf16 v131, v65, v65, v131
    v_dot2_f32_bf16 v128, v66, v198, v128
    v_dot2_f32_bf16 v129, v66, v66, v129
    v_dot2_f32_bf16 v130, v67, v198, v130
    v_dot2_f32_bf16 v131, v67, v67, v131
    v_dot2_f32_bf16 v128, v68, v198, v128
    v_dot2_f32_bf16 v129, v68, v68, v129
    v_dot2_f32_bf16 v130, v69, v198, v130
    v_dot2_f32_bf16 v131, v69, v69, v131
    v_dot2_f32_bf16 v128, v70, v198, v128
    v_dot2_f32_bf16 v129, v70, v70, v129
    v_dot2_f32_bf16 v130, v71, v198, v130
    v_dot2_f32_bf16 v131, v71, v71, v131
    v_dot2_f32_bf16 v128, v72, v198, v128
    v_dot2_f32_bf16 v129, v72, v72, v129
    v_dot2_f32_bf16 v130, v73, v198, v130
    v_dot2_f32_bf16 v131, v73, v73, v131
    v_dot2_f32_bf16 v128, v74, v198, v128
    v_dot2_f32_bf16 v129, v74, v74, v129
    v_dot2_f32_bf16 v130, v75, v198, v130
    v_dot2_f32_bf16 v131, v75, v75, v131
    s_nop 3
    v_add_f32 v128, v128, v130
    v_add_f32 v129, v129, v131
    s_nop 1
    v_add_f32_dpp v128, v128, v128 row_ror:8 row_mask:0xf bank_mask:0xf
    v_add_f32_dpp v129, v129, v129 row_ror:8 row_mask:0xf bank_mask:0xf
    s_nop 1
    v_add_f32_dpp v128, v128, v128 row_ror:4 row_mask:0xf bank_mask:0xf
    v_add_f32_dpp v129, v129, v129 row_ror:4 row_mask:0xf bank_mask:0xf
    s_nop 1
    v_add_f32_dpp v128, v128, v128 row_ror:2 row_mask:0xf bank_mask:0xf
    v_add_f32_dpp v129, v129, v129 row_ror:2 row_mask:0xf bank_mask:0xf
    s_nop 1
    v_add_f32_dpp v128, v128, v128 row_ror:1 row_mask:0xf bank_mask:0xf
    v_add_f32_dpp v129, v129, v129 row_ror:1 row_mask:0xf bank_mask:0xf
    s_nop 1
    s_mov_b32 s26, 0x3acccccd
    s_mov_b32 s27, 0x3727c5ac
    v_mul_f32 v128, s26, v128
    v_mul_f32 v129, s26, v129
    v_fma_f32 v129, -v128, v128, v129
    v_max_f32 v129, 0, v129
    v_cvt_pk_bf16_f32 v128, 0, v128
    v_cvt_pk_bf16_f32 v129, 0, v129
    v_add_f32 v129, s27, v129
    v_cvt_pk_bf16_f32 v129, 0, v129
    v_sqrt_f32 v129, v129
    s_nop 0
    v_xor_b32 v128, 0x80000000, v128
    v_cvt_pk_bf16_f32 v129, 0, v129
    v_rcp_f32 v140, v129
    s_nop 0
    v_fma_f32 v129, -v129, v140, 2.0
    v_mul_f32 v129, v140, v129
    v_lshlrev_b32 v148, 16, v56
    v_and_b32 v149, 0xffff0000, v56
    v_lshlrev_b32 v150, 16, v57
    v_and_b32 v151, 0xffff0000, v57
    v_lshlrev_b32 v152, 16, v58
    v_and_b32 v153, 0xffff0000, v58
    v_lshlrev_b32 v154, 16, v59
    v_and_b32 v155, 0xffff0000, v59
    v_pk_add_f32 v[148:149], v[148:149], v[128:129] op_sel_hi:[1,0]
    v_pk_add_f32 v[150:151], v[150:151], v[128:129] op_sel_hi:[1,0]
    v_pk_add_f32 v[152:153], v[152:153], v[128:129] op_sel_hi:[1,0]
    v_pk_add_f32 v[154:155], v[154:155], v[128:129] op_sel_hi:[1,0]
    v_cvt_pk_bf16_f32 v148, 0, v148
    v_cvt_pk_bf16_f32 v149, 0, v149
    v_cvt_pk_bf16_f32 v150, 0, v150
    v_cvt_pk_bf16_f32 v151, 0, v151
    v_cvt_pk_bf16_f32 v152, 0, v152
    v_cvt_pk_bf16_f32 v153, 0, v153
    v_cvt_pk_bf16_f32 v154, 0, v154
    v_cvt_pk_bf16_f32 v155, 0, v155
    v_pk_mul_f32 v[148:149], v[148:149], v[128:129] op_sel:[0,1] op_sel_hi:[1,1]
    v_pk_mul_f32 v[150:151], v[150:151], v[128:129] op_sel:[0,1] op_sel_hi:[1,1]
    v_pk_mul_f32 v[152:153], v[152:153], v[128:129] op_sel:[0,1] op_sel_hi:[1,1]
    v_pk_mul_f32 v[154:155], v[154:155], v[128:129] op_sel:[0,1] op_sel_hi:[1,1]
    v_cvt_pk_bf16_f32 v56, v148, v149
    v_cvt_pk_bf16_f32 v57, v150, v151
    v_cvt_pk_bf16_f32 v58, v152, v153
    v_cvt_pk_bf16_f32 v59, v154, v155
    v_lshlrev_b32 v148, 16, v60
    v_and_b32 v149, 0xffff0000, v60
    v_lshlrev_b32 v150, 16, v61
    v_and_b32 v151, 0xffff0000, v61
    v_lshlrev_b32 v152, 16, v62
    v_and_b32 v153, 0xffff0000, v62
    v_lshlrev_b32 v154, 16, v63
    v_and_b32 v155, 0xffff0000, v63
    v_pk_add_f32 v[148:149], v[148:149], v[128:129] op_sel_hi:[1,0]
    v_pk_add_f32 v[150:151], v[150:151], v[128:129] op_sel_hi:[1,0]
    v_pk_add_f32 v[152:153], v[152:153], v[128:129] op_sel_hi:[1,0]
    v_pk_add_f32 v[154:155], v[154:155], v[128:129] op_sel_hi:[1,0]
    v_cvt_pk_bf16_f32 v148, 0, v148
    v_cvt_pk_bf16_f32 v149, 0, v149
    v_cvt_pk_bf16_f32 v150, 0, v150
    v_cvt_pk_bf16_f32 v151, 0, v151
    v_cvt_pk_bf16_f32 v152, 0, v152
    v_cvt_pk_bf16_f32 v153, 0, v153
    v_cvt_pk_bf16_f32 v154, 0, v154
    v_cvt_pk_bf16_f32 v155, 0, v155
    v_pk_mul_f32 v[148:149], v[148:149], v[128:129] op_sel:[0,1] op_sel_hi:[1,1]
    v_pk_mul_f32 v[150:151], v[150:151], v[128:129] op_sel:[0,1] op_sel_hi:[1,1]
    v_pk_mul_f32 v[152:153], v[152:153], v[128:129] op_sel:[0,1] op_sel_hi:[1,1]
    v_pk_mul_f32 v[154:155], v[154:155], v[128:129] op_sel:[0,1] op_sel_hi:[1,1]
    v_cvt_pk_bf16_f32 v60, v148, v149
    v_cvt_pk_bf16_f32 v61, v150, v151
    v_cvt_pk_bf16_f32 v62, v152, v153
    v_cvt_pk_bf16_f32 v63, v154, v155
    v_lshlrev_b32 v148, 16, v64
    v_and_b32 v149, 0xffff0000, v64
    v_lshlrev_b32 v150, 16, v65
    v_and_b32 v151, 0xffff0000, v65
    v_lshlrev_b32 v152, 16, v66
    v_and_b32 v153, 0xffff0000, v66
    v_lshlrev_b32 v154, 16, v67
    v_and_b32 v155, 0xffff0000, v67
    v_pk_add_f32 v[148:149], v[148:149], v[128:129] op_sel_hi:[1,0]
    v_pk_add_f32 v[150:151], v[150:151], v[128:129] op_sel_hi:[1,0]
    v_pk_add_f32 v[152:153], v[152:153], v[128:129] op_sel_hi:[1,0]
    v_pk_add_f32 v[154:155], v[154:155], v[128:129] op_sel_hi:[1,0]
    v_cvt_pk_bf16_f32 v148, 0, v148
    v_cvt_pk_bf16_f32 v149, 0, v149
    v_cvt_pk_bf16_f32 v150, 0, v150
    v_cvt_pk_bf16_f32 v151, 0, v151
    v_cvt_pk_bf16_f32 v152, 0, v152
    v_cvt_pk_bf16_f32 v153, 0, v153
    v_cvt_pk_bf16_f32 v154, 0, v154
    v_cvt_pk_bf16_f32 v155, 0, v155
    v_pk_mul_f32 v[148:149], v[148:149], v[128:129] op_sel:[0,1] op_sel_hi:[1,1]
    v_pk_mul_f32 v[150:151], v[150:151], v[128:129] op_sel:[0,1] op_sel_hi:[1,1]
    v_pk_mul_f32 v[152:153], v[152:153], v[128:129] op_sel:[0,1] op_sel_hi:[1,1]
    v_pk_mul_f32 v[154:155], v[154:155], v[128:129] op_sel:[0,1] op_sel_hi:[1,1]
    v_cvt_pk_bf16_f32 v64, v148, v149
    v_cvt_pk_bf16_f32 v65, v150, v151
    v_cvt_pk_bf16_f32 v66, v152, v153
    v_cvt_pk_bf16_f32 v67, v154, v155
    v_lshlrev_b32 v148, 16, v68
    v_and_b32 v149, 0xffff0000, v68
    v_lshlrev_b32 v150, 16, v69
    v_and_b32 v151, 0xffff0000, v69
    v_lshlrev_b32 v152, 16, v70
    v_and_b32 v153, 0xffff0000, v70
    v_lshlrev_b32 v154, 16, v71
    v_and_b32 v155, 0xffff0000, v71
    v_pk_add_f32 v[148:149], v[148:149], v[128:129] op_sel_hi:[1,0]
    v_pk_add_f32 v[150:151], v[150:151], v[128:129] op_sel_hi:[1,0]
    v_pk_add_f32 v[152:153], v[152:153], v[128:129] op_sel_hi:[1,0]
    v_pk_add_f32 v[154:155], v[154:155], v[128:129] op_sel_hi:[1,0]
    v_cvt_pk_bf16_f32 v148, 0, v148
    v_cvt_pk_bf16_f32 v149, 0, v149
    v_cvt_pk_bf16_f32 v150, 0, v150
    v_cvt_pk_bf16_f32 v151, 0, v151
    v_cvt_pk_bf16_f32 v152, 0, v152
    v_cvt_pk_bf16_f32 v153, 0, v153
    v_cvt_pk_bf16_f32 v154, 0, v154
    v_cvt_pk_bf16_f32 v155, 0, v155
    v_pk_mul_f32 v[148:149], v[148:149], v[128:129] op_sel:[0,1] op_sel_hi:[1,1]
    v_pk_mul_f32 v[150:151], v[150:151], v[128:129] op_sel:[0,1] op_sel_hi:[1,1]
    v_pk_mul_f32 v[152:153], v[152:153], v[128:129] op_sel:[0,1] op_sel_hi:[1,1]
    v_pk_mul_f32 v[154:155], v[154:155], v[128:129] op_sel:[0,1] op_sel_hi:[1,1]
    v_cvt_pk_bf16_f32 v68, v148, v149
    v_cvt_pk_bf16_f32 v69, v150, v151
    v_cvt_pk_bf16_f32 v70, v152, v153
    v_cvt_pk_bf16_f32 v71, v154, v155
    v_lshlrev_b32 v148, 16, v72
    v_and_b32 v149, 0xffff0000, v72
    v_lshlrev_b32 v150, 16, v73
    v_and_b32 v151, 0xffff0000, v73
    v_lshlrev_b32 v152, 16, v74
    v_and_b32 v153, 0xffff0000, v74
    v_lshlrev_b32 v154, 16, v75
    v_and_b32 v155, 0xffff0000, v75
    v_pk_add_f32 v[148:149], v[148:149], v[128:129] op_sel_hi:[1,0]
    v_pk_add_f32 v[150:151], v[150:151], v[128:129] op_sel_hi:[1,0]
    v_pk_add_f32 v[152:153], v[152:153], v[128:129] op_sel_hi:[1,0]
    v_pk_add_f32 v[154:155], v[154:155], v[128:129] op_sel_hi:[1,0]
    v_cvt_pk_bf16_f32 v148, 0, v148
    v_cvt_pk_bf16_f32 v149, 0, v149
    v_cvt_pk_bf16_f32 v150, 0, v150
    v_cvt_pk_bf16_f32 v151, 0, v151
    v_cvt_pk_bf16_f32 v152, 0, v152
    v_cvt_pk_bf16_f32 v153, 0, v153
    v_cvt_pk_bf16_f32 v154, 0, v154
    v_cvt_pk_bf16_f32 v155, 0, v155
    v_pk_mul_f32 v[148:149], v[148:149], v[128:129] op_sel:[0,1] op_sel_hi:[1,1]
    v_pk_mul_f32 v[150:151], v[150:151], v[128:129] op_sel:[0,1] op_sel_hi:[1,1]
    v_pk_mul_f32 v[152:153], v[152:153], v[128:129] op_sel:[0,1] op_sel_hi:[1,1]
    v_pk_mul_f32 v[154:155], v[154:155], v[128:129] op_sel:[0,1] op_sel_hi:[1,1]
    v_cvt_pk_bf16_f32 v72, v148, v149
    v_cvt_pk_bf16_f32 v73, v150, v151
    v_cvt_pk_bf16_f32 v74, v152, v153
    v_cvt_pk_bf16_f32 v75, v154, v155
    s_add_u32 m0, s28, 0x0
    s_nop 0
    buffer_load_dwordx4 v8, s[8:11], s23 offen lds
    s_add_u32 m0, s28, 0x400
    s_nop 0
    buffer_load_dwordx4 v9, s[8:11], s23 offen lds
    s_add_u32 s23, s23, 110592
    s_add_u32 m0, s28, 0x4000
    s_nop 0
    buffer_load_dwordx4 v8, s[8:11], s23 offen lds
    s_add_u32 m0, s28, 0x4400
    s_nop 0
    buffer_load_dwordx4 v9, s[8:11], s23 offen lds
    s_add_u32 s23, s23, 110592
    s_add_u32 m0, s28, 0x8000
    s_nop 0
    buffer_load_dwordx4 v8, s[8:11], s23 offen lds
    s_add_u32 m0, s28, 0x8400
    s_nop 0
    buffer_load_dwordx4 v9, s[8:11], s23 offen lds
    s_add_u32 s23, s23, 110592
    s_add_u32 m0, s28, 0xc000
    s_nop 0
    buffer_load_dwordx4 v8, s[8:11], s23 offen lds
    s_add_u32 m0, s28, 0xc400
    s_nop 0
    buffer_load_dwordx4 v9, s[8:11], s23 offen lds
    s_add_u32 s23, s23, 110592
    s_waitcnt vmcnt(13)
    v_dot2_f32_bf16 v128, v76, v198, 0
    v_dot2_f32_bf16 v129, v76, v76, 0
    v_dot2_f32_bf16 v130, v77, v198, 0
    v_dot2_f32_bf16 v131, v77, v77, 0
    v_dot2_f32_bf16 v128, v78, v198, v128
    v_dot2_f32_bf16 v129, v78, v78, v129
    v_dot2_f32_bf16 v130, v79, v198, v130
    v_dot2_f32_bf16 v131, v79, v79, v131
    v_dot2_f32_bf16 v128, v80, v198, v128
    v_dot2_f32_bf16 v129, v80, v80, v129
    v_dot2_f32_bf16 v130, v81, v198, v130
    v_dot2_f32_bf16 v131, v81, v81, v131
    v_dot2_f32_bf16 v128, v82, v198, v128
    v_dot2_f32_bf16 v129, v82, v82, v129
    v_dot2_f32_bf16 v130, v83, v198, v130
    v_dot2_f32_bf16 v131, v83, v83, v131
    v_dot2_f32_bf16 v128, v84, v198, v128
    v_dot2_f32_bf16 v129, v84, v84, v129
    v_dot2_f32_bf16 v130, v85, v198, v130
    v_dot2_f32_bf16 v131, v85, v85, v131
    v_dot2_f32_bf16 v128, v86, v198, v128
    v_dot2_f32_bf16 v129, v86, v86, v129
    v_dot2_f32_bf16 v130, v87, v198, v130
    v_dot2_f32_bf16 v131, v87, v87, v131
    v_dot2_f32_bf16 v128, v88, v198, v128
    v_dot2_f32_bf16 v129, v88, v88, v129
    v_dot2_f32_bf16 v130, v89, v198, v130
    v_dot2_f32_bf16 v131, v89, v89, v131
    v_dot2_f32_bf16 v128, v90, v198, v128
    v_dot2_f32_bf16 v129, v90, v90, v129
    v_dot2_f32_bf16 v130, v91, v198, v130
    v_dot2_f32_bf16 v131, v91, v91, v131
    v_dot2_f32_bf16 v128, v92, v198, v128
    v_dot2_f32_bf16 v129, v92, v92, v129
    v_dot2_f32_bf16 v130, v93, v198, v130
    v_dot2_f32_bf16 v131, v93, v93, v131
    v_dot2_f32_bf16 v128, v94, v198, v128
    v_dot2_f32_bf16 v129, v94, v94, v129
    v_dot2_f32_bf16 v130, v95, v198, v130
    v_dot2_f32_bf16 v131, v95, v95, v131
    s_nop 3
    v_add_f32 v128, v128, v130
    v_add_f32 v129, v129, v131
    s_nop 1
    v_add_f32_dpp v128, v128, v128 row_ror:8 row_mask:0xf bank_mask:0xf
    v_add_f32_dpp v129, v129, v129 row_ror:8 row_mask:0xf bank_mask:0xf
    s_nop 1
    v_add_f32_dpp v128, v128, v128 row_ror:4 row_mask:0xf bank_mask:0xf
    v_add_f32_dpp v129, v129, v129 row_ror:4 row_mask:0xf bank_mask:0xf
    s_nop 1
    v_add_f32_dpp v128, v128, v128 row_ror:2 row_mask:0xf bank_mask:0xf
    v_add_f32_dpp v129, v129, v129 row_ror:2 row_mask:0xf bank_mask:0xf
    s_nop 1
    v_add_f32_dpp v128, v128, v128 row_ror:1 row_mask:0xf bank_mask:0xf
    v_add_f32_dpp v129, v129, v129 row_ror:1 row_mask:0xf bank_mask:0xf
    s_nop 1
    s_mov_b32 s26, 0x3acccccd
    s_mov_b32 s27, 0x3727c5ac
    v_mul_f32 v128, s26, v128
    v_mul_f32 v129, s26, v129
    v_fma_f32 v129, -v128, v128, v129
    v_max_f32 v129, 0, v129
    v_cvt_pk_bf16_f32 v128, 0, v128
    v_cvt_pk_bf16_f32 v129, 0, v129
    v_add_f32 v129, s27, v129
    v_cvt_pk_bf16_f32 v129, 0, v129
    v_sqrt_f32 v129, v129
    s_nop 0
    v_xor_b32 v128, 0x80000000, v128
    v_cvt_pk_bf16_f32 v129, 0, v129
    v_rcp_f32 v140, v129
    s_nop 0
    v_fma_f32 v129, -v129, v140, 2.0
    v_mul_f32 v129, v140, v129
    v_lshlrev_b32 v148, 16, v76
    v_and_b32 v149, 0xffff0000, v76
    v_lshlrev_b32 v150, 16, v77
    v_and_b32 v151, 0xffff0000, v77
    v_lshlrev_b32 v152, 16, v78
    v_and_b32 v153, 0xffff0000, v78
    v_lshlrev_b32 v154, 16, v79
    v_and_b32 v155, 0xffff0000, v79
    v_pk_add_f32 v[148:149], v[148:149], v[128:129] op_sel_hi:[1,0]
    v_pk_add_f32 v[150:151], v[150:151], v[128:129] op_sel_hi:[1,0]
    v_pk_add_f32 v[152:153], v[152:153], v[128:129] op_sel_hi:[1,0]
    v_pk_add_f32 v[154:155], v[154:155], v[128:129] op_sel_hi:[1,0]
    v_cvt_pk_bf16_f32 v148, 0, v148
    v_cvt_pk_bf16_f32 v149, 0, v149
    v_cvt_pk_bf16_f32 v150, 0, v150
    v_cvt_pk_bf16_f32 v151, 0, v151
    v_cvt_pk_bf16_f32 v152, 0, v152
    v_cvt_pk_bf16_f32 v153, 0, v153
    v_cvt_pk_bf16_f32 v154, 0, v154
    v_cvt_pk_bf16_f32 v155, 0, v155
    v_pk_mul_f32 v[148:149], v[148:149], v[128:129] op_sel:[0,1] op_sel_hi:[1,1]
    v_pk_mul_f32 v[150:151], v[150:151], v[128:129] op_sel:[0,1] op_sel_hi:[1,1]
    v_pk_mul_f32 v[152:153], v[152:153], v[128:129] op_sel:[0,1] op_sel_hi:[1,1]
    v_pk_mul_f32 v[154:155], v[154:155], v[128:129] op_sel:[0,1] op_sel_hi:[1,1]
    v_cvt_pk_bf16_f32 v76, v148, v149
    v_cvt_pk_bf16_f32 v77, v150, v151
    v_cvt_pk_bf16_f32 v78, v152, v153
    v_cvt_pk_bf16_f32 v79, v154, v155
    v_lshlrev_b32 v148, 16, v80
    v_and_b32 v149, 0xffff0000, v80
    v_lshlrev_b32 v150, 16, v81
    v_and_b32 v151, 0xffff0000, v81
    v_lshlrev_b32 v152, 16, v82
    v_and_b32 v153, 0xffff0000, v82
    v_lshlrev_b32 v154, 16, v83
    v_and_b32 v155, 0xffff0000, v83
    v_pk_add_f32 v[148:149], v[148:149], v[128:129] op_sel_hi:[1,0]
    v_pk_add_f32 v[150:151], v[150:151], v[128:129] op_sel_hi:[1,0]
    v_pk_add_f32 v[152:153], v[152:153], v[128:129] op_sel_hi:[1,0]
    v_pk_add_f32 v[154:155], v[154:155], v[128:129] op_sel_hi:[1,0]
    v_cvt_pk_bf16_f32 v148, 0, v148
    v_cvt_pk_bf16_f32 v149, 0, v149
    v_cvt_pk_bf16_f32 v150, 0, v150
    v_cvt_pk_bf16_f32 v151, 0, v151
    v_cvt_pk_bf16_f32 v152, 0, v152
    v_cvt_pk_bf16_f32 v153, 0, v153
    v_cvt_pk_bf16_f32 v154, 0, v154
    v_cvt_pk_bf16_f32 v155, 0, v155
    v_pk_mul_f32 v[148:149], v[148:149], v[128:129] op_sel:[0,1] op_sel_hi:[1,1]
    v_pk_mul_f32 v[150:151], v[150:151], v[128:129] op_sel:[0,1] op_sel_hi:[1,1]
    v_pk_mul_f32 v[152:153], v[152:153], v[128:129] op_sel:[0,1] op_sel_hi:[1,1]
    v_pk_mul_f32 v[154:155], v[154:155], v[128:129] op_sel:[0,1] op_sel_hi:[1,1]
    v_cvt_pk_bf16_f32 v80, v148, v149
    v_cvt_pk_bf16_f32 v81, v150, v151
    v_cvt_pk_bf16_f32 v82, v152, v153
    v_cvt_pk_bf16_f32 v83, v154, v155
    v_lshlrev_b32 v148, 16, v84
    v_and_b32 v149, 0xffff0000, v84
    v_lshlrev_b32 v150, 16, v85
    v_and_b32 v151, 0xffff0000, v85
    v_lshlrev_b32 v152, 16, v86
    v_and_b32 v153, 0xffff0000, v86
    v_lshlrev_b32 v154, 16, v87
    v_and_b32 v155, 0xffff0000, v87
    v_pk_add_f32 v[148:149], v[148:149], v[128:129] op_sel_hi:[1,0]
    v_pk_add_f32 v[150:151], v[150:151], v[128:129] op_sel_hi:[1,0]
    v_pk_add_f32 v[152:153], v[152:153], v[128:129] op_sel_hi:[1,0]
    v_pk_add_f32 v[154:155], v[154:155], v[128:129] op_sel_hi:[1,0]
    v_cvt_pk_bf16_f32 v148, 0, v148
    v_cvt_pk_bf16_f32 v149, 0, v149
    v_cvt_pk_bf16_f32 v150, 0, v150
    v_cvt_pk_bf16_f32 v151, 0, v151
    v_cvt_pk_bf16_f32 v152, 0, v152
    v_cvt_pk_bf16_f32 v153, 0, v153
    v_cvt_pk_bf16_f32 v154, 0, v154
    v_cvt_pk_bf16_f32 v155, 0, v155
    v_pk_mul_f32 v[148:149], v[148:149], v[128:129] op_sel:[0,1] op_sel_hi:[1,1]
    v_pk_mul_f32 v[150:151], v[150:151], v[128:129] op_sel:[0,1] op_sel_hi:[1,1]
    v_pk_mul_f32 v[152:153], v[152:153], v[128:129] op_sel:[0,1] op_sel_hi:[1,1]
    v_pk_mul_f32 v[154:155], v[154:155], v[128:129] op_sel:[0,1] op_sel_hi:[1,1]
    v_cvt_pk_bf16_f32 v84, v148, v149
    v_cvt_pk_bf16_f32 v85, v150, v151
    v_cvt_pk_bf16_f32 v86, v152, v153
    v_cvt_pk_bf16_f32 v87, v154, v155
    v_lshlrev_b32 v148, 16, v88
    v_and_b32 v149, 0xffff0000, v88
    v_lshlrev_b32 v150, 16, v89
    v_and_b32 v151, 0xffff0000, v89
    v_lshlrev_b32 v152, 16, v90
    v_and_b32 v153, 0xffff0000, v90
    v_lshlrev_b32 v154, 16, v91
    v_and_b32 v155, 0xffff0000, v91
    v_pk_add_f32 v[148:149], v[148:149], v[128:129] op_sel_hi:[1,0]
    v_pk_add_f32 v[150:151], v[150:151], v[128:129] op_sel_hi:[1,0]
    v_pk_add_f32 v[152:153], v[152:153], v[128:129] op_sel_hi:[1,0]
    v_pk_add_f32 v[154:155], v[154:155], v[128:129] op_sel_hi:[1,0]
    v_cvt_pk_bf16_f32 v148, 0, v148
    v_cvt_pk_bf16_f32 v149, 0, v149
    v_cvt_pk_bf16_f32 v150, 0, v150
    v_cvt_pk_bf16_f32 v151, 0, v151
    v_cvt_pk_bf16_f32 v152, 0, v152
    v_cvt_pk_bf16_f32 v153, 0, v153
    v_cvt_pk_bf16_f32 v154, 0, v154
    v_cvt_pk_bf16_f32 v155, 0, v155
    v_pk_mul_f32 v[148:149], v[148:149], v[128:129] op_sel:[0,1] op_sel_hi:[1,1]
    v_pk_mul_f32 v[150:151], v[150:151], v[128:129] op_sel:[0,1] op_sel_hi:[1,1]
    v_pk_mul_f32 v[152:153], v[152:153], v[128:129] op_sel:[0,1] op_sel_hi:[1,1]
    v_pk_mul_f32 v[154:155], v[154:155], v[128:129] op_sel:[0,1] op_sel_hi:[1,1]
    v_cvt_pk_bf16_f32 v88, v148, v149
    v_cvt_pk_bf16_f32 v89, v150, v151
    v_cvt_pk_bf16_f32 v90, v152, v153
    v_cvt_pk_bf16_f32 v91, v154, v155
    v_lshlrev_b32 v148, 16, v92
    v_and_b32 v149, 0xffff0000, v92
    v_lshlrev_b32 v150, 16, v93
    v_and_b32 v151, 0xffff0000, v93
    v_lshlrev_b32 v152, 16, v94
    v_and_b32 v153, 0xffff0000, v94
    v_lshlrev_b32 v154, 16, v95
    v_and_b32 v155, 0xffff0000, v95
    v_pk_add_f32 v[148:149], v[148:149], v[128:129] op_sel_hi:[1,0]
    v_pk_add_f32 v[150:151], v[150:151], v[128:129] op_sel_hi:[1,0]
    v_pk_add_f32 v[152:153], v[152:153], v[128:129] op_sel_hi:[1,0]
    v_pk_add_f32 v[154:155], v[154:155], v[128:129] op_sel_hi:[1,0]
    v_cvt_pk_bf16_f32 v148, 0, v148
    v_cvt_pk_bf16_f32 v149, 0, v149
    v_cvt_pk_bf16_f32 v150, 0, v150
    v_cvt_pk_bf16_f32 v151, 0, v151
    v_cvt_pk_bf16_f32 v152, 0, v152
    v_cvt_pk_bf16_f32 v153, 0, v153
    v_cvt_pk_bf16_f32 v154, 0, v154
    v_cvt_pk_bf16_f32 v155, 0, v155
    v_pk_mul_f32 v[148:149], v[148:149], v[128:129] op_sel:[0,1] op_sel_hi:[1,1]
    v_pk_mul_f32 v[150:151], v[150:151], v[128:129] op_sel:[0,1] op_sel_hi:[1,1]
    v_pk_mul_f32 v[152:153], v[152:153], v[128:129] op_sel:[0,1] op_sel_hi:[1,1]
    v_pk_mul_f32 v[154:155], v[154:155], v[128:129] op_sel:[0,1] op_sel_hi:[1,1]
    v_cvt_pk_bf16_f32 v92, v148, v149
    v_cvt_pk_bf16_f32 v93, v150, v151
    v_cvt_pk_bf16_f32 v94, v152, v153
    v_cvt_pk_bf16_f32 v95, v154, v155
    s_waitcnt vmcnt(8)
    v_dot2_f32_bf16 v128, v96, v198, 0
    v_dot2_f32_bf16 v129, v96, v96, 0
    v_dot2_f32_bf16 v130, v97, v198, 0
    v_dot2_f32_bf16 v131, v97, v97, 0
    v_dot2_f32_bf16 v128, v98, v198, v128
    v_dot2_f32_bf16 v129, v98, v98, v129
    v_dot2_f32_bf16 v130, v99, v198, v130
    v_dot2_f32_bf16 v131, v99, v99, v131
    v_dot2_f32_bf16 v128, v100, v198, v128
    v_dot2_f32_bf16 v129, v100, v100, v129
    v_dot2_f32_bf16 v130, v101, v198, v130
    v_dot2_f32_bf16 v131, v101, v101, v131
    v_dot2_f32_bf16 v128, v102, v198, v128
    v_dot2_f32_bf16 v129, v102, v102, v129
    v_dot2_f32_bf16 v130, v103, v198, v130
    v_dot2_f32_bf16 v131, v103, v103, v131
    v_dot2_f32_bf16 v128, v104, v198, v128
    v_dot2_f32_bf16 v129, v104, v104, v129
    v_dot2_f32_bf16 v130, v105, v198, v130
    v_dot2_f32_bf16 v131, v105, v105, v131
    v_dot2_f32_bf16 v128, v106, v198, v128
    v_dot2_f32_bf16 v129, v106, v106, v129
    v_dot2_f32_bf16 v130, v107, v198, v130
    v_dot2_f32_bf16 v131, v107, v107, v131
    v_dot2_f32_bf16 v128, v108, v198, v128
    v_dot2_f32_bf16 v129, v108, v108, v129
    v_dot2_f32_bf16 v130, v109, v198, v130
    v_dot2_f32_bf16 v131, v109, v109, v131
    v_dot2_f32_bf16 v128, v110, v198, v128
    v_dot2_f32_bf16 v129, v110, v110, v129
    v_dot2_f32_bf16 v130, v111, v198, v130
    v_dot2_f32_bf16 v131, v111, v111, v131
    v_dot2_f32_bf16 v128, v112, v198, v128
    v_dot2_f32_bf16 v129, v112, v112, v129
    v_dot2_f32_bf16 v130, v113, v198, v130
    v_dot2_f32_bf16 v131, v113, v113, v131
    v_dot2_f32_bf16 v128, v114, v198, v128
    v_dot2_f32_bf16 v129, v114, v114, v129
    v_dot2_f32_bf16 v130, v115, v198, v130
    v_dot2_f32_bf16 v131, v115, v115, v131
    s_nop 3
    v_add_f32 v128, v128, v130
    v_add_f32 v129, v129, v131
    s_nop 1
    v_add_f32_dpp v128, v128, v128 row_ror:8 row_mask:0xf bank_mask:0xf
    v_add_f32_dpp v129, v129, v129 row_ror:8 row_mask:0xf bank_mask:0xf
    s_nop 1
    v_add_f32_dpp v128, v128, v128 row_ror:4 row_mask:0xf bank_mask:0xf
    v_add_f32_dpp v129, v129, v129 row_ror:4 row_mask:0xf bank_mask:0xf
    s_nop 1
    v_add_f32_dpp v128, v128, v128 row_ror:2 row_mask:0xf bank_mask:0xf
    v_add_f32_dpp v129, v129, v129 row_ror:2 row_mask:0xf bank_mask:0xf
    s_nop 1
    v_add_f32_dpp v128, v128, v128 row_ror:1 row_mask:0xf bank_mask:0xf
    v_add_f32_dpp v129, v129, v129 row_ror:1 row_mask:0xf bank_mask:0xf
    s_nop 1
    s_mov_b32 s26, 0x3acccccd
    s_mov_b32 s27, 0x3727c5ac
    v_mul_f32 v128, s26, v128
    v_mul_f32 v129, s26, v129
    v_fma_f32 v129, -v128, v128, v129
    v_max_f32 v129, 0, v129
    v_cvt_pk_bf16_f32 v128, 0, v128
    v_cvt_pk_bf16_f32 v129, 0, v129
    v_add_f32 v129, s27, v129
    v_cvt_pk_bf16_f32 v129, 0, v129
    v_sqrt_f32 v129, v129
    s_nop 0
    v_xor_b32 v128, 0x80000000, v128
    v_cvt_pk_bf16_f32 v129, 0, v129
    v_rcp_f32 v140, v129
    s_nop 0
    v_fma_f32 v129, -v129, v140, 2.0
    v_mul_f32 v129, v140, v129
    v_lshlrev_b32 v148, 16, v96
    v_and_b32 v149, 0xffff0000, v96
    v_lshlrev_b32 v150, 16, v97
    v_and_b32 v151, 0xffff0000, v97
    v_lshlrev_b32 v152, 16, v98
    v_and_b32 v153, 0xffff0000, v98
    v_lshlrev_b32 v154, 16, v99
    v_and_b32 v155, 0xffff0000, v99
    v_pk_add_f32 v[148:149], v[148:149], v[128:129] op_sel_hi:[1,0]
    v_pk_add_f32 v[150:151], v[150:151], v[128:129] op_sel_hi:[1,0]
    v_pk_add_f32 v[152:153], v[152:153], v[128:129] op_sel_hi:[1,0]
    v_pk_add_f32 v[154:155], v[154:155], v[128:129] op_sel_hi:[1,0]
    v_cvt_pk_bf16_f32 v148, 0, v148
    v_cvt_pk_bf16_f32 v149, 0, v149
    v_cvt_pk_bf16_f32 v150, 0, v150
    v_cvt_pk_bf16_f32 v151, 0, v151
    v_cvt_pk_bf16_f32 v152, 0, v152
    v_cvt_pk_bf16_f32 v153, 0, v153
    v_cvt_pk_bf16_f32 v154, 0, v154
    v_cvt_pk_bf16_f32 v155, 0, v155
    v_pk_mul_f32 v[148:149], v[148:149], v[128:129] op_sel:[0,1] op_sel_hi:[1,1]
    v_pk_mul_f32 v[150:151], v[150:151], v[128:129] op_sel:[0,1] op_sel_hi:[1,1]
    v_pk_mul_f32 v[152:153], v[152:153], v[128:129] op_sel:[0,1] op_sel_hi:[1,1]
    v_pk_mul_f32 v[154:155], v[154:155], v[128:129] op_sel:[0,1] op_sel_hi:[1,1]
    v_cvt_pk_bf16_f32 v96, v148, v149
    v_cvt_pk_bf16_f32 v97, v150, v151
    v_cvt_pk_bf16_f32 v98, v152, v153
    v_cvt_pk_bf16_f32 v99, v154, v155
    v_lshlrev_b32 v148, 16, v100
    v_and_b32 v149, 0xffff0000, v100
    v_lshlrev_b32 v150, 16, v101
    v_and_b32 v151, 0xffff0000, v101
    v_lshlrev_b32 v152, 16, v102
    v_and_b32 v153, 0xffff0000, v102
    v_lshlrev_b32 v154, 16, v103
    v_and_b32 v155, 0xffff0000, v103
    v_pk_add_f32 v[148:149], v[148:149], v[128:129] op_sel_hi:[1,0]
    v_pk_add_f32 v[150:151], v[150:151], v[128:129] op_sel_hi:[1,0]
    v_pk_add_f32 v[152:153], v[152:153], v[128:129] op_sel_hi:[1,0]
    v_pk_add_f32 v[154:155], v[154:155], v[128:129] op_sel_hi:[1,0]
    v_cvt_pk_bf16_f32 v148, 0, v148
    v_cvt_pk_bf16_f32 v149, 0, v149
    v_cvt_pk_bf16_f32 v150, 0, v150
    v_cvt_pk_bf16_f32 v151, 0, v151
    v_cvt_pk_bf16_f32 v152, 0, v152
    v_cvt_pk_bf16_f32 v153, 0, v153
    v_cvt_pk_bf16_f32 v154, 0, v154
    v_cvt_pk_bf16_f32 v155, 0, v155
    v_pk_mul_f32 v[148:149], v[148:149], v[128:129] op_sel:[0,1] op_sel_hi:[1,1]
    v_pk_mul_f32 v[150:151], v[150:151], v[128:129] op_sel:[0,1] op_sel_hi:[1,1]
    v_pk_mul_f32 v[152:153], v[152:153], v[128:129] op_sel:[0,1] op_sel_hi:[1,1]
    v_pk_mul_f32 v[154:155], v[154:155], v[128:129] op_sel:[0,1] op_sel_hi:[1,1]
    v_cvt_pk_bf16_f32 v100, v148, v149
    v_cvt_pk_bf16_f32 v101, v150, v151
    v_cvt_pk_bf16_f32 v102, v152, v153
    v_cvt_pk_bf16_f32 v103, v154, v155
    v_lshlrev_b32 v148, 16, v104
    v_and_b32 v149, 0xffff0000, v104
    v_lshlrev_b32 v150, 16, v105
    v_and_b32 v151, 0xffff0000, v105
    v_lshlrev_b32 v152, 16, v106
    v_and_b32 v153, 0xffff0000, v106
    v_lshlrev_b32 v154, 16, v107
    v_and_b32 v155, 0xffff0000, v107
    v_pk_add_f32 v[148:149], v[148:149], v[128:129] op_sel_hi:[1,0]
    v_pk_add_f32 v[150:151], v[150:151], v[128:129] op_sel_hi:[1,0]
    v_pk_add_f32 v[152:153], v[152:153], v[128:129] op_sel_hi:[1,0]
    v_pk_add_f32 v[154:155], v[154:155], v[128:129] op_sel_hi:[1,0]
    v_cvt_pk_bf16_f32 v148, 0, v148
    v_cvt_pk_bf16_f32 v149, 0, v149
    v_cvt_pk_bf16_f32 v150, 0, v150
    v_cvt_pk_bf16_f32 v151, 0, v151
    v_cvt_pk_bf16_f32 v152, 0, v152
    v_cvt_pk_bf16_f32 v153, 0, v153
    v_cvt_pk_bf16_f32 v154, 0, v154
    v_cvt_pk_bf16_f32 v155, 0, v155
    v_pk_mul_f32 v[148:149], v[148:149], v[128:129] op_sel:[0,1] op_sel_hi:[1,1]
    v_pk_mul_f32 v[150:151], v[150:151], v[128:129] op_sel:[0,1] op_sel_hi:[1,1]
    v_pk_mul_f32 v[152:153], v[152:153], v[128:129] op_sel:[0,1] op_sel_hi:[1,1]
    v_pk_mul_f32 v[154:155], v[154:155], v[128:129] op_sel:[0,1] op_sel_hi:[1,1]
    v_cvt_pk_bf16_f32 v104, v148, v149
    v_cvt_pk_bf16_f32 v105, v150, v151
    v_cvt_pk_bf16_f32 v106, v152, v153
    v_cvt_pk_bf16_f32 v107, v154, v155
    v_lshlrev_b32 v148, 16, v108
    v_and_b32 v149, 0xffff0000, v108
    v_lshlrev_b32 v150, 16, v109
    v_and_b32 v151, 0xffff0000, v109
    v_lshlrev_b32 v152, 16, v110
    v_and_b32 v153, 0xffff0000, v110
    v_lshlrev_b32 v154, 16, v111
    v_and_b32 v155, 0xffff0000, v111
    v_pk_add_f32 v[148:149], v[148:149], v[128:129] op_sel_hi:[1,0]
    v_pk_add_f32 v[150:151], v[150:151], v[128:129] op_sel_hi:[1,0]
    v_pk_add_f32 v[152:153], v[152:153], v[128:129] op_sel_hi:[1,0]
    v_pk_add_f32 v[154:155], v[154:155], v[128:129] op_sel_hi:[1,0]
    v_cvt_pk_bf16_f32 v148, 0, v148
    v_cvt_pk_bf16_f32 v149, 0, v149
    v_cvt_pk_bf16_f32 v150, 0, v150
    v_cvt_pk_bf16_f32 v151, 0, v151
    v_cvt_pk_bf16_f32 v152, 0, v152
    v_cvt_pk_bf16_f32 v153, 0, v153
    v_cvt_pk_bf16_f32 v154, 0, v154
    v_cvt_pk_bf16_f32 v155, 0, v155
    v_pk_mul_f32 v[148:149], v[148:149], v[128:129] op_sel:[0,1] op_sel_hi:[1,1]
    v_pk_mul_f32 v[150:151], v[150:151], v[128:129] op_sel:[0,1] op_sel_hi:[1,1]
    v_pk_mul_f32 v[152:153], v[152:153], v[128:129] op_sel:[0,1] op_sel_hi:[1,1]
    v_pk_mul_f32 v[154:155], v[154:155], v[128:129] op_sel:[0,1] op_sel_hi:[1,1]
    v_cvt_pk_bf16_f32 v108, v148, v149
    v_cvt_pk_bf16_f32 v109, v150, v151
    v_cvt_pk_bf16_f32 v110, v152, v153
    v_cvt_pk_bf16_f32 v111, v154, v155
    v_lshlrev_b32 v148, 16, v112
    v_and_b32 v149, 0xffff0000, v112
    v_lshlrev_b32 v150, 16, v113
    v_and_b32 v151, 0xffff0000, v113
    v_lshlrev_b32 v152, 16, v114
    v_and_b32 v153, 0xffff0000, v114
    v_lshlrev_b32 v154, 16, v115
    v_and_b32 v155, 0xffff0000, v115
    v_pk_add_f32 v[148:149], v[148:149], v[128:129] op_sel_hi:[1,0]
    v_pk_add_f32 v[150:151], v[150:151], v[128:129] op_sel_hi:[1,0]
    v_pk_add_f32 v[152:153], v[152:153], v[128:129] op_sel_hi:[1,0]
    v_pk_add_f32 v[154:155], v[154:155], v[128:129] op_sel_hi:[1,0]
    v_cvt_pk_bf16_f32 v148, 0, v148
    v_cvt_pk_bf16_f32 v149, 0, v149
    v_cvt_pk_bf16_f32 v150, 0, v150
    v_cvt_pk_bf16_f32 v151, 0, v151
    v_cvt_pk_bf16_f32 v152, 0, v152
    v_cvt_pk_bf16_f32 v153, 0, v153
    v_cvt_pk_bf16_f32 v154, 0, v154
    v_cvt_pk_bf16_f32 v155, 0, v155
    v_pk_mul_f32 v[148:149], v[148:149], v[128:129] op_sel:[0,1] op_sel_hi:[1,1]
    v_pk_mul_f32 v[150:151], v[150:151], v[128:129] op_sel:[0,1] op_sel_hi:[1,1]
    v_pk_mul_f32 v[152:153], v[152:153], v[128:129] op_sel:[0,1] op_sel_hi:[1,1]
    v_pk_mul_f32 v[154:155], v[154:155], v[128:129] op_sel:[0,1] op_sel_hi:[1,1]
    v_cvt_pk_bf16_f32 v112, v148, v149
    v_cvt_pk_bf16_f32 v113, v150, v151
    v_cvt_pk_bf16_f32 v114, v152, v153
    v_cvt_pk_bf16_f32 v115, v154, v155
    ds_write_b128 v4, v[36:39] offset:0
    ds_write_b128 v5, v[56:59] offset:0
    ds_write_b128 v6, v[76:79] offset:0
    ds_write_b128 v7, v[96:99] offset:0
    s_waitcnt lgkmcnt(0)
    s_cmp_eq_u32 s22, 0
    s_cbranch_scc0 L_k1_H_ph1
    s_waitcnt vmcnt(6)
    s_barrier
    ds_read_b128 a[24:27], v32 offset:0
    ds_read_b128 a[28:31], v32 offset:1024
    ds_read_b64_tr_b16 a[0:1], v10 offset:0
    ds_read_b64_tr_b16 a[2:3], v10 offset:4096
    ds_read_b64_tr_b16 a[4:5], v11 offset:0
    ds_read_b64_tr_b16 a[6:7], v11 offset:4096
    ds_read_b64_tr_b16 a[8:9], v12 offset:0
    ds_read_b64_tr_b16 a[10:11], v12 offset:4096
    ds_read_b64_tr_b16 a[12:13], v13 offset:0
    ds_read_b64_tr_b16 a[14:15], v13 offset:4096
    s_waitcnt lgkmcnt(4)
    v_mfma_f32_16x16x32_bf16 v[128:131], a[0:3], a[24:27], 0
    ds_read_b64_tr_b16 a[16:17], v14 offset:0
    v_mfma_f32_16x16x32_bf16 v[160:163], a[0:3], a[28:31], 0
    ds_read_b64_tr_b16 a[18:19], v14 offset:4096
    v_mfma_f32_16x16x32_bf16 v[132:135], a[4:7], a[24:27], 0
    ds_read_b64_tr_b16 a[20:21], v15 offset:0
    v_mfma_f32_16x16x32_bf16 v[164:167], a[4:7], a[28:31], 0
    ds_read_b64_tr_b16 a[22:23], v15 offset:4096
    s_waitcnt lgkmcnt(4)
    v_mfma_f32_16x16x32_bf16 v[136:139], a[8:11], a[24:27], 0
    ds_read_b64_tr_b16 a[0:1], v16 offset:0
    v_mfma_f32_16x16x32_bf16 v[168:171], a[8:11], a[28:31], 0
    ds_read_b64_tr_b16 a[2:3], v16 offset:4096
    v_mfma_f32_16x16x32_bf16 v[140:143], a[12:15], a[24:27], 0
    ds_read_b64_tr_b16 a[4:5], v17 offset:0
    v_mfma_f32_16x16x32_bf16 v[172:175], a[12:15], a[28:31], 0
    ds_read_b64_tr_b16 a[6:7], v17 offset:4096
    s_waitcnt vmcnt(4)
    s_barrier
    ds_write_b128 v4, v[40:43] offset:33024
    ds_write_b128 v5, v[60:63] offset:33024
    ds_write_b128 v6, v[80:83] offset:33024
    ds_write_b128 v7, v[100:103] offset:33024
    ds_read_b128 a[36:39], v32 offset:8256
    ds_read_b128 a[40:43], v32 offset:9280
    s_add_u32 m0, s28, 0x10000
    s_nop 0
    buffer_load_dwordx4 v8, s[8:11], s23 offen lds
    s_waitcnt lgkmcnt(10)
    v_mfma_f32_16x16x32_bf16 v[144:147], a[16:19], a[24:27], 0
    ds_read_b64_tr_b16 a[8:9], v10 offset:16384
    v_mfma_f32_16x16x32_bf16 v[176:179], a[16:19], a[28:31], 0
    ds_read_b64_tr_b16 a[10:11], v10 offset:20480
    v_mfma_f32_16x16x32_bf16 v[148:151], a[20:23], a[24:27], 0
    ds_read_b64_tr_b16 a[12:13], v11 offset:16384
    v_mfma_f32_16x16x32_bf16 v[180:183], a[20:23], a[28:31], 0
    ds_read_b64_tr_b16 a[14:15], v11 offset:20480
    s_add_u32 m0, s28, 0x10400
    s_nop 0
    buffer_load_dwordx4 v9, s[8:11], s23 offen lds
    s_add_u32 s23, s23, 110592
    s_waitcnt lgkmcnt(10)
    v_mfma_f32_16x16x32_bf16 v[152:155], a[0:3], a[24:27], 0
    ds_read_b64_tr_b16 a[16:17], v12 offset:16384
    v_mfma_f32_16x16x32_bf16 v[184:187], a[0:3], a[28:31], 0
    ds_read_b64_tr_b16 a[18:19], v12 offset:20480
    v_mfma_f32_16x16x32_bf16 v[156:159], a[4:7], a[24:27], 0
    ds_read_b64_tr_b16 a[20:21], v13 offset:16384
    v_mfma_f32_16x16x32_bf16 v[188:191], a[4:7], a[28:31], 0
    ds_read_b64_tr_b16 a[22:23], v13 offset:20480
    s_waitcnt lgkmcnt(4)
    v_mfma_f32_16x16x32_bf16 v[128:131], a[8:11], a[36:39], v[128:131]
    ds_read_b64_tr_b16 a[0:1], v14 offset:16384
    v_mfma_f32_16x16x32_bf16 v[160:163], a[8:11], a[40:43], v[160:163]
    ds_read_b64_tr_b16 a[2:3], v14 offset:20480
    v_mfma_f32_16x16x32_bf16 v[132:135], a[12:15], a[36:39], v[132:135]
    ds_read_b64_tr_b16 a[4:5], v15 offset:16384
    v_mfma_f32_16x16x32_bf16 v[164:167], a[12:15], a[40:43], v[164:167]
    ds_read_b64_tr_b16 a[6:7], v15 offset:20480
    s_waitcnt lgkmcnt(4)
    v_mfma_f32_16x16x32_bf16 v[136:139], a[16:19], a[36:39], v[136:139]
    ds_read_b64_tr_b16 a[8:9], v16 offset:16384
    v_mfma_f32_16x16x32_bf16 v[168:171], a[16:19], a[40:43], v[168:171]
    ds_read_b64_tr_b16 a[10:11], v16 offset:20480
    v_mfma_f32_16x16x32_bf16 v[140:143], a[20:23], a[36:39], v[140:143]
    ds_read_b64_tr_b16 a[12:13], v17 offset:16384
    v_mfma_f32_16x16x32_bf16 v[172:175], a[20:23], a[40:43], v[172:175]
    ds_read_b64_tr_b16 a[14:15], v17 offset:20480
    s_waitcnt vmcnt(4)
    s_barrier
    ds_read_b128 a[24:27], v32 offset:16512
    ds_read_b128 a[28:31], v32 offset:17536
    s_add_u32 m0, s28, 0x0
    s_nop 0
    buffer_load_dwordx4 v8, s[8:11], s23 offen lds
    s_waitcnt lgkmcnt(6)
    v_mfma_f32_16x16x32_bf16 v[144:147], a[0:3], a[36:39], v[144:147]
    ds_read_b64_tr_b16 a[16:17], v10 offset:32768
    v_mfma_f32_16x16x32_bf16 v[176:179], a[0:3], a[40:43], v[176:179]
    ds_read_b64_tr_b16 a[18:19], v10 offset:36864
    v_mfma_f32_16x16x32_bf16 v[148:151], a[4:7], a[36:39], v[148:151]
    ds_read_b64_tr_b16 a[20:21], v11 offset:32768
    v_mfma_f32_16x16x32_bf16 v[180:183], a[4:7], a[40:43], v[180:183]
    ds_read_b64_tr_b16 a[22:23], v11 offset:36864
    s_add_u32 m0, s28, 0x400
    s_nop 0
    buffer_load_dwordx4 v9, s[8:11], s23 offen lds
    s_add_u32 s23, s23, 110592
    s_waitcnt lgkmcnt(6)
    v_mfma_f32_16x16x32_bf16 v[152:155], a[8:11], a[36:39], v[152:155]
    ds_read_b64_tr_b16 a[0:1], v12 offset:32768
    v_mfma_f32_16x16x32_bf16 v[184:187], a[8:11], a[40:43], v[184:187]
    ds_read_b64_tr_b16 a[2:3], v12 offset:36864
    v_mfma_f32_16x16x32_bf16 v[156:159], a[12:15], a[36:39], v[156:159]
    ds_read_b64_tr_b16 a[4:5], v13 offset:32768
    v_mfma_f32_16x16x32_bf16 v[188:191], a[12:15], a[40:43], v[188:191]
    ds_read_b64_tr_b16 a[6:7], v13 offset:36864
    s_waitcnt lgkmcnt(4)
    v_mfma_f32_16x16x32_bf16 v[128:131], a[16:19], a[24:27], v[128:131]
    ds_read_b64_tr_b16 a[8:9], v14 offset:32768
    v_mfma_f32_16x16x32_bf16 v[160:163], a[16:19], a[28:31], v[160:163]
    ds_read_b64_tr_b16 a[10:11], v14 offset:36864
    v_mfma_f32_16x16x32_bf16 v[132:135], a[20:23], a[24:27], v[132:135]
    ds_read_b64_tr_b16 a[12:13], v15 offset:32768
    v_mfma_f32_16x16x32_bf16 v[164:167], a[20:23], a[28:31], v[164:167]
    ds_read_b64_tr_b16 a[14:15], v15 offset:36864
    s_waitcnt lgkmcnt(4)
    v_mfma_f32_16x16x32_bf16 v[136:139], a[0:3], a[24:27], v[136:139]
    ds_read_b64_tr_b16 a[16:17], v16 offset:32768
    v_mfma_f32_16x16x32_bf16 v[168:171], a[0:3], a[28:31], v[168:171]
    ds_read_b64_tr_b16 a[18:19], v16 offset:36864
    v_mfma_f32_16x16x32_bf16 v[140:143], a[4:7], a[24:27], v[140:143]
    ds_read_b64_tr_b16 a[20:21], v17 offset:32768
    v_mfma_f32_16x16x32_bf16 v[172:175], a[4:7], a[28:31], v[172:175]
    ds_read_b64_tr_b16 a[22:23], v17 offset:36864
    s_waitcnt vmcnt(4)
    s_barrier
    ds_read_b128 a[36:39], v32 offset:24768
    ds_read_b128 a[40:43], v32 offset:25792
    s_add_u32 m0, s28, 0x4000
    s_nop 0
    buffer_load_dwordx4 v8, s[8:11], s23 offen lds
    s_waitcnt lgkmcnt(6)
    v_mfma_f32_16x16x32_bf16 v[144:147], a[8:11], a[24:27], v[144:147]
    ds_read_b64_tr_b16 a[0:1], v10 offset:49152
    v_mfma_f32_16x16x32_bf16 v[176:179], a[8:11], a[28:31], v[176:179]
    ds_read_b64_tr_b16 a[2:3], v10 offset:53248
    v_mfma_f32_16x16x32_bf16 v[148:151], a[12:15], a[24:27], v[148:151]
    ds_read_b64_tr_b16 a[4:5], v11 offset:49152
    v_mfma_f32_16x16x32_bf16 v[180:183], a[12:15], a[28:31], v[180:183]
    ds_read_b64_tr_b16 a[6:7], v11 offset:53248
    s_add_u32 m0, s28, 0x4400
    s_nop 0
    buffer_load_dwordx4 v9, s[8:11], s23 offen lds
    s_add_u32 s23, s23, 110592
    s_waitcnt lgkmcnt(6)
    v_mfma_f32_16x16x32_bf16 v[152:155], a[16:19], a[24:27], v[152:155]
    ds_read_b64_tr_b16 a[8:9], v12 offset:49152
    v_mfma_f32_16x16x32_bf16 v[184:187], a[16:19], a[28:31], v[184:187]
    ds_read_b64_tr_b16 a[10:11], v12 offset:53248
    v_mfma_f32_16x16x32_bf16 v[156:159], a[20:23], a[24:27], v[156:159]
    ds_read_b64_tr_b16 a[12:13], v13 offset:49152
    v_mfma_f32_16x16x32_bf16 v[188:191], a[20:23], a[28:31], v[188:191]
    ds_read_b64_tr_b16 a[14:15], v13 offset:53248
    s_waitcnt lgkmcnt(4)
    v_mfma_f32_16x16x32_bf16 v[128:131], a[0:3], a[36:39], v[128:131]
    ds_read_b64_tr_b16 a[16:17], v14 offset:49152
    v_mfma_f32_16x16x32_bf16 v[160:163], a[0:3], a[40:43], v[160:163]
    ds_read_b64_tr_b16 a[18:19], v14 offset:53248
    v_mfma_f32_16x16x32_bf16 v[132:135], a[4:7], a[36:39], v[132:135]
    ds_read_b64_tr_b16 a[20:21], v15 offset:49152
    v_mfma_f32_16x16x32_bf16 v[164:167], a[4:7], a[40:43], v[164:167]
    ds_read_b64_tr_b16 a[22:23], v15 offset:53248
    s_waitcnt lgkmcnt(4)
    v_mfma_f32_16x16x32_bf16 v[136:139], a[8:11], a[36:39], v[136:139]
    ds_read_b64_tr_b16 a[0:1], v16 offset:49152
    v_mfma_f32_16x16x32_bf16 v[168:171], a[8:11], a[40:43], v[168:171]
    ds_read_b64_tr_b16 a[2:3], v16 offset:53248
    v_mfma_f32_16x16x32_bf16 v[140:143], a[12:15], a[36:39], v[140:143]
    ds_read_b64_tr_b16 a[4:5], v17 offset:49152
    v_mfma_f32_16x16x32_bf16 v[172:175], a[12:15], a[40:43], v[172:175]
    ds_read_b64_tr_b16 a[6:7], v17 offset:53248
    s_waitcnt vmcnt(4)
    s_barrier
    ds_read_b128 a[24:27], v35 offset:0
    ds_read_b128 a[28:31], v35 offset:1024
    s_add_u32 m0, s28, 0x8000
    s_nop 0
    buffer_load_dwordx4 v8, s[8:11], s23 offen lds
    s_waitcnt lgkmcnt(6)
    v_mfma_f32_16x16x32_bf16 v[144:147], a[16:19], a[36:39], v[144:147]
    ds_read_b64_tr_b16 a[8:9], v21 offset:0
    v_mfma_f32_16x16x32_bf16 v[176:179], a[16:19], a[40:43], v[176:179]
    ds_read_b64_tr_b16 a[10:11], v21 offset:4096
    v_mfma_f32_16x16x32_bf16 v[148:151], a[20:23], a[36:39], v[148:151]
    ds_read_b64_tr_b16 a[12:13], v22 offset:0
    v_mfma_f32_16x16x32_bf16 v[180:183], a[20:23], a[40:43], v[180:183]
    ds_read_b64_tr_b16 a[14:15], v22 offset:4096
    s_add_u32 m0, s28, 0x8400
    s_nop 0
    buffer_load_dwordx4 v9, s[8:11], s23 offen lds
    s_add_u32 s23, s23, 110592
    s_waitcnt lgkmcnt(6)
    v_mfma_f32_16x16x32_bf16 v[152:155], a[0:3], a[36:39], v[152:155]
    ds_read_b64_tr_b16 a[16:17], v23 offset:0
    v_mfma_f32_16x16x32_bf16 v[184:187], a[0:3], a[40:43], v[184:187]
    ds_read_b64_tr_b16 a[18:19], v23 offset:4096
    v_mfma_f32_16x16x32_bf16 v[156:159], a[4:7], a[36:39], v[156:159]
    ds_read_b64_tr_b16 a[20:21], v24 offset:0
    v_mfma_f32_16x16x32_bf16 v[188:191], a[4:7], a[40:43], v[188:191]
    ds_read_b64_tr_b16 a[22:23], v24 offset:4096
    s_waitcnt lgkmcnt(4)
    v_mfma_f32_16x16x32_bf16 v[128:131], a[8:11], a[24:27], v[128:131]
    ds_read_b64_tr_b16 a[0:1], v25 offset:0
    v_mfma_f32_16x16x32_bf16 v[160:163], a[8:11], a[28:31], v[160:163]
    ds_read_b64_tr_b16 a[2:3], v25 offset:4096
    v_mfma_f32_16x16x32_bf16 v[132:135], a[12:15], a[24:27], v[132:135]
    ds_read_b64_tr_b16 a[4:5], v26 offset:0
    v_mfma_f32_16x16x32_bf16 v[164:167], a[12:15], a[28:31], v[164:167]
    ds_read_b64_tr_b16 a[6:7], v26 offset:4096
    s_waitcnt lgkmcnt(4)
    v_mfma_f32_16x16x32_bf16 v[136:139], a[16:19], a[24:27], v[136:139]
    ds_read_b64_tr_b16 a[8:9], v27 offset:0
    v_mfma_f32_16x16x32_bf16 v[168:171], a[16:19], a[28:31], v[168:171]
    ds_read_b64_tr_b16 a[10:11], v27 offset:4096
    v_mfma_f32_16x16x32_bf16 v[140:143], a[20:23], a[24:27], v[140:143]
    ds_read_b64_tr_b16 a[12:13], v28 offset:0
    v_mfma_f32_16x16x32_bf16 v[172:175], a[20:23], a[28:31], v[172:175]
    ds_read_b64_tr_b16 a[14:15], v28 offset:4096
    s_waitcnt vmcnt(4)
    s_barrier
    ds_write_b128 v4, v[44:47] offset:0
    ds_write_b128 v5, v[64:67] offset:0
    ds_write_b128 v6, v[84:87] offset:0
    ds_write_b128 v7, v[104:107] offset:0
    ds_read_b128 a[36:39], v35 offset:8256
    ds_read_b128 a[40:43], v35 offset:9280
    s_add_u32 m0, s28, 0xc000
    s_nop 0
    buffer_load_dwordx4 v8, s[8:11], s23 offen lds
    s_waitcnt lgkmcnt(10)
    v_mfma_f32_16x16x32_bf16 v[144:147], a[0:3], a[24:27], v[144:147]
    ds_read_b64_tr_b16 a[16:17], v10 offset:0
    v_mfma_f32_16x16x32_bf16 v[176:179], a[0:3], a[28:31], v[176:179]
    ds_read_b64_tr_b16 a[18:19], v10 offset:4096
    v_mfma_f32_16x16x32_bf16 v[148:151], a[4:7], a[24:27], v[148:151]
    ds_read_b64_tr_b16 a[20:21], v11 offset:0
    v_mfma_f32_16x16x32_bf16 v[180:183], a[4:7], a[28:31], v[180:183]
    ds_read_b64_tr_b16 a[22:23], v11 offset:4096
    s_add_u32 m0, s28, 0xc400
    s_nop 0
    buffer_load_dwordx4 v9, s[8:11], s23 offen lds
    s_add_u32 s23, s23, 110592
    s_waitcnt lgkmcnt(10)
    v_mfma_f32_16x16x32_bf16 v[152:155], a[8:11], a[24:27], v[152:155]
    ds_read_b64_tr_b16 a[0:1], v12 offset:0
    v_mfma_f32_16x16x32_bf16 v[184:187], a[8:11], a[28:31], v[184:187]
    ds_read_b64_tr_b16 a[2:3], v12 offset:4096
    v_mfma_f32_16x16x32_bf16 v[156:159], a[12:15], a[24:27], v[156:159]
    ds_read_b64_tr_b16 a[4:5], v13 offset:0
    v_mfma_f32_16x16x32_bf16 v[188:191], a[12:15], a[28:31], v[188:191]
    ds_read_b64_tr_b16 a[6:7], v13 offset:4096
    s_waitcnt lgkmcnt(4)
    v_mfma_f32_16x16x32_bf16 v[128:131], a[16:19], a[36:39], v[128:131]
    ds_read_b64_tr_b16 a[8:9], v14 offset:0
    v_mfma_f32_16x16x32_bf16 v[160:163], a[16:19], a[40:43], v[160:163]
    ds_read_b64_tr_b16 a[10:11], v14 offset:4096
    v_mfma_f32_16x16x32_bf16 v[132:135], a[20:23], a[36:39], v[132:135]
    ds_read_b64_tr_b16 a[12:13], v15 offset:0
    v_mfma_f32_16x16x32_bf16 v[164:167], a[20:23], a[40:43], v[164:167]
    ds_read_b64_tr_b16 a[14:15], v15 offset:4096
    s_waitcnt lgkmcnt(4)
    v_mfma_f32_16x16x32_bf16 v[136:139], a[0:3], a[36:39], v[136:139]
    ds_read_b64_tr_b16 a[16:17], v16 offset:0
    v_mfma_f32_16x16x32_bf16 v[168:171], a[0:3], a[40:43], v[168:171]
    ds_read_b64_tr_b16 a[18:19], v16 offset:4096
    v_mfma_f32_16x16x32_bf16 v[140:143], a[4:7], a[36:39], v[140:143]
    ds_read_b64_tr_b16 a[20:21], v17 offset:0
    v_mfma_f32_16x16x32_bf16 v[172:175], a[4:7], a[40:43], v[172:175]
    ds_read_b64_tr_b16 a[22:23], v17 offset:4096
    s_waitcnt vmcnt(4)
    s_barrier
    ds_read_b128 a[24:27], v35 offset:16512
    ds_read_b128 a[28:31], v35 offset:17536
    s_add_u32 m0, s28, 0x10000
    s_nop 0
    buffer_load_dwordx4 v8, s[8:11], s23 offen lds
    s_waitcnt lgkmcnt(6)
    v_mfma_f32_16x16x32_bf16 v[144:147], a[8:11], a[36:39], v[144:147]
    ds_read_b64_tr_b16 a[0:1], v10 offset:16384
    v_mfma_f32_16x16x32_bf16 v[176:179], a[8:11], a[40:43], v[176:179]
    ds_read_b64_tr_b16 a[2:3], v10 offset:20480
    v_mfma_f32_16x16x32_bf16 v[148:151], a[12:15], a[36:39], v[148:151]
    ds_read_b64_tr_b16 a[4:5], v11 offset:16384
    v_mfma_f32_16x16x32_bf16 v[180:183], a[12:15], a[40:43], v[180:183]
    ds_read_b64_tr_b16 a[6:7], v11 offset:20480
    s_add_u32 m0, s28, 0x10400
    s_nop 0
    buffer_load_dwordx4 v9, s[8:11], s23 offen lds
    s_add_u32 s23, s23, 110592
    s_waitcnt lgkmcnt(6)
    v_mfma_f32_16x16x32_bf16 v[152:155], a[16:19], a[36:39], v[152:155]
    ds_read_b64_tr_b16 a[8:9], v12 offset:16384
    v_mfma_f32_16x16x32_bf16 v[184:187], a[16:19], a[40:43], v[184:187]
    ds_read_b64_tr_b16 a[10:11], v12 offset:20480
    v_mfma_f32_16x16x32_bf16 v[156:159], a[20:23], a[36:39], v[156:159]
    ds_read_b64_tr_b16 a[12:13], v13 offset:16384
    v_mfma_f32_16x16x32_bf16 v[188:191], a[20:23], a[40:43], v[188:191]
    ds_read_b64_tr_b16 a[14:15], v13 offset:20480
    s_waitcnt lgkmcnt(4)
    v_mfma_f32_16x16x32_bf16 v[128:131], a[0:3], a[24:27], v[128:131]
    ds_read_b64_tr_b16 a[16:17], v14 offset:16384
    v_mfma_f32_16x16x32_bf16 v[160:163], a[0:3], a[28:31], v[160:163]
    ds_read_b64_tr_b16 a[18:19], v14 offset:20480
    v_mfma_f32_16x16x32_bf16 v[132:135], a[4:7], a[24:27], v[132:135]
    ds_read_b64_tr_b16 a[20:21], v15 offset:16384
    v_mfma_f32_16x16x32_bf16 v[164:167], a[4:7], a[28:31], v[164:167]
    ds_read_b64_tr_b16 a[22:23], v15 offset:20480
    s_waitcnt lgkmcnt(4)
    v_mfma_f32_16x16x32_bf16 v[136:139], a[8:11], a[24:27], v[136:139]
    ds_read_b64_tr_b16 a[0:1], v16 offset:16384
    v_mfma_f32_16x16x32_bf16 v[168:171], a[8:11], a[28:31], v[168:171]
    ds_read_b64_tr_b16 a[2:3], v16 offset:20480
    v_mfma_f32_16x16x32_bf16 v[140:143], a[12:15], a[24:27], v[140:143]
    ds_read_b64_tr_b16 a[4:5], v17 offset:16384
    v_mfma_f32_16x16x32_bf16 v[172:175], a[12:15], a[28:31], v[172:175]
    ds_read_b64_tr_b16 a[6:7], v17 offset:20480
    s_waitcnt vmcnt(4)
    s_barrier
    ds_read_b128 a[36:39], v35 offset:24768
    ds_read_b128 a[40:43], v35 offset:25792
    s_add_u32 m0, s28, 0x0
    s_nop 0
    buffer_load_dwordx4 v8, s[8:11], s23 offen lds
    s_waitcnt lgkmcnt(6)
    v_mfma_f32_16x16x32_bf16 v[144:147], a[16:19], a[24:27], v[144:147]
    ds_read_b64_tr_b16 a[8:9], v10 offset:32768
    v_mfma_f32_16x16x32_bf16 v[176:179], a[16:19], a[28:31], v[176:179]
    ds_read_b64_tr_b16 a[10:11], v10 offset:36864
    v_mfma_f32_16x16x32_bf16 v[148:151], a[20:23], a[24:27], v[148:151]
    ds_read_b64_tr_b16 a[12:13], v11 offset:32768
    v_mfma_f32_16x16x32_bf16 v[180:183], a[20:23], a[28:31], v[180:183]
    ds_read_b64_tr_b16 a[14:15], v11 offset:36864
    s_add_u32 m0, s28, 0x400
    s_nop 0
    buffer_load_dwordx4 v9, s[8:11], s23 offen lds
    s_add_u32 s23, s23, 110592
    s_waitcnt lgkmcnt(6)
    v_mfma_f32_16x16x32_bf16 v[152:155], a[0:3], a[24:27], v[152:155]
    ds_read_b64_tr_b16 a[16:17], v12 offset:32768
    v_mfma_f32_16x16x32_bf16 v[184:187], a[0:3], a[28:31], v[184:187]
    ds_read_b64_tr_b16 a[18:19], v12 offset:36864
    v_mfma_f32_16x16x32_bf16 v[156:159], a[4:7], a[24:27], v[156:159]
    ds_read_b64_tr_b16 a[20:21], v13 offset:32768
    v_mfma_f32_16x16x32_bf16 v[188:191], a[4:7], a[28:31], v[188:191]
    ds_read_b64_tr_b16 a[22:23], v13 offset:36864
    s_waitcnt lgkmcnt(4)
    v_mfma_f32_16x16x32_bf16 v[128:131], a[8:11], a[36:39], v[128:131]
    ds_read_b64_tr_b16 a[0:1], v14 offset:32768
    v_mfma_f32_16x16x32_bf16 v[160:163], a[8:11], a[40:43], v[160:163]
    ds_read_b64_tr_b16 a[2:3], v14 offset:36864
    v_mfma_f32_16x16x32_bf16 v[132:135], a[12:15], a[36:39], v[132:135]
    ds_read_b64_tr_b16 a[4:5], v15 offset:32768
    v_mfma_f32_16x16x32_bf16 v[164:167], a[12:15], a[40:43], v[164:167]
    ds_read_b64_tr_b16 a[6:7], v15 offset:36864
    s_waitcnt lgkmcnt(4)
    v_mfma_f32_16x16x32_bf16 v[136:139], a[16:19], a[36:39], v[136:139]
    ds_read_b64_tr_b16 a[8:9], v16 offset:32768
    v_mfma_f32_16x16x32_bf16 v[168:171], a[16:19], a[40:43], v[168:171]
    ds_read_b64_tr_b16 a[10:11], v16 offset:36864
    v_mfma_f32_16x16x32_bf16 v[140:143], a[20:23], a[36:39], v[140:143]
    ds_read_b64_tr_b16 a[12:13], v17 offset:32768
    v_mfma_f32_16x16x32_bf16 v[172:175], a[20:23], a[40:43], v[172:175]
    ds_read_b64_tr_b16 a[14:15], v17 offset:36864
    s_waitcnt vmcnt(4)
    s_barrier
    ds_read_b128 a[24:27], v32 offset:0
    ds_read_b128 a[28:31], v32 offset:1024
    s_add_u32 m0, s28, 0x4000
    s_nop 0
    buffer_load_dwordx4 v8, s[8:11], s23 offen lds
    s_waitcnt lgkmcnt(6)
    v_mfma_f32_16x16x32_bf16 v[144:147], a[0:3], a[36:39], v[144:147]
    ds_read_b64_tr_b16 a[16:17], v10 offset:49152
    v_mfma_f32_16x16x32_bf16 v[176:179], a[0:3], a[40:43], v[176:179]
    ds_read_b64_tr_b16 a[18:19], v10 offset:53248
    v_mfma_f32_16x16x32_bf16 v[148:151], a[4:7], a[36:39], v[148:151]
    ds_read_b64_tr_b16 a[20:21], v11 offset:49152
    v_mfma_f32_16x16x32_bf16 v[180:183], a[4:7], a[40:43], v[180:183]
    ds_read_b64_tr_b16 a[22:23], v11 offset:53248
    s_add_u32 m0, s28, 0x4400
    s_nop 0
    buffer_load_dwordx4 v9, s[8:11], s23 offen lds
    s_add_u32 s23, s23, 110592
    s_waitcnt lgkmcnt(6)
    v_mfma_f32_16x16x32_bf16 v[152:155], a[8:11], a[36:39], v[152:155]
    ds_read_b64_tr_b16 a[0:1], v12 offset:49152
    v_mfma_f32_16x16x32_bf16 v[184:187], a[8:11], a[40:43], v[184:187]
    ds_read_b64_tr_b16 a[2:3], v12 offset:53248
    v_mfma_f32_16x16x32_bf16 v[156:159], a[12:15], a[36:39], v[156:159]
    ds_read_b64_tr_b16 a[4:5], v13 offset:49152
    v_mfma_f32_16x16x32_bf16 v[188:191], a[12:15], a[40:43], v[188:191]
    ds_read_b64_tr_b16 a[6:7], v13 offset:53248
    s_waitcnt lgkmcnt(4)
    v_mfma_f32_16x16x32_bf16 v[128:131], a[16:19], a[24:27], v[128:131]
    ds_read_b64_tr_b16 a[8:9], v14 offset:49152
    v_mfma_f32_16x16x32_bf16 v[160:163], a[16:19], a[28:31], v[160:163]
    ds_read_b64_tr_b16 a[10:11], v14 offset:53248
    v_mfma_f32_16x16x32_bf16 v[132:135], a[20:23], a[24:27], v[132:135]
    ds_read_b64_tr_b16 a[12:13], v15 offset:49152
    v_mfma_f32_16x16x32_bf16 v[164:167], a[20:23], a[28:31], v[164:167]
    ds_read_b64_tr_b16 a[14:15], v15 offset:53248
    s_waitcnt lgkmcnt(4)
    v_mfma_f32_16x16x32_bf16 v[136:139], a[0:3], a[24:27], v[136:139]
    ds_read_b64_tr_b16 a[16:17], v16 offset:49152
    v_mfma_f32_16x16x32_bf16 v[168:171], a[0:3], a[28:31], v[168:171]
    ds_read_b64_tr_b16 a[18:19], v16 offset:53248
    v_mfma_f32_16x16x32_bf16 v[140:143], a[4:7], a[24:27], v[140:143]
    ds_read_b64_tr_b16 a[20:21], v17 offset:49152
    v_mfma_f32_16x16x32_bf16 v[172:175], a[4:7], a[28:31], v[172:175]
    ds_read_b64_tr_b16 a[22:23], v17 offset:53248
    s_waitcnt vmcnt(4)
    s_barrier
    ds_write_b128 v4, v[48:51] offset:33024
    ds_write_b128 v5, v[68:71] offset:33024
    ds_write_b128 v6, v[88:91] offset:33024
    ds_write_b128 v7, v[108:111] offset:33024
    ds_read_b128 a[36:39], v32 offset:8256
    ds_read_b128 a[40:43], v32 offset:9280
    s_add_u32 m0, s28, 0x8000
    s_nop 0
    buffer_load_dwordx4 v8, s[8:11], s23 offen lds
    s_waitcnt lgkmcnt(10)
    v_mfma_f32_16x16x32_bf16 v[144:147], a[8:11], a[24:27], v[144:147]
    ds_read_b64_tr_b16 a[0:1], v21 offset:0
    v_mfma_f32_16x16x32_bf16 v[176:179], a[8:11], a[28:31], v[176:179]
    ds_read_b64_tr_b16 a[2:3], v21 offset:4096
    v_mfma_f32_16x16x32_bf16 v[148:151], a[12:15], a[24:27], v[148:151]
    ds_read_b64_tr_b16 a[4:5], v22 offset:0
    v_mfma_f32_16x16x32_bf16 v[180:183], a[12:15], a[28:31], v[180:183]
    ds_read_b64_tr_b16 a[6:7], v22 offset:4096
    s_add_u32 m0, s28, 0x8400
    s_nop 0
    buffer_load_dwordx4 v9, s[8:11], s23 offen lds
    s_add_u32 s23, s23, 110592
    s_waitcnt lgkmcnt(10)
    v_mfma_f32_16x16x32_bf16 v[152:155], a[16:19], a[24:27], v[152:155]
    ds_read_b64_tr_b16 a[8:9], v23 offset:0
    v_mfma_f32_16x16x32_bf16 v[184:187], a[16:19], a[28:31], v[184:187]
    ds_read_b64_tr_b16 a[10:11], v23 offset:4096
    v_mfma_f32_16x16x32_bf16 v[156:159], a[20:23], a[24:27], v[156:159]
    ds_read_b64_tr_b16 a[12:13], v24 offset:0
    v_mfma_f32_16x16x32_bf16 v[188:191], a[20:23], a[28:31], v[188:191]
    ds_read_b64_tr_b16 a[14:15], v24 offset:4096
    s_waitcnt lgkmcnt(4)
    v_mfma_f32_16x16x32_bf16 v[128:131], a[0:3], a[36:39], v[128:131]
    ds_read_b64_tr_b16 a[16:17], v25 offset:0
    v_mfma_f32_16x16x32_bf16 v[160:163], a[0:3], a[40:43], v[160:163]
    ds_read_b64_tr_b16 a[18:19], v25 offset:4096
    v_mfma_f32_16x16x32_bf16 v[132:135], a[4:7], a[36:39], v[132:135]
    ds_read_b64_tr_b16 a[20:21], v26 offset:0
    v_mfma_f32_16x16x32_bf16 v[164:167], a[4:7], a[40:43], v[164:167]
    ds_read_b64_tr_b16 a[22:23], v26 offset:4096
    s_waitcnt lgkmcnt(4)
    v_mfma_f32_16x16x32_bf16 v[136:139], a[8:11], a[36:39], v[136:139]
    ds_read_b64_tr_b16 a[0:1], v27 offset:0
    v_mfma_f32_16x16x32_bf16 v[168:171], a[8:11], a[40:43], v[168:171]
    ds_read_b64_tr_b16 a[2:3], v27 offset:4096
    v_mfma_f32_16x16x32_bf16 v[140:143], a[12:15], a[36:39], v[140:143]
    ds_read_b64_tr_b16 a[4:5], v28 offset:0
    v_mfma_f32_16x16x32_bf16 v[172:175], a[12:15], a[40:43], v[172:175]
    ds_read_b64_tr_b16 a[6:7], v28 offset:4096
    s_waitcnt vmcnt(4)
    s_barrier
    ds_read_b128 a[24:27], v32 offset:16512
    ds_read_b128 a[28:31], v32 offset:17536
    s_add_u32 m0, s28, 0xc000
    s_nop 0
    buffer_load_dwordx4 v8, s[8:11], s23 offen lds
    s_waitcnt lgkmcnt(6)
    v_mfma_f32_16x16x32_bf16 v[144:147], a[16:19], a[36:39], v[144:147]
    ds_read_b64_tr_b16 a[8:9], v10 offset:0
    v_mfma_f32_16x16x32_bf16 v[176:179], a[16:19], a[40:43], v[176:179]
    ds_read_b64_tr_b16 a[10:11], v10 offset:4096
    v_mfma_f32_16x16x32_bf16 v[148:151], a[20:23], a[36:39], v[148:151]
    ds_read_b64_tr_b16 a[12:13], v11 offset:0
    v_mfma_f32_16x16x32_bf16 v[180:183], a[20:23], a[40:43], v[180:183]
    ds_read_b64_tr_b16 a[14:15], v11 offset:4096
    s_add_u32 m0, s28, 0xc400
    s_nop 0
    buffer_load_dwordx4 v9, s[8:11], s23 offen lds
    s_add_u32 s23, s23, 110592
    s_waitcnt lgkmcnt(6)
    v_mfma_f32_16x16x32_bf16 v[152:155], a[0:3], a[36:39], v[152:155]
    ds_read_b64_tr_b16 a[16:17], v12 offset:0
    v_mfma_f32_16x16x32_bf16 v[184:187], a[0:3], a[40:43], v[184:187]
    ds_read_b64_tr_b16 a[18:19], v12 offset:4096
    v_mfma_f32_16x16x32_bf16 v[156:159], a[4:7], a[36:39], v[156:159]
    ds_read_b64_tr_b16 a[20:21], v13 offset:0
    v_mfma_f32_16x16x32_bf16 v[188:191], a[4:7], a[40:43], v[188:191]
    ds_read_b64_tr_b16 a[22:23], v13 offset:4096
    s_waitcnt lgkmcnt(4)
    v_mfma_f32_16x16x32_bf16 v[128:131], a[8:11], a[24:27], v[128:131]
    ds_read_b64_tr_b16 a[0:1], v14 offset:0
    v_mfma_f32_16x16x32_bf16 v[160:163], a[8:11], a[28:31], v[160:163]
    ds_read_b64_tr_b16 a[2:3], v14 offset:4096
    v_mfma_f32_16x16x32_bf16 v[132:135], a[12:15], a[24:27], v[132:135]
    ds_read_b64_tr_b16 a[4:5], v15 offset:0
    v_mfma_f32_16x16x32_bf16 v[164:167], a[12:15], a[28:31], v[164:167]
    ds_read_b64_tr_b16 a[6:7], v15 offset:4096
    s_waitcnt lgkmcnt(4)
    v_mfma_f32_16x16x32_bf16 v[136:139], a[16:19], a[24:27], v[136:139]
    ds_read_b64_tr_b16 a[8:9], v16 offset:0
    v_mfma_f32_16x16x32_bf16 v[168:171], a[16:19], a[28:31], v[168:171]
    ds_read_b64_tr_b16 a[10:11], v16 offset:4096
    v_mfma_f32_16x16x32_bf16 v[140:143], a[20:23], a[24:27], v[140:143]
    ds_read_b64_tr_b16 a[12:13], v17 offset:0
    v_mfma_f32_16x16x32_bf16 v[172:175], a[20:23], a[28:31], v[172:175]
    ds_read_b64_tr_b16 a[14:15], v17 offset:4096
    s_waitcnt vmcnt(4)
    s_barrier
    ds_read_b128 a[36:39], v32 offset:24768
    ds_read_b128 a[40:43], v32 offset:25792
    s_add_u32 m0, s28, 0x10000
    s_nop 0
    buffer_load_dwordx4 v8, s[8:11], s23 offen lds
    s_waitcnt lgkmcnt(6)
    v_mfma_f32_16x16x32_bf16 v[144:147], a[0:3], a[24:27], v[144:147]
    ds_read_b64_tr_b16 a[16:17], v10 offset:16384
    v_mfma_f32_16x16x32_bf16 v[176:179], a[0:3], a[28:31], v[176:179]
    ds_read_b64_tr_b16 a[18:19], v10 offset:20480
    v_mfma_f32_16x16x32_bf16 v[148:151], a[4:7], a[24:27], v[148:151]
    ds_read_b64_tr_b16 a[20:21], v11 offset:16384
    v_mfma_f32_16x16x32_bf16 v[180:183], a[4:7], a[28:31], v[180:183]
    ds_read_b64_tr_b16 a[22:23], v11 offset:20480
    s_add_u32 m0, s28, 0x10400
    s_nop 0
    buffer_load_dwordx4 v9, s[8:11], s23 offen lds
    s_add_u32 s23, s23, 110592
    s_waitcnt lgkmcnt(6)
    v_mfma_f32_16x16x32_bf16 v[152:155], a[8:11], a[24:27], v[152:155]
    ds_read_b64_tr_b16 a[0:1], v12 offset:16384
    v_mfma_f32_16x16x32_bf16 v[184:187], a[8:11], a[28:31], v[184:187]
    ds_read_b64_tr_b16 a[2:3], v12 offset:20480
    v_mfma_f32_16x16x32_bf16 v[156:159], a[12:15], a[24:27], v[156:159]
    ds_read_b64_tr_b16 a[4:5], v13 offset:16384
    v_mfma_f32_16x16x32_bf16 v[188:191], a[12:15], a[28:31], v[188:191]
    ds_read_b64_tr_b16 a[6:7], v13 offset:20480
    s_waitcnt lgkmcnt(4)
    v_mfma_f32_16x16x32_bf16 v[128:131], a[16:19], a[36:39], v[128:131]
    ds_read_b64_tr_b16 a[8:9], v14 offset:16384
    v_mfma_f32_16x16x32_bf16 v[160:163], a[16:19], a[40:43], v[160:163]
    ds_read_b64_tr_b16 a[10:11], v14 offset:20480
    v_mfma_f32_16x16x32_bf16 v[132:135], a[20:23], a[36:39], v[132:135]
    ds_read_b64_tr_b16 a[12:13], v15 offset:16384
    v_mfma_f32_16x16x32_bf16 v[164:167], a[20:23], a[40:43], v[164:167]
    ds_read_b64_tr_b16 a[14:15], v15 offset:20480
    s_waitcnt lgkmcnt(4)
    v_mfma_f32_16x16x32_bf16 v[136:139], a[0:3], a[36:39], v[136:139]
    ds_read_b64_tr_b16 a[16:17], v16 offset:16384
    v_mfma_f32_16x16x32_bf16 v[168:171], a[0:3], a[40:43], v[168:171]
    ds_read_b64_tr_b16 a[18:19], v16 offset:20480
    v_mfma_f32_16x16x32_bf16 v[140:143], a[4:7], a[36:39], v[140:143]
    ds_read_b64_tr_b16 a[20:21], v17 offset:16384
    v_mfma_f32_16x16x32_bf16 v[172:175], a[4:7], a[40:43], v[172:175]
    ds_read_b64_tr_b16 a[22:23], v17 offset:20480
    s_waitcnt vmcnt(4)
    s_barrier
    ds_read_b128 a[24:27], v35 offset:0
    ds_read_b128 a[28:31], v35 offset:1024
    s_add_u32 m0, s28, 0x0
    s_nop 0
    buffer_load_dwordx4 v8, s[8:11], s23 offen lds
    s_waitcnt lgkmcnt(6)
    v_mfma_f32_16x16x32_bf16 v[144:147], a[8:11], a[36:39], v[144:147]
    ds_read_b64_tr_b16 a[0:1], v10 offset:32768
    v_mfma_f32_16x16x32_bf16 v[176:179], a[8:11], a[40:43], v[176:179]
    ds_read_b64_tr_b16 a[2:3], v10 offset:36864
    v_mfma_f32_16x16x32_bf16 v[148:151], a[12:15], a[36:39], v[148:151]
    ds_read_b64_tr_b16 a[4:5], v11 offset:32768
    v_mfma_f32_16x16x32_bf16 v[180:183], a[12:15], a[40:43], v[180:183]
    ds_read_b64_tr_b16 a[6:7], v11 offset:36864
    s_add_u32 m0, s28, 0x400
    s_nop 0
    buffer_load_dwordx4 v9, s[8:11], s23 offen lds
    s_add_u32 s23, s23, 110592
    s_waitcnt lgkmcnt(6)
    v_mfma_f32_16x16x32_bf16 v[152:155], a[16:19], a[36:39], v[152:155]
    ds_read_b64_tr_b16 a[8:9], v12 offset:32768
    v_mfma_f32_16x16x32_bf16 v[184:187], a[16:19], a[40:43], v[184:187]
    ds_read_b64_tr_b16 a[10:11], v12 offset:36864
    v_mfma_f32_16x16x32_bf16 v[156:159], a[20:23], a[36:39], v[156:159]
    ds_read_b64_tr_b16 a[12:13], v13 offset:32768
    v_mfma_f32_16x16x32_bf16 v[188:191], a[20:23], a[40:43], v[188:191]
    ds_read_b64_tr_b16 a[14:15], v13 offset:36864
    s_waitcnt lgkmcnt(4)
    v_mfma_f32_16x16x32_bf16 v[128:131], a[0:3], a[24:27], v[128:131]
    ds_read_b64_tr_b16 a[16:17], v14 offset:32768
    v_mfma_f32_16x16x32_bf16 v[160:163], a[0:3], a[28:31], v[160:163]
    ds_read_b64_tr_b16 a[18:19], v14 offset:36864
    v_mfma_f32_16x16x32_bf16 v[132:135], a[4:7], a[24:27], v[132:135]
    ds_read_b64_tr_b16 a[20:21], v15 offset:32768
    v_mfma_f32_16x16x32_bf16 v[164:167], a[4:7], a[28:31], v[164:167]
    ds_read_b64_tr_b16 a[22:23], v15 offset:36864
    s_waitcnt lgkmcnt(4)
    v_mfma_f32_16x16x32_bf16 v[136:139], a[8:11], a[24:27], v[136:139]
    ds_read_b64_tr_b16 a[0:1], v16 offset:32768
    v_mfma_f32_16x16x32_bf16 v[168:171], a[8:11], a[28:31], v[168:171]
    ds_read_b64_tr_b16 a[2:3], v16 offset:36864
    v_mfma_f32_16x16x32_bf16 v[140:143], a[12:15], a[24:27], v[140:143]
    ds_read_b64_tr_b16 a[4:5], v17 offset:32768
    v_mfma_f32_16x16x32_bf16 v[172:175], a[12:15], a[28:31], v[172:175]
    ds_read_b64_tr_b16 a[6:7], v17 offset:36864
    s_waitcnt vmcnt(4)
    s_barrier
    ds_write_b128 v4, v[52:55] offset:0
    ds_write_b128 v5, v[72:75] offset:0
    ds_write_b128 v6, v[92:95] offset:0
    ds_write_b128 v7, v[112:115] offset:0
    ds_read_b128 a[36:39], v35 offset:8256
    ds_read_b128 a[40:43], v35 offset:9280
    s_add_u32 m0, s28, 0x4000
    s_nop 0
    buffer_load_dwordx4 v8, s[8:11], s23 offen lds
    s_waitcnt lgkmcnt(10)
    v_mfma_f32_16x16x32_bf16 v[144:147], a[16:19], a[24:27], v[144:147]
    ds_read_b64_tr_b16 a[8:9], v10 offset:49152
    v_mfma_f32_16x16x32_bf16 v[176:179], a[16:19], a[28:31], v[176:179]
    ds_read_b64_tr_b16 a[10:11], v10 offset:53248
    v_mfma_f32_16x16x32_bf16 v[148:151], a[20:23], a[24:27], v[148:151]
    ds_read_b64_tr_b16 a[12:13], v11 offset:49152
    v_mfma_f32_16x16x32_bf16 v[180:183], a[20:23], a[28:31], v[180:183]
    ds_read_b64_tr_b16 a[14:15], v11 offset:53248
    s_add_u32 m0, s28, 0x4400
    s_nop 0
    buffer_load_dwordx4 v9, s[8:11], s23 offen lds
    s_add_u32 s23, s23, 110592
    s_waitcnt lgkmcnt(10)
    v_mfma_f32_16x16x32_bf16 v[152:155], a[0:3], a[24:27], v[152:155]
    ds_read_b64_tr_b16 a[16:17], v12 offset:49152
    v_mfma_f32_16x16x32_bf16 v[184:187], a[0:3], a[28:31], v[184:187]
    ds_read_b64_tr_b16 a[18:19], v12 offset:53248
    v_mfma_f32_16x16x32_bf16 v[156:159], a[4:7], a[24:27], v[156:159]
    ds_read_b64_tr_b16 a[20:21], v13 offset:49152
    v_mfma_f32_16x16x32_bf16 v[188:191], a[4:7], a[28:31], v[188:191]
    ds_read_b64_tr_b16 a[22:23], v13 offset:53248
    s_waitcnt lgkmcnt(4)
    v_mfma_f32_16x16x32_bf16 v[128:131], a[8:11], a[36:39], v[128:131]
    ds_read_b64_tr_b16 a[0:1], v14 offset:49152
    v_mfma_f32_16x16x32_bf16 v[160:163], a[8:11], a[40:43], v[160:163]
    ds_read_b64_tr_b16 a[2:3], v14 offset:53248
    v_mfma_f32_16x16x32_bf16 v[132:135], a[12:15], a[36:39], v[132:135]
    ds_read_b64_tr_b16 a[4:5], v15 offset:49152
    v_mfma_f32_16x16x32_bf16 v[164:167], a[12:15], a[40:43], v[164:167]
    ds_read_b64_tr_b16 a[6:7], v15 offset:53248
    s_waitcnt lgkmcnt(4)
    v_mfma_f32_16x16x32_bf16 v[136:139], a[16:19], a[36:39], v[136:139]
    ds_read_b64_tr_b16 a[8:9], v16 offset:49152
    v_mfma_f32_16x16x32_bf16 v[168:171], a[16:19], a[40:43], v[168:171]
    ds_read_b64_tr_b16 a[10:11], v16 offset:53248
    v_mfma_f32_16x16x32_bf16 v[140:143], a[20:23], a[36:39], v[140:143]
    ds_read_b64_tr_b16 a[12:13], v17 offset:49152
    v_mfma_f32_16x16x32_bf16 v[172:175], a[20:23], a[40:43], v[172:175]
    ds_read_b64_tr_b16 a[14:15], v17 offset:53248
    s_waitcnt vmcnt(4)
    s_barrier
    ds_read_b128 a[24:27], v35 offset:16512
    ds_read_b128 a[28:31], v35 offset:17536
    s_add_u32 m0, s28, 0x8000
    s_nop 0
    buffer_load_dwordx4 v8, s[8:11], s23 offen lds
    s_waitcnt lgkmcnt(6)
    v_mfma_f32_16x16x32_bf16 v[144:147], a[0:3], a[36:39], v[144:147]
    ds_read_b64_tr_b16 a[16:17], v21 offset:0
    v_mfma_f32_16x16x32_bf16 v[176:179], a[0:3], a[40:43], v[176:179]
    ds_read_b64_tr_b16 a[18:19], v21 offset:4096
    v_mfma_f32_16x16x32_bf16 v[148:151], a[4:7], a[36:39], v[148:151]
    ds_read_b64_tr_b16 a[20:21], v22 offset:0
    v_mfma_f32_16x16x32_bf16 v[180:183], a[4:7], a[40:43], v[180:183]
    ds_read_b64_tr_b16 a[22:23], v22 offset:4096
    s_add_u32 m0, s28, 0x8400
    s_nop 0
    buffer_load_dwordx4 v9, s[8:11], s23 offen lds
    s_add_u32 s23, s23, 110592
    s_waitcnt lgkmcnt(6)
    v_mfma_f32_16x16x32_bf16 v[152:155], a[8:11], a[36:39], v[152:155]
    ds_read_b64_tr_b16 a[0:1], v23 offset:0
    v_mfma_f32_16x16x32_bf16 v[184:187], a[8:11], a[40:43], v[184:187]
    ds_read_b64_tr_b16 a[2:3], v23 offset:4096
    v_mfma_f32_16x16x32_bf16 v[156:159], a[12:15], a[36:39], v[156:159]
    ds_read_b64_tr_b16 a[4:5], v24 offset:0
    v_mfma_f32_16x16x32_bf16 v[188:191], a[12:15], a[40:43], v[188:191]
    ds_read_b64_tr_b16 a[6:7], v24 offset:4096
    s_waitcnt lgkmcnt(4)
    v_mfma_f32_16x16x32_bf16 v[128:131], a[16:19], a[24:27], v[128:131]
    ds_read_b64_tr_b16 a[8:9], v25 offset:0
    v_mfma_f32_16x16x32_bf16 v[160:163], a[16:19], a[28:31], v[160:163]
    ds_read_b64_tr_b16 a[10:11], v25 offset:4096
    v_mfma_f32_16x16x32_bf16 v[132:135], a[20:23], a[24:27], v[132:135]
    ds_read_b64_tr_b16 a[12:13], v26 offset:0
    v_mfma_f32_16x16x32_bf16 v[164:167], a[20:23], a[28:31], v[164:167]
    ds_read_b64_tr_b16 a[14:15], v26 offset:4096
    s_waitcnt lgkmcnt(4)
    v_mfma_f32_16x16x32_bf16 v[136:139], a[0:3], a[24:27], v[136:139]
    ds_read_b64_tr_b16 a[16:17], v27 offset:0
    v_mfma_f32_16x16x32_bf16 v[168:171], a[0:3], a[28:31], v[168:171]
    ds_read_b64_tr_b16 a[18:19], v27 offset:4096
    v_mfma_f32_16x16x32_bf16 v[140:143], a[4:7], a[24:27], v[140:143]
    ds_read_b64_tr_b16 a[20:21], v28 offset:0
    v_mfma_f32_16x16x32_bf16 v[172:175], a[4:7], a[28:31], v[172:175]
    ds_read_b64_tr_b16 a[22:23], v28 offset:4096
    s_waitcnt vmcnt(4)
    s_barrier
    ds_read_b128 a[36:39], v35 offset:24768
    ds_read_b128 a[40:43], v35 offset:25792
    s_add_u32 m0, s28, 0xc000
    s_nop 0
    buffer_load_dwordx4 v8, s[8:11], s23 offen lds
    s_waitcnt lgkmcnt(6)
    v_mfma_f32_16x16x32_bf16 v[144:147], a[8:11], a[24:27], v[144:147]
    ds_read_b64_tr_b16 a[0:1], v10 offset:0
    v_mfma_f32_16x16x32_bf16 v[176:179], a[8:11], a[28:31], v[176:179]
    ds_read_b64_tr_b16 a[2:3], v10 offset:4096
    v_mfma_f32_16x16x32_bf16 v[148:151], a[12:15], a[24:27], v[148:151]
    ds_read_b64_tr_b16 a[4:5], v11 offset:0
    v_mfma_f32_16x16x32_bf16 v[180:183], a[12:15], a[28:31], v[180:183]
    ds_read_b64_tr_b16 a[6:7], v11 offset:4096
    s_add_u32 m0, s28, 0xc400
    s_nop 0
    buffer_load_dwordx4 v9, s[8:11], s23 offen lds
    s_add_u32 s23, s23, 110592
    s_waitcnt lgkmcnt(6)
    v_mfma_f32_16x16x32_bf16 v[152:155], a[16:19], a[24:27], v[152:155]
    ds_read_b64_tr_b16 a[8:9], v12 offset:0
    v_mfma_f32_16x16x32_bf16 v[184:187], a[16:19], a[28:31], v[184:187]
    ds_read_b64_tr_b16 a[10:11], v12 offset:4096
    v_mfma_f32_16x16x32_bf16 v[156:159], a[20:23], a[24:27], v[156:159]
    ds_read_b64_tr_b16 a[12:13], v13 offset:0
    v_mfma_f32_16x16x32_bf16 v[188:191], a[20:23], a[28:31], v[188:191]
    ds_read_b64_tr_b16 a[14:15], v13 offset:4096
    s_waitcnt lgkmcnt(4)
    v_mfma_f32_16x16x32_bf16 v[128:131], a[0:3], a[36:39], v[128:131]
    ds_read_b64_tr_b16 a[16:17], v14 offset:0
    v_mfma_f32_16x16x32_bf16 v[160:163], a[0:3], a[40:43], v[160:163]
    ds_read_b64_tr_b16 a[18:19], v14 offset:4096
    v_mfma_f32_16x16x32_bf16 v[132:135], a[4:7], a[36:39], v[132:135]
    ds_read_b64_tr_b16 a[20:21], v15 offset:0
    v_mfma_f32_16x16x32_bf16 v[164:167], a[4:7], a[40:43], v[164:167]
    ds_read_b64_tr_b16 a[22:23], v15 offset:4096
    s_waitcnt lgkmcnt(4)
    v_mfma_f32_16x16x32_bf16 v[136:139], a[8:11], a[36:39], v[136:139]
    ds_read_b64_tr_b16 a[0:1], v16 offset:0
    v_mfma_f32_16x16x32_bf16 v[168:171], a[8:11], a[40:43], v[168:171]
    ds_read_b64_tr_b16 a[2:3], v16 offset:4096
    v_mfma_f32_16x16x32_bf16 v[140:143], a[12:15], a[36:39], v[140:143]
    ds_read_b64_tr_b16 a[4:5], v17 offset:0
    v_mfma_f32_16x16x32_bf16 v[172:175], a[12:15], a[40:43], v[172:175]
    ds_read_b64_tr_b16 a[6:7], v17 offset:4096
    s_waitcnt vmcnt(4)
    s_barrier
    ds_read_b128 a[24:27], v32 offset:0
    ds_read_b128 a[28:31], v32 offset:1024
    s_add_u32 m0, s28, 0x10000
    s_nop 0
    buffer_load_dwordx4 v8, s[8:11], s23 offen lds
    s_waitcnt lgkmcnt(6)
    v_mfma_f32_16x16x32_bf16 v[144:147], a[16:19], a[36:39], v[144:147]
    ds_read_b64_tr_b16 a[8:9], v10 offset:16384
    v_mfma_f32_16x16x32_bf16 v[176:179], a[16:19], a[40:43], v[176:179]
    ds_read_b64_tr_b16 a[10:11], v10 offset:20480
    v_mfma_f32_16x16x32_bf16 v[148:151], a[20:23], a[36:39], v[148:151]
    ds_read_b64_tr_b16 a[12:13], v11 offset:16384
    v_mfma_f32_16x16x32_bf16 v[180:183], a[20:23], a[40:43], v[180:183]
    ds_read_b64_tr_b16 a[14:15], v11 offset:20480
    s_add_u32 m0, s28, 0x10400
    s_nop 0
    buffer_load_dwordx4 v9, s[8:11], s23 offen lds
    s_add_u32 s23, s23, 110592
    s_waitcnt lgkmcnt(6)
    v_mfma_f32_16x16x32_bf16 v[152:155], a[0:3], a[36:39], v[152:155]
    ds_read_b64_tr_b16 a[16:17], v12 offset:16384
    v_mfma_f32_16x16x32_bf16 v[184:187], a[0:3], a[40:43], v[184:187]
    ds_read_b64_tr_b16 a[18:19], v12 offset:20480
    v_mfma_f32_16x16x32_bf16 v[156:159], a[4:7], a[36:39], v[156:159]
    ds_read_b64_tr_b16 a[20:21], v13 offset:16384
    v_mfma_f32_16x16x32_bf16 v[188:191], a[4:7], a[40:43], v[188:191]
    ds_read_b64_tr_b16 a[22:23], v13 offset:20480
    s_waitcnt lgkmcnt(4)
    v_mfma_f32_16x16x32_bf16 v[128:131], a[8:11], a[24:27], v[128:131]
    ds_read_b64_tr_b16 a[0:1], v14 offset:16384
    v_mfma_f32_16x16x32_bf16 v[160:163], a[8:11], a[28:31], v[160:163]
    ds_read_b64_tr_b16 a[2:3], v14 offset:20480
    v_mfma_f32_16x16x32_bf16 v[132:135], a[12:15], a[24:27], v[132:135]
    ds_read_b64_tr_b16 a[4:5], v15 offset:16384
    v_mfma_f32_16x16x32_bf16 v[164:167], a[12:15], a[28:31], v[164:167]
    ds_read_b64_tr_b16 a[6:7], v15 offset:20480
    s_waitcnt lgkmcnt(4)
    v_mfma_f32_16x16x32_bf16 v[136:139], a[16:19], a[24:27], v[136:139]
    ds_read_b64_tr_b16 a[8:9], v16 offset:16384
    v_mfma_f32_16x16x32_bf16 v[168:171], a[16:19], a[28:31], v[168:171]
    ds_read_b64_tr_b16 a[10:11], v16 offset:20480
    v_mfma_f32_16x16x32_bf16 v[140:143], a[20:23], a[24:27], v[140:143]
    ds_read_b64_tr_b16 a[12:13], v17 offset:16384
    v_mfma_f32_16x16x32_bf16 v[172:175], a[20:23], a[28:31], v[172:175]
    ds_read_b64_tr_b16 a[14:15], v17 offset:20480
    s_waitcnt vmcnt(4)
    s_barrier
    ds_read_b128 a[36:39], v32 offset:8256
    ds_read_b128 a[40:43], v32 offset:9280
    s_waitcnt lgkmcnt(6)
    v_mfma_f32_16x16x32_bf16 v[144:147], a[0:3], a[24:27], v[144:147]
    ds_read_b64_tr_b16 a[16:17], v10 offset:32768
    v_mfma_f32_16x16x32_bf16 v[176:179], a[0:3], a[28:31], v[176:179]
    ds_read_b64_tr_b16 a[18:19], v10 offset:36864
    v_mfma_f32_16x16x32_bf16 v[148:151], a[4:7], a[24:27], v[148:151]
    ds_read_b64_tr_b16 a[20:21], v11 offset:32768
    v_mfma_f32_16x16x32_bf16 v[180:183], a[4:7], a[28:31], v[180:183]
    ds_read_b64_tr_b16 a[22:23], v11 offset:36864
    s_waitcnt lgkmcnt(6)
    v_mfma_f32_16x16x32_bf16 v[152:155], a[8:11], a[24:27], v[152:155]
    ds_read_b64_tr_b16 a[0:1], v12 offset:32768
    v_mfma_f32_16x16x32_bf16 v[184:187], a[8:11], a[28:31], v[184:187]
    ds_read_b64_tr_b16 a[2:3], v12 offset:36864
    v_mfma_f32_16x16x32_bf16 v[156:159], a[12:15], a[24:27], v[156:159]
    ds_read_b64_tr_b16 a[4:5], v13 offset:32768
    v_mfma_f32_16x16x32_bf16 v[188:191], a[12:15], a[28:31], v[188:191]
    ds_read_b64_tr_b16 a[6:7], v13 offset:36864
    s_waitcnt lgkmcnt(4)
    v_mfma_f32_16x16x32_bf16 v[128:131], a[16:19], a[36:39], v[128:131]
    ds_read_b64_tr_b16 a[8:9], v14 offset:32768
    v_mfma_f32_16x16x32_bf16 v[160:163], a[16:19], a[40:43], v[160:163]
    ds_read_b64_tr_b16 a[10:11], v14 offset:36864
    v_mfma_f32_16x16x32_bf16 v[132:135], a[20:23], a[36:39], v[132:135]
    ds_read_b64_tr_b16 a[12:13], v15 offset:32768
    v_mfma_f32_16x16x32_bf16 v[164:167], a[20:23], a[40:43], v[164:167]
    ds_read_b64_tr_b16 a[14:15], v15 offset:36864
    s_waitcnt lgkmcnt(4)
    v_mfma_f32_16x16x32_bf16 v[136:139], a[0:3], a[36:39], v[136:139]
    ds_read_b64_tr_b16 a[16:17], v16 offset:32768
    v_mfma_f32_16x16x32_bf16 v[168:171], a[0:3], a[40:43], v[168:171]
    ds_read_b64_tr_b16 a[18:19], v16 offset:36864
    v_mfma_f32_16x16x32_bf16 v[140:143], a[4:7], a[36:39], v[140:143]
    ds_read_b64_tr_b16 a[20:21], v17 offset:32768
    v_mfma_f32_16x16x32_bf16 v[172:175], a[4:7], a[40:43], v[172:175]
    ds_read_b64_tr_b16 a[22:23], v17 offset:36864
    s_waitcnt vmcnt(2)
    s_barrier
    ds_read_b128 a[24:27], v32 offset:16512
    ds_read_b128 a[28:31], v32 offset:17536
    s_waitcnt lgkmcnt(6)
    v_mfma_f32_16x16x32_bf16 v[144:147], a[8:11], a[36:39], v[144:147]
    ds_read_b64_tr_b16 a[0:1], v10 offset:49152
    v_mfma_f32_16x16x32_bf16 v[176:179], a[8:11], a[40:43], v[176:179]
    ds_read_b64_tr_b16 a[2:3], v10 offset:53248
    v_mfma_f32_16x16x32_bf16 v[148:151], a[12:15], a[36:39], v[148:151]
    ds_read_b64_tr_b16 a[4:5], v11 offset:49152
    v_mfma_f32_16x16x32_bf16 v[180:183], a[12:15], a[40:43], v[180:183]
    ds_read_b64_tr_b16 a[6:7], v11 offset:53248
    s_waitcnt lgkmcnt(6)
    v_mfma_f32_16x16x32_bf16 v[152:155], a[16:19], a[36:39], v[152:155]
    ds_read_b64_tr_b16 a[8:9], v12 offset:49152
    v_mfma_f32_16x16x32_bf16 v[184:187], a[16:19], a[40:43], v[184:187]
    ds_read_b64_tr_b16 a[10:11], v12 offset:53248
    v_mfma_f32_16x16x32_bf16 v[156:159], a[20:23], a[36:39], v[156:159]
    ds_read_b64_tr_b16 a[12:13], v13 offset:49152
    v_mfma_f32_16x16x32_bf16 v[188:191], a[20:23], a[40:43], v[188:191]
    ds_read_b64_tr_b16 a[14:15], v13 offset:53248
    s_waitcnt lgkmcnt(4)
    v_mfma_f32_16x16x32_bf16 v[128:131], a[0:3], a[24:27], v[128:131]
    ds_read_b64_tr_b16 a[16:17], v14 offset:49152
    v_mfma_f32_16x16x32_bf16 v[160:163], a[0:3], a[28:31], v[160:163]
    ds_read_b64_tr_b16 a[18:19], v14 offset:53248
    v_mfma_f32_16x16x32_bf16 v[132:135], a[4:7], a[24:27], v[132:135]
    ds_read_b64_tr_b16 a[20:21], v15 offset:49152
    v_mfma_f32_16x16x32_bf16 v[164:167], a[4:7], a[28:31], v[164:167]
    ds_read_b64_tr_b16 a[22:23], v15 offset:53248
    s_waitcnt lgkmcnt(4)
    v_mfma_f32_16x16x32_bf16 v[136:139], a[8:11], a[24:27], v[136:139]
    ds_read_b64_tr_b16 a[0:1], v16 offset:49152
    v_mfma_f32_16x16x32_bf16 v[168:171], a[8:11], a[28:31], v[168:171]
    ds_read_b64_tr_b16 a[2:3], v16 offset:53248
    v_mfma_f32_16x16x32_bf16 v[140:143], a[12:15], a[24:27], v[140:143]
    ds_read_b64_tr_b16 a[4:5], v17 offset:49152
    v_mfma_f32_16x16x32_bf16 v[172:175], a[12:15], a[28:31], v[172:175]
    ds_read_b64_tr_b16 a[6:7], v17 offset:53248
    s_waitcnt vmcnt(0)
    s_barrier
    ds_read_b128 a[36:39], v32 offset:24768
    ds_read_b128 a[40:43], v32 offset:25792
    s_waitcnt lgkmcnt(6)
    v_mfma_f32_16x16x32_bf16 v[144:147], a[16:19], a[24:27], v[144:147]
    ds_read_b64_tr_b16 a[8:9], v21 offset:0
    v_mfma_f32_16x16x32_bf16 v[176:179], a[16:19], a[28:31], v[176:179]
    ds_read_b64_tr_b16 a[10:11], v21 offset:4096
    v_mfma_f32_16x16x32_bf16 v[148:151], a[20:23], a[24:27], v[148:151]
    ds_read_b64_tr_b16 a[12:13], v22 offset:0
    v_mfma_f32_16x16x32_bf16 v[180:183], a[20:23], a[28:31], v[180:183]
    ds_read_b64_tr_b16 a[14:15], v22 offset:4096
    s_waitcnt lgkmcnt(6)
    v_mfma_f32_16x16x32_bf16 v[152:155], a[0:3], a[24:27], v[152:155]
    ds_read_b64_tr_b16 a[16:17], v23 offset:0
    v_mfma_f32_16x16x32_bf16 v[184:187], a[0:3], a[28:31], v[184:187]
    ds_read_b64_tr_b16 a[18:19], v23 offset:4096
    v_mfma_f32_16x16x32_bf16 v[156:159], a[4:7], a[24:27], v[156:159]
    ds_read_b64_tr_b16 a[20:21], v24 offset:0
    v_mfma_f32_16x16x32_bf16 v[188:191], a[4:7], a[28:31], v[188:191]
    ds_read_b64_tr_b16 a[22:23], v24 offset:4096
    s_waitcnt lgkmcnt(4)
    v_mfma_f32_16x16x32_bf16 v[128:131], a[8:11], a[36:39], v[128:131]
    ds_read_b64_tr_b16 a[0:1], v25 offset:0
    v_mfma_f32_16x16x32_bf16 v[160:163], a[8:11], a[40:43], v[160:163]
    ds_read_b64_tr_b16 a[2:3], v25 offset:4096
    v_mfma_f32_16x16x32_bf16 v[132:135], a[12:15], a[36:39], v[132:135]
    ds_read_b64_tr_b16 a[4:5], v26 offset:0
    v_mfma_f32_16x16x32_bf16 v[164:167], a[12:15], a[40:43], v[164:167]
    ds_read_b64_tr_b16 a[6:7], v26 offset:4096
    s_waitcnt lgkmcnt(4)
    v_mfma_f32_16x16x32_bf16 v[136:139], a[16:19], a[36:39], v[136:139]
    ds_read_b64_tr_b16 a[8:9], v27 offset:0
    v_mfma_f32_16x16x32_bf16 v[168:171], a[16:19], a[40:43], v[168:171]
    ds_read_b64_tr_b16 a[10:11], v27 offset:4096
    v_mfma_f32_16x16x32_bf16 v[140:143], a[20:23], a[36:39], v[140:143]
    ds_read_b64_tr_b16 a[12:13], v28 offset:0
    v_mfma_f32_16x16x32_bf16 v[172:175], a[20:23], a[40:43], v[172:175]
    ds_read_b64_tr_b16 a[14:15], v28 offset:4096
    s_waitcnt lgkmcnt(4)
    v_mfma_f32_16x16x32_bf16 v[144:147], a[0:3], a[36:39], v[144:147]
    v_mfma_f32_16x16x32_bf16 v[176:179], a[0:3], a[40:43], v[176:179]
    v_mfma_f32_16x16x32_bf16 v[148:151], a[4:7], a[36:39], v[148:151]
    v_mfma_f32_16x16x32_bf16 v[180:183], a[4:7], a[40:43], v[180:183]
    s_waitcnt lgkmcnt(0)
    v_mfma_f32_16x16x32_bf16 v[152:155], a[8:11], a[36:39], v[152:155]
    v_mfma_f32_16x16x32_bf16 v[184:187], a[8:11], a[40:43], v[184:187]
    v_mfma_f32_16x16x32_bf16 v[156:159], a[12:15], a[36:39], v[156:159]
    v_mfma_f32_16x16x32_bf16 v[188:191], a[12:15], a[40:43], v[188:191]
    s_branch L_k1_H_done
L_k1_H_ph1:
    s_waitcnt vmcnt(6)
    s_barrier
    ds_read_b128 a[24:27], v32 offset:0
    ds_read_b128 a[28:31], v32 offset:1024
    ds_read_b64_tr_b16 a[0:1], v10 offset:0
    ds_read_b64_tr_b16 a[2:3], v10 offset:4096
    ds_read_b64_tr_b16 a[4:5], v11 offset:0
    ds_read_b64_tr_b16 a[6:7], v11 offset:4096
    ds_read_b64_tr_b16 a[8:9], v12 offset:0
    ds_read_b64_tr_b16 a[10:11], v12 offset:4096
    ds_read_b64_tr_b16 a[12:13], v13 offset:0
    ds_read_b64_tr_b16 a[14:15], v13 offset:4096
    s_waitcnt lgkmcnt(4)
    v_mfma_f32_16x16x32_bf16 v[128:131], a[0:3], a[24:27], 0
    ds_read_b64_tr_b16 a[16:17], v14 offset:0
    v_mfma_f32_16x16x32_bf16 v[160:163], a[0:3], a[28:31], 0
    ds_read_b64_tr_b16 a[18:19], v14 offset:4096
    v_mfma_f32_16x16x32_bf16 v[132:135], a[4:7], a[24:27], 0
    ds_read_b64_tr_b16 a[20:21], v15 offset:0
    v_mfma_f32_16x16x32_bf16 v[164:167], a[4:7], a[28:31], 0
    ds_read_b64_tr_b16 a[22:23], v15 offset:4096
    s_waitcnt lgkmcnt(4)
    v_mfma_f32_16x16x32_bf16 v[136:139], a[8:11], a[24:27], 0
    ds_read_b64_tr_b16 a[0:1], v16 offset:0
    v_mfma_f32_16x16x32_bf16 v[168:171], a[8:11], a[28:31], 0
    ds_read_b64_tr_b16 a[2:3], v16 offset:4096
    v_mfma_f32_16x16x32_bf16 v[140:143], a[12:15], a[24:27], 0
    ds_read_b64_tr_b16 a[4:5], v17 offset:0
    v_mfma_f32_16x16x32_bf16 v[172:175], a[12:15], a[28:31], 0
    ds_read_b64_tr_b16 a[6:7], v17 offset:4096
    s_waitcnt vmcnt(4)
    s_barrier
    ds_write_b128 v4, v[40:43] offset:33024
    ds_write_b128 v5, v[60:63] offset:33024
    ds_write_b128 v6, v[80:83] offset:33024
    ds_write_b128 v7, v[100:103] offset:33024
    ds_read_b128 a[36:39], v32 offset:8256
    ds_read_b128 a[40:43], v32 offset:9280
    s_waitcnt lgkmcnt(10)
    v_mfma_f32_16x16x32_bf16 v[144:147], a[16:19], a[24:27], 0
    ds_read_b64_tr_b16 a[8:9], v10 offset:16384
    v_mfma_f32_16x16x32_bf16 v[176:179], a[16:19], a[28:31], 0
    ds_read_b64_tr_b16 a[10:11], v10 offset:20480
    v_mfma_f32_16x16x32_bf16 v[148:151], a[20:23], a[24:27], 0
    ds_read_b64_tr_b16 a[12:13], v11 offset:16384
    v_mfma_f32_16x16x32_bf16 v[180:183], a[20:23], a[28:31], 0
    ds_read_b64_tr_b16 a[14:15], v11 offset:20480
    s_waitcnt lgkmcnt(10)
    v_mfma_f32_16x16x32_bf16 v[152:155], a[0:3], a[24:27], 0
    ds_read_b64_tr_b16 a[16:17], v12 offset:16384
    v_mfma_f32_16x16x32_bf16 v[184:187], a[0:3], a[28:31], 0
    ds_read_b64_tr_b16 a[18:19], v12 offset:20480
    v_mfma_f32_16x16x32_bf16 v[156:159], a[4:7], a[24:27], 0
    ds_read_b64_tr_b16 a[20:21], v13 offset:16384
    v_mfma_f32_16x16x32_bf16 v[188:191], a[4:7], a[28:31], 0
    ds_read_b64_tr_b16 a[22:23], v13 offset:20480
    s_add_u32 m0, s28, 0x10000
    s_nop 0
    buffer_load_dwordx4 v8, s[8:11], s23 offen lds
    s_waitcnt lgkmcnt(4)
    v_mfma_f32_16x16x32_bf16 v[128:131], a[8:11], a[36:39], v[128:131]
    ds_read_b64_tr_b16 a[0:1], v14 offset:16384
    v_mfma_f32_16x16x32_bf16 v[160:163], a[8:11], a[40:43], v[160:163]
    ds_read_b64_tr_b16 a[2:3], v14 offset:20480
    v_mfma_f32_16x16x32_bf16 v[132:135], a[12:15], a[36:39], v[132:135]
    ds_read_b64_tr_b16 a[4:5], v15 offset:16384
    v_mfma_f32_16x16x32_bf16 v[164:167], a[12:15], a[40:43], v[164:167]
    ds_read_b64_tr_b16 a[6:7], v15 offset:20480
    s_add_u32 m0, s28, 0x10400
    s_nop 0
    buffer_load_dwordx4 v9, s[8:11], s23 offen lds
    s_add_u32 s23, s23, 110592
    s_waitcnt lgkmcnt(4)
    v_mfma_f32_16x16x32_bf16 v[136:139], a[16:19], a[36:39], v[136:139]
    ds_read_b64_tr_b16 a[8:9], v16 offset:16384
    v_mfma_f32_16x16x32_bf16 v[168:171], a[16:19], a[40:43], v[168:171]
    ds_read_b64_tr_b16 a[10:11], v16 offset:20480
    v_mfma_f32_16x16x32_bf16 v[140:143], a[20:23], a[36:39], v[140:143]
    ds_read_b64_tr_b16 a[12:13], v17 offset:16384
    v_mfma_f32_16x16x32_bf16 v[172:175], a[20:23], a[40:43], v[172:175]
    ds_read_b64_tr_b16 a[14:15], v17 offset:20480
    s_waitcnt vmcnt(4)
    s_barrier
    ds_read_b128 a[24:27], v32 offset:16512
    ds_read_b128 a[28:31], v32 offset:17536
    s_waitcnt lgkmcnt(6)
    v_mfma_f32_16x16x32_bf16 v[144:147], a[0:3], a[36:39], v[144:147]
    ds_read_b64_tr_b16 a[16:17], v10 offset:32768
    v_mfma_f32_16x16x32_bf16 v[176:179], a[0:3], a[40:43], v[176:179]
    ds_read_b64_tr_b16 a[18:19], v10 offset:36864
    v_mfma_f32_16x16x32_bf16 v[148:151], a[4:7], a[36:39], v[148:151]
    ds_read_b64_tr_b16 a[20:21], v11 offset:32768
    v_mfma_f32_16x16x32_bf16 v[180:183], a[4:7], a[40:43], v[180:183]
    ds_read_b64_tr_b16 a[22:23], v11 offset:36864
    s_waitcnt lgkmcnt(6)
    v_mfma_f32_16x16x32_bf16 v[152:155], a[8:11], a[36:39], v[152:155]
    ds_read_b64_tr_b16 a[0:1], v12 offset:32768
    v_mfma_f32_16x16x32_bf16 v[184:187], a[8:11], a[40:43], v[184:187]
    ds_read_b64_tr_b16 a[2:3], v12 offset:36864
    v_mfma_f32_16x16x32_bf16 v[156:159], a[12:15], a[36:39], v[156:159]
    ds_read_b64_tr_b16 a[4:5], v13 offset:32768
    v_mfma_f32_16x16x32_bf16 v[188:191], a[12:15], a[40:43], v[188:191]
    ds_read_b64_tr_b16 a[6:7], v13 offset:36864
    s_add_u32 m0, s28, 0x0
    s_nop 0
    buffer_load_dwordx4 v8, s[8:11], s23 offen lds
    s_waitcnt lgkmcnt(4)
    v_mfma_f32_16x16x32_bf16 v[128:131], a[16:19], a[24:27], v[128:131]
    ds_read_b64_tr_b16 a[8:9], v14 offset:32768
    v_mfma_f32_16x16x32_bf16 v[160:163], a[16:19], a[28:31], v[160:163]
    ds_read_b64_tr_b16 a[10:11], v14 offset:36864
    v_mfma_f32_16x16x32_bf16 v[132:135], a[20:23], a[24:27], v[132:135]
    ds_read_b64_tr_b16 a[12:13], v15 offset:32768
    v_mfma_f32_16x16x32_bf16 v[164:167], a[20:23], a[28:31], v[164:167]
    ds_read_b64_tr_b16 a[14:15], v15 offset:36864
    s_add_u32 m0, s28, 0x400
    s_nop 0
    buffer_load_dwordx4 v9, s[8:11], s23 offen lds
    s_add_u32 s23, s23, 110592
    s_waitcnt lgkmcnt(4)
    v_mfma_f32_16x16x32_bf16 v[136:139], a[0:3], a[24:27], v[136:139]
    ds_read_b64_tr_b16 a[16:17], v16 offset:32768
    v_mfma_f32_16x16x32_bf16 v[168:171], a[0:3], a[28:31], v[168:171]
    ds_read_b64_tr_b16 a[18:19], v16 offset:36864
    v_mfma_f32_16x16x32_bf16 v[140:143], a[4:7], a[24:27], v[140:143]
    ds_read_b64_tr_b16 a[20:21], v17 offset:32768
    v_mfma_f32_16x16x32_bf16 v[172:175], a[4:7], a[28:31], v[172:175]
    ds_read_b64_tr_b16 a[22:23], v17 offset:36864
    s_waitcnt vmcnt(4)
    s_barrier
    ds_read_b128 a[36:39], v32 offset:24768
    ds_read_b128 a[40:43], v32 offset:25792
    s_waitcnt lgkmcnt(6)
    v_mfma_f32_16x16x32_bf16 v[144:147], a[8:11], a[24:27], v[144:147]
    ds_read_b64_tr_b16 a[0:1], v10 offset:49152
    v_mfma_f32_16x16x32_bf16 v[176:179], a[8:11], a[28:31], v[176:179]
    ds_read_b64_tr_b16 a[2:3], v10 offset:53248
    v_mfma_f32_16x16x32_bf16 v[148:151], a[12:15], a[24:27], v[148:151]
    ds_read_b64_tr_b16 a[4:5], v11 offset:49152
    v_mfma_f32_16x16x32_bf16 v[180:183], a[12:15], a[28:31], v[180:183]
    ds_read_b64_tr_b16 a[6:7], v11 offset:53248
    s_waitcnt lgkmcnt(6)
    v_mfma_f32_16x16x32_bf16 v[152:155], a[16:19], a[24:27], v[152:155]
    ds_read_b64_tr_b16 a[8:9], v12 offset:49152
    v_mfma_f32_16x16x32_bf16 v[184:187], a[16:19], a[28:31], v[184:187]
    ds_read_b64_tr_b16 a[10:11], v12 offset:53248
    v_mfma_f32_16x16x32_bf16 v[156:159], a[20:23], a[24:27], v[156:159]
    ds_read_b64_tr_b16 a[12:13], v13 offset:49152
    v_mfma_f32_16x16x32_bf16 v[188:191], a[20:23], a[28:31], v[188:191]
    ds_read_b64_tr_b16 a[14:15], v13 offset:53248
    s_add_u32 m0, s28, 0x4000
    s_nop 0
    buffer_load_dwordx4 v8, s[8:11], s23 offen lds
    s_waitcnt lgkmcnt(4)
    v_mfma_f32_16x16x32_bf16 v[128:131], a[0:3], a[36:39], v[128:131]
    ds_read_b64_tr_b16 a[16:17], v14 offset:49152
    v_mfma_f32_16x16x32_bf16 v[160:163], a[0:3], a[40:43], v[160:163]
    ds_read_b64_tr_b16 a[18:19], v14 offset:53248
    v_mfma_f32_16x16x32_bf16 v[132:135], a[4:7], a[36:39], v[132:135]
    ds_read_b64_tr_b16 a[20:21], v15 offset:49152
    v_mfma_f32_16x16x32_bf16 v[164:167], a[4:7], a[40:43], v[164:167]
    ds_read_b64_tr_b16 a[22:23], v15 offset:53248
    s_add_u32 m0, s28, 0x4400
    s_nop 0
    buffer_load_dwordx4 v9, s[8:11], s23 offen lds
    s_add_u32 s23, s23, 110592
    s_waitcnt lgkmcnt(4)
    v_mfma_f32_16x16x32_bf16 v[136:139], a[8:11], a[36:39], v[136:139]
    ds_read_b64_tr_b16 a[0:1], v16 offset:49152
    v_mfma_f32_16x16x32_bf16 v[168:171], a[8:11], a[40:43], v[168:171]
    ds_read_b64_tr_b16 a[2:3], v16 offset:53248
    v_mfma_f32_16x16x32_bf16 v[140:143], a[12:15], a[36:39], v[140:143]
    ds_read_b64_tr_b16 a[4:5], v17 offset:49152
    v_mfma_f32_16x16x32_bf16 v[172:175], a[12:15], a[40:43], v[172:175]
    ds_read_b64_tr_b16 a[6:7], v17 offset:53248
    s_waitcnt vmcnt(4)
    s_barrier
    ds_read_b128 a[24:27], v35 offset:0
    ds_read_b128 a[28:31], v35 offset:1024
    s_waitcnt lgkmcnt(6)
    v_mfma_f32_16x16x32_bf16 v[144:147], a[16:19], a[36:39], v[144:147]
    ds_read_b64_tr_b16 a[8:9], v21 offset:0
    v_mfma_f32_16x16x32_bf16 v[176:179], a[16:19], a[40:43], v[176:179]
    ds_read_b64_tr_b16 a[10:11], v21 offset:4096
    v_mfma_f32_16x16x32_bf16 v[148:151], a[20:23], a[36:39], v[148:151]
    ds_read_b64_tr_b16 a[12:13], v22 offset:0
    v_mfma_f32_16x16x32_bf16 v[180:183], a[20:23], a[40:43], v[180:183]
    ds_read_b64_tr_b16 a[14:15], v22 offset:4096
    s_waitcnt lgkmcnt(6)
    v_mfma_f32_16x16x32_bf16 v[152:155], a[0:3], a[36:39], v[152:155]
    ds_read_b64_tr_b16 a[16:17], v23 offset:0
    v_mfma_f32_16x16x32_bf16 v[184:187], a[0:3], a[40:43], v[184:187]
    ds_read_b64_tr_b16 a[18:19], v23 offset:4096
    v_mfma_f32_16x16x32_bf16 v[156:159], a[4:7], a[36:39], v[156:159]
    ds_read_b64_tr_b16 a[20:21], v24 offset:0
    v_mfma_f32_16x16x32_bf16 v[188:191], a[4:7], a[40:43], v[188:191]
    ds_read_b64_tr_b16 a[22:23], v24 offset:4096
    s_add_u32 m0, s28, 0x8000
    s_nop 0
    buffer_load_dwordx4 v8, s[8:11], s23 offen lds
    s_waitcnt lgkmcnt(4)
    v_mfma_f32_16x16x32_bf16 v[128:131], a[8:11], a[24:27], v[128:131]
    ds_read_b64_tr_b16 a[0:1], v25 offset:0
    v_mfma_f32_16x16x32_bf16 v[160:163], a[8:11], a[28:31], v[160:163]
    ds_read_b64_tr_b16 a[2:3], v25 offset:4096
    v_mfma_f32_16x16x32_bf16 v[132:135], a[12:15], a[24:27], v[132:135]
    ds_read_b64_tr_b16 a[4:5], v26 offset:0
    v_mfma_f32_16x16x32_bf16 v[164:167], a[12:15], a[28:31], v[164:167]
    ds_read_b64_tr_b16 a[6:7], v26 offset:4096
    s_add_u32 m0, s28, 0x8400
    s_nop 0
    buffer_load_dwordx4 v9, s[8:11], s23 offen lds
    s_add_u32 s23, s23, 110592
    s_waitcnt lgkmcnt(4)
    v_mfma_f32_16x16x32_bf16 v[136:139], a[16:19], a[24:27], v[136:139]
    ds_read_b64_tr_b16 a[8:9], v27 offset:0
    v_mfma_f32_16x16x32_bf16 v[168:171], a[16:19], a[28:31], v[168:171]
    ds_read_b64_tr_b16 a[10:11], v27 offset:4096
    v_mfma_f32_16x16x32_bf16 v[140:143], a[20:23], a[24:27], v[140:143]
    ds_read_b64_tr_b16 a[12:13], v28 offset:0
    v_mfma_f32_16x16x32_bf16 v[172:175], a[20:23], a[28:31], v[172:175]
    ds_read_b64_tr_b16 a[14:15], v28 offset:4096
    s_waitcnt vmcnt(4)
    s_barrier
    ds_write_b128 v4, v[44:47] offset:0
    ds_write_b128 v5, v[64:67] offset:0
    ds_write_b128 v6, v[84:87] offset:0
    ds_write_b128 v7, v[104:107] offset:0
    ds_read_b128 a[36:39], v35 offset:8256
    ds_read_b128 a[40:43], v35 offset:9280
    s_waitcnt lgkmcnt(10)
    v_mfma_f32_16x16x32_bf16 v[144:147], a[0:3], a[24:27], v[144:147]
    ds_read_b64_tr_b16 a[16:17], v10 offset:0
    v_mfma_f32_16x16x32_bf16 v[176:179], a[0:3], a[28:31], v[176:179]
    ds_read_b64_tr_b16 a[18:19], v10 offset:4096
    v_mfma_f32_16x16x32_bf16 v[148:151], a[4:7], a[24:27], v[148:151]
    ds_read_b64_tr_b16 a[20:21], v11 offset:0
    v_mfma_f32_16x16x32_bf16 v[180:183], a[4:7], a[28:31], v[180:183]
    ds_read_b64_tr_b16 a[22:23], v11 offset:4096
    s_waitcnt lgkmcnt(10)
    v_mfma_f32_16x16x32_bf16 v[152:155], a[8:11], a[24:27], v[152:155]
    ds_read_b64_tr_b16 a[0:1], v12 offset:0
    v_mfma_f32_16x16x32_bf16 v[184:187], a[8:11], a[28:31], v[184:187]
    ds_read_b64_tr_b16 a[2:3], v12 offset:4096
    v_mfma_f32_16x16x32_bf16 v[156:159], a[12:15], a[24:27], v[156:159]
    ds_read_b64_tr_b16 a[4:5], v13 offset:0
    v_mfma_f32_16x16x32_bf16 v[188:191], a[12:15], a[28:31], v[188:191]
    ds_read_b64_tr_b16 a[6:7], v13 offset:4096
    s_add_u32 m0, s28, 0xc000
    s_nop 0
    buffer_load_dwordx4 v8, s[8:11], s23 offen lds
    s_waitcnt lgkmcnt(4)
    v_mfma_f32_16x16x32_bf16 v[128:131], a[16:19], a[36:39], v[128:131]
    ds_read_b64_tr_b16 a[8:9], v14 offset:0
    v_mfma_f32_16x16x32_bf16 v[160:163], a[16:19], a[40:43], v[160:163]
    ds_read_b64_tr_b16 a[10:11], v14 offset:4096
    v_mfma_f32_16x16x32_bf16 v[132:135], a[20:23], a[36:39], v[132:135]
    ds_read_b64_tr_b16 a[12:13], v15 offset:0
    v_mfma_f32_16x16x32_bf16 v[164:167], a[20:23], a[40:43], v[164:167]
    ds_read_b64_tr_b16 a[14:15], v15 offset:4096
    s_add_u32 m0, s28, 0xc400
    s_nop 0
    buffer_load_dwordx4 v9, s[8:11], s23 offen lds
    s_add_u32 s23, s23, 110592
    s_waitcnt lgkmcnt(4)
    v_mfma_f32_16x16x32_bf16 v[136:139], a[0:3], a[36:39], v[136:139]
    ds_read_b64_tr_b16 a[16:17], v16 offset:0
    v_mfma_f32_16x16x32_bf16 v[168:171], a[0:3], a[40:43], v[168:171]
    ds_read_b64_tr_b16 a[18:19], v16 offset:4096
    v_mfma_f32_16x16x32_bf16 v[140:143], a[4:7], a[36:39], v[140:143]
    ds_read_b64_tr_b16 a[20:21], v17 offset:0
    v_mfma_f32_16x16x32_bf16 v[172:175], a[4:7], a[40:43], v[172:175]
    ds_read_b64_tr_b16 a[22:23], v17 offset:4096
    s_waitcnt vmcnt(4)
    s_barrier
    ds_read_b128 a[24:27], v35 offset:16512
    ds_read_b128 a[28:31], v35 offset:17536
    s_waitcnt lgkmcnt(6)
    v_mfma_f32_16x16x32_bf16 v[144:147], a[8:11], a[36:39], v[144:147]
    ds_read_b64_tr_b16 a[0:1], v10 offset:16384
    v_mfma_f32_16x16x32_bf16 v[176:179], a[8:11], a[40:43], v[176:179]
    ds_read_b64_tr_b16 a[2:3], v10 offset:20480
    v_mfma_f32_16x16x32_bf16 v[148:151], a[12:15], a[36:39], v[148:151]
    ds_read_b64_tr_b16 a[4:5], v11 offset:16384
    v_mfma_f32_16x16x32_bf16 v[180:183], a[12:15], a[40:43], v[180:183]
    ds_read_b64_tr_b16 a[6:7], v11 offset:20480
    s_waitcnt lgkmcnt(6)
    v_mfma_f32_16x16x32_bf16 v[152:155], a[16:19], a[36:39], v[152:155]
    ds_read_b64_tr_b16 a[8:9], v12 offset:16384
    v_mfma_f32_16x16x32_bf16 v[184:187], a[16:19], a[40:43], v[184:187]
    ds_read_b64_tr_b16 a[10:11], v12 offset:20480
    v_mfma_f32_16x16x32_bf16 v[156:159], a[20:23], a[36:39], v[156:159]
    ds_read_b64_tr_b16 a[12:13], v13 offset:16384
    v_mfma_f32_16x16x32_bf16 v[188:191], a[20:23], a[40:43], v[188:191]
    ds_read_b64_tr_b16 a[14:15], v13 offset:20480
    s_add_u32 m0, s28, 0x10000
    s_nop 0
    buffer_load_dwordx4 v8, s[8:11], s23 offen lds
    s_waitcnt lgkmcnt(4)
    v_mfma_f32_16x16x32_bf16 v[128:131], a[0:3], a[24:27], v[128:131]
    ds_read_b64_tr_b16 a[16:17], v14 offset:16384
    v_mfma_f32_16x16x32_bf16 v[160:163], a[0:3], a[28:31], v[160:163]
    ds_read_b64_tr_b16 a[18:19], v14 offset:20480
    v_mfma_f32_16x16x32_bf16 v[132:135], a[4:7], a[24:27], v[132:135]
    ds_read_b64_tr_b16 a[20:21], v15 offset:16384
    v_mfma_f32_16x16x32_bf16 v[164:167], a[4:7], a[28:31], v[164:167]
    ds_read_b64_tr_b16 a[22:23], v15 offset:20480
    s_add_u32 m0, s28, 0x10400
    s_nop 0
    buffer_load_dwordx4 v9, s[8:11], s23 offen lds
    s_add_u32 s23, s23, 110592
    s_waitcnt lgkmcnt(4)
    v_mfma_f32_16x16x32_bf16 v[136:139], a[8:11], a[24:27], v[136:139]
    ds_read_b64_tr_b16 a[0:1], v16 offset:16384
    v_mfma_f32_16x16x32_bf16 v[168:171], a[8:11], a[28:31], v[168:171]
    ds_read_b64_tr_b16 a[2:3], v16 offset:20480
    v_mfma_f32_16x16x32_bf16 v[140:143], a[12:15], a[24:27], v[140:143]
    ds_read_b64_tr_b16 a[4:5], v17 offset:16384
    v_mfma_f32_16x16x32_bf16 v[172:175], a[12:15], a[28:31], v[172:175]
    ds_read_b64_tr_b16 a[6:7], v17 offset:20480
    s_waitcnt vmcnt(4)
    s_barrier
    ds_read_b128 a[36:39], v35 offset:24768
    ds_read_b128 a[40:43], v35 offset:25792
    s_waitcnt lgkmcnt(6)
    v_mfma_f32_16x16x32_bf16 v[144:147], a[16:19], a[24:27], v[144:147]
    ds_read_b64_tr_b16 a[8:9], v10 offset:32768
    v_mfma_f32_16x16x32_bf16 v[176:179], a[16:19], a[28:31], v[176:179]
    ds_read_b64_tr_b16 a[10:11], v10 offset:36864
    v_mfma_f32_16x16x32_bf16 v[148:151], a[20:23], a[24:27], v[148:151]
    ds_read_b64_tr_b16 a[12:13], v11 offset:32768
    v_mfma_f32_16x16x32_bf16 v[180:183], a[20:23], a[28:31], v[180:183]
    ds_read_b64_tr_b16 a[14:15], v11 offset:36864
    s_waitcnt lgkmcnt(6)
    v_mfma_f32_16x16x32_bf16 v[152:155], a[0:3], a[24:27], v[152:155]
    ds_read_b64_tr_b16 a[16:17], v12 offset:32768
    v_mfma_f32_16x16x32_bf16 v[184:187], a[0:3], a[28:31], v[184:187]
    ds_read_b64_tr_b16 a[18:19], v12 offset:36864
    v_mfma_f32_16x16x32_bf16 v[156:159], a[4:7], a[24:27], v[156:159]
    ds_read_b64_tr_b16 a[20:21], v13 offset:32768
    v_mfma_f32_16x16x32_bf16 v[188:191], a[4:7], a[28:31], v[188:191]
    ds_read_b64_tr_b16 a[22:23], v13 offset:36864
    s_add_u32 m0, s28, 0x0
    s_nop 0
    buffer_load_dwordx4 v8, s[8:11], s23 offen lds
    s_waitcnt lgkmcnt(4)
    v_mfma_f32_16x16x32_bf16 v[128:131], a[8:11], a[36:39], v[128:131]
    ds_read_b64_tr_b16 a[0:1], v14 offset:32768
    v_mfma_f32_16x16x32_bf16 v[160:163], a[8:11], a[40:43], v[160:163]
    ds_read_b64_tr_b16 a[2:3], v14 offset:36864
    v_mfma_f32_16x16x32_bf16 v[132:135], a[12:15], a[36:39], v[132:135]
    ds_read_b64_tr_b16 a[4:5], v15 offset:32768
    v_mfma_f32_16x16x32_bf16 v[164:167], a[12:15], a[40:43], v[164:167]
    ds_read_b64_tr_b16 a[6:7], v15 offset:36864
    s_add_u32 m0, s28, 0x400
    s_nop 0
    buffer_load_dwordx4 v9, s[8:11], s23 offen lds
    s_add_u32 s23, s23, 110592
    s_waitcnt lgkmcnt(4)
    v_mfma_f32_16x16x32_bf16 v[136:139], a[16:19], a[36:39], v[136:139]
    ds_read_b64_tr_b16 a[8:9], v16 offset:32768
    v_mfma_f32_16x16x32_bf16 v[168:171], a[16:19], a[40:43], v[168:171]
    ds_read_b64_tr_b16 a[10:11], v16 offset:36864
    v_mfma_f32_16x16x32_bf16 v[140:143], a[20:23], a[36:39], v[140:143]
    ds_read_b64_tr_b16 a[12:13], v17 offset:32768
    v_mfma_f32_16x16x32_bf16 v[172:175], a[20:23], a[40:43], v[172:175]
    ds_read_b64_tr_b16 a[14:15], v17 offset:36864
    s_waitcnt vmcnt(4)
    s_barrier
    ds_read_b128 a[24:27], v32 offset:0
    ds_read_b128 a[28:31], v32 offset:1024
    s_waitcnt lgkmcnt(6)
    v_mfma_f32_16x16x32_bf16 v[144:147], a[0:3], a[36:39], v[144:147]
    ds_read_b64_tr_b16 a[16:17], v10 offset:49152
    v_mfma_f32_16x16x32_bf16 v[176:179], a[0:3], a[40:43], v[176:179]
    ds_read_b64_tr_b16 a[18:19], v10 offset:53248
    v_mfma_f32_16x16x32_bf16 v[148:151], a[4:7], a[36:39], v[148:151]
    ds_read_b64_tr_b16 a[20:21], v11 offset:49152
    v_mfma_f32_16x16x32_bf16 v[180:183], a[4:7], a[40:43], v[180:183]
    ds_read_b64_tr_b16 a[22:23], v11 offset:53248
    s_waitcnt lgkmcnt(6)
    v_mfma_f32_16x16x32_bf16 v[152:155], a[8:11], a[36:39], v[152:155]
    ds_read_b64_tr_b16 a[0:1], v12 offset:49152
    v_mfma_f32_16x16x32_bf16 v[184:187], a[8:11], a[40:43], v[184:187]
    ds_read_b64_tr_b16 a[2:3], v12 offset:53248
    v_mfma_f32_16x16x32_bf16 v[156:159], a[12:15], a[36:39], v[156:159]
    ds_read_b64_tr_b16 a[4:5], v13 offset:49152
    v_mfma_f32_16x16x32_bf16 v[188:191], a[12:15], a[40:43], v[188:191]
    ds_read_b64_tr_b16 a[6:7], v13 offset:53248
    s_add_u32 m0, s28, 0x4000
    s_nop 0
    buffer_load_dwordx4 v8, s[8:11], s23 offen lds
    s_waitcnt lgkmcnt(4)
    v_mfma_f32_16x16x32_bf16 v[128:131], a[16:19], a[24:27], v[128:131]
    ds_read_b64_tr_b16 a[8:9], v14 offset:49152
    v_mfma_f32_16x16x32_bf16 v[160:163], a[16:19], a[28:31], v[160:163]
    ds_read_b64_tr_b16 a[10:11], v14 offset:53248
    v_mfma_f32_16x16x32_bf16 v[132:135], a[20:23], a[24:27], v[132:135]
    ds_read_b64_tr_b16 a[12:13], v15 offset:49152
    v_mfma_f32_16x16x32_bf16 v[164:167], a[20:23], a[28:31], v[164:167]
    ds_read_b64_tr_b16 a[14:15], v15 offset:53248
    s_add_u32 m0, s28, 0x4400
    s_nop 0
    buffer_load_dwordx4 v9, s[8:11], s23 offen lds
    s_add_u32 s23, s23, 110592
    s_waitcnt lgkmcnt(4)
    v_mfma_f32_16x16x32_bf16 v[136:139], a[0:3], a[24:27], v[136:139]
    ds_read_b64_tr_b16 a[16:17], v16 offset:49152
    v_mfma_f32_16x16x32_bf16 v[168:171], a[0:3], a[28:31], v[168:171]
    ds_read_b64_tr_b16 a[18:19], v16 offset:53248
    v_mfma_f32_16x16x32_bf16 v[140:143], a[4:7], a[24:27], v[140:143]
    ds_read_b64_tr_b16 a[20:21], v17 offset:49152
    v_mfma_f32_16x16x32_bf16 v[172:175], a[4:7], a[28:31], v[172:175]
    ds_read_b64_tr_b16 a[22:23], v17 offset:53248
    s_waitcnt vmcnt(4)
    s_barrier
    ds_write_b128 v4, v[48:51] offset:33024
    ds_write_b128 v5, v[68:71] offset:33024
    ds_write_b128 v6, v[88:91] offset:33024
    ds_write_b128 v7, v[108:111] offset:33024
    ds_read_b128 a[36:39], v32 offset:8256
    ds_read_b128 a[40:43], v32 offset:9280
    s_waitcnt lgkmcnt(10)
    v_mfma_f32_16x16x32_bf16 v[144:147], a[8:11], a[24:27], v[144:147]
    ds_read_b64_tr_b16 a[0:1], v21 offset:0
    v_mfma_f32_16x16x32_bf16 v[176:179], a[8:11], a[28:31], v[176:179]
    ds_read_b64_tr_b16 a[2:3], v21 offset:4096
    v_mfma_f32_16x16x32_bf16 v[148:151], a[12:15], a[24:27], v[148:151]
    ds_read_b64_tr_b16 a[4:5], v22 offset:0
    v_mfma_f32_16x16x32_bf16 v[180:183], a[12:15], a[28:31], v[180:183]
    ds_read_b64_tr_b16 a[6:7], v22 offset:4096
    s_waitcnt lgkmcnt(10)
    v_mfma_f32_16x16x32_bf16 v[152:155], a[16:19], a[24:27], v[152:155]
    ds_read_b64_tr_b16 a[8:9], v23 offset:0
    v_mfma_f32_16x16x32_bf16 v[184:187], a[16:19], a[28:31], v[184:187]
    ds_read_b64_tr_b16 a[10:11], v23 offset:4096
    v_mfma_f32_16x16x32_bf16 v[156:159], a[20:23], a[24:27], v[156:159]
    ds_read_b64_tr_b16 a[12:13], v24 offset:0
    v_mfma_f32_16x16x32_bf16 v[188:191], a[20:23], a[28:31], v[188:191]
    ds_read_b64_tr_b16 a[14:15], v24 offset:4096
    s_add_u32 m0, s28, 0x8000
    s_nop 0
    buffer_load_dwordx4 v8, s[8:11], s23 offen lds
    s_waitcnt lgkmcnt(4)
    v_mfma_f32_16x16x32_bf16 v[128:131], a[0:3], a[36:39], v[128:131]
    ds_read_b64_tr_b16 a[16:17], v25 offset:0
    v_mfma_f32_16x16x32_bf16 v[160:163], a[0:3], a[40:43], v[160:163]
    ds_read_b64_tr_b16 a[18:19], v25 offset:4096
    v_mfma_f32_16x16x32_bf16 v[132:135], a[4:7], a[36:39], v[132:135]
    ds_read_b64_tr_b16 a[20:21], v26 offset:0
    v_mfma_f32_16x16x32_bf16 v[164:167], a[4:7], a[40:43], v[164:167]
    ds_read_b64_tr_b16 a[22:23], v26 offset:4096
    s_add_u32 m0, s28, 0x8400
    s_nop 0
    buffer_load_dwordx4 v9, s[8:11], s23 offen lds
    s_add_u32 s23, s23, 110592
    s_waitcnt lgkmcnt(4)
    v_mfma_f32_16x16x32_bf16 v[136:139], a[8:11], a[36:39], v[136:139]
    ds_read_b64_tr_b16 a[0:1], v27 offset:0
    v_mfma_f32_16x16x32_bf16 v[168:171], a[8:11], a[40:43], v[168:171]
    ds_read_b64_tr_b16 a[2:3], v27 offset:4096
    v_mfma_f32_16x16x32_bf16 v[140:143], a[12:15], a[36:39], v[140:143]
    ds_read_b64_tr_b16 a[4:5], v28 offset:0
    v_mfma_f32_16x16x32_bf16 v[172:175], a[12:15], a[40:43], v[172:175]
    ds_read_b64_tr_b16 a[6:7], v28 offset:4096
    s_waitcnt vmcnt(4)
    s_barrier
    ds_read_b128 a[24:27], v32 offset:16512
    ds_read_b128 a[28:31], v32 offset:17536
    s_waitcnt lgkmcnt(6)
    v_mfma_f32_16x16x32_bf16 v[144:147], a[16:19], a[36:39], v[144:147]
    ds_read_b64_tr_b16 a[8:9], v10 offset:0
    v_mfma_f32_16x16x32_bf16 v[176:179], a[16:19], a[40:43], v[176:179]
    ds_read_b64_tr_b16 a[10:11], v10 offset:4096
    v_mfma_f32_16x16x32_bf16 v[148:151], a[20:23], a[36:39], v[148:151]
    ds_read_b64_tr_b16 a[12:13], v11 offset:0
    v_mfma_f32_16x16x32_bf16 v[180:183], a[20:23], a[40:43], v[180:183]
    ds_read_b64_tr_b16 a[14:15], v11 offset:4096
    s_waitcnt lgkmcnt(6)
    v_mfma_f32_16x16x32_bf16 v[152:155], a[0:3], a[36:39], v[152:155]
    ds_read_b64_tr_b16 a[16:17], v12 offset:0
    v_mfma_f32_16x16x32_bf16 v[184:187], a[0:3], a[40:43], v[184:187]
    ds_read_b64_tr_b16 a[18:19], v12 offset:4096
    v_mfma_f32_16x16x32_bf16 v[156:159], a[4:7], a[36:39], v[156:159]
    ds_read_b64_tr_b16 a[20:21], v13 offset:0
    v_mfma_f32_16x16x32_bf16 v[188:191], a[4:7], a[40:43], v[188:191]
    ds_read_b64_tr_b16 a[22:23], v13 offset:4096
    s_add_u32 m0, s28, 0xc000
    s_nop 0
    buffer_load_dwordx4 v8, s[8:11], s23 offen lds
    s_waitcnt lgkmcnt(4)
    v_mfma_f32_16x16x32_bf16 v[128:131], a[8:11], a[24:27], v[128:131]
    ds_read_b64_tr_b16 a[0:1], v14 offset:0
    v_mfma_f32_16x16x32_bf16 v[160:163], a[8:11], a[28:31], v[160:163]
    ds_read_b64_tr_b16 a[2:3], v14 offset:4096
    v_mfma_f32_16x16x32_bf16 v[132:135], a[12:15], a[24:27], v[132:135]
    ds_read_b64_tr_b16 a[4:5], v15 offset:0
    v_mfma_f32_16x16x32_bf16 v[164:167], a[12:15], a[28:31], v[164:167]
    ds_read_b64_tr_b16 a[6:7], v15 offset:4096
    s_add_u32 m0, s28, 0xc400
    s_nop 0
    buffer_load_dwordx4 v9, s[8:11], s23 offen lds
    s_add_u32 s23, s23, 110592
    s_waitcnt lgkmcnt(4)
    v_mfma_f32_16x16x32_bf16 v[136:139], a[16:19], a[24:27], v[136:139]
    ds_read_b64_tr_b16 a[8:9], v16 offset:0
    v_mfma_f32_16x16x32_bf16 v[168:171], a[16:19], a[28:31], v[168:171]
    ds_read_b64_tr_b16 a[10:11], v16 offset:4096
    v_mfma_f32_16x16x32_bf16 v[140:143], a[20:23], a[24:27], v[140:143]
    ds_read_b64_tr_b16 a[12:13], v17 offset:0
    v_mfma_f32_16x16x32_bf16 v[172:175], a[20:23], a[28:31], v[172:175]
    ds_read_b64_tr_b16 a[14:15], v17 offset:4096
    s_waitcnt vmcnt(4)
    s_barrier
    ds_read_b128 a[36:39], v32 offset:24768
    ds_read_b128 a[40:43], v32 offset:25792
    s_waitcnt lgkmcnt(6)
    v_mfma_f32_16x16x32_bf16 v[144:147], a[0:3], a[24:27], v[144:147]
    ds_read_b64_tr_b16 a[16:17], v10 offset:16384
    v_mfma_f32_16x16x32_bf16 v[176:179], a[0:3], a[28:31], v[176:179]
    ds_read_b64_tr_b16 a[18:19], v10 offset:20480
    v_mfma_f32_16x16x32_bf16 v[148:151], a[4:7], a[24:27], v[148:151]
    ds_read_b64_tr_b16 a[20:21], v11 offset:16384
    v_mfma_f32_16x16x32_bf16 v[180:183], a[4:7], a[28:31], v[180:183]
    ds_read_b64_tr_b16 a[22:23], v11 offset:20480
    s_waitcnt lgkmcnt(6)
    v_mfma_f32_16x16x32_bf16 v[152:155], a[8:11], a[24:27], v[152:155]
    ds_read_b64_tr_b16 a[0:1], v12 offset:16384
    v_mfma_f32_16x16x32_bf16 v[184:187], a[8:11], a[28:31], v[184:187]
    ds_read_b64_tr_b16 a[2:3], v12 offset:20480
    v_mfma_f32_16x16x32_bf16 v[156:159], a[12:15], a[24:27], v[156:159]
    ds_read_b64_tr_b16 a[4:5], v13 offset:16384
    v_mfma_f32_16x16x32_bf16 v[188:191], a[12:15], a[28:31], v[188:191]
    ds_read_b64_tr_b16 a[6:7], v13 offset:20480
    s_add_u32 m0, s28, 0x10000
    s_nop 0
    buffer_load_dwordx4 v8, s[8:11], s23 offen lds
    s_waitcnt lgkmcnt(4)
    v_mfma_f32_16x16x32_bf16 v[128:131], a[16:19], a[36:39], v[128:131]
    ds_read_b64_tr_b16 a[8:9], v14 offset:16384
    v_mfma_f32_16x16x32_bf16 v[160:163], a[16:19], a[40:43], v[160:163]
    ds_read_b64_tr_b16 a[10:11], v14 offset:20480
    v_mfma_f32_16x16x32_bf16 v[132:135], a[20:23], a[36:39], v[132:135]
    ds_read_b64_tr_b16 a[12:13], v15 offset:16384
    v_mfma_f32_16x16x32_bf16 v[164:167], a[20:23], a[40:43], v[164:167]
    ds_read_b64_tr_b16 a[14:15], v15 offset:20480
    s_add_u32 m0, s28, 0x10400
    s_nop 0
    buffer_load_dwordx4 v9, s[8:11], s23 offen lds
    s_add_u32 s23, s23, 110592
    s_waitcnt lgkmcnt(4)
    v_mfma_f32_16x16x32_bf16 v[136:139], a[0:3], a[36:39], v[136:139]
    ds_read_b64_tr_b16 a[16:17], v16 offset:16384
    v_mfma_f32_16x16x32_bf16 v[168:171], a[0:3], a[40:43], v[168:171]
    ds_read_b64_tr_b16 a[18:19], v16 offset:20480
    v_mfma_f32_16x16x32_bf16 v[140:143], a[4:7], a[36:39], v[140:143]
    ds_read_b64_tr_b16 a[20:21], v17 offset:16384
    v_mfma_f32_16x16x32_bf16 v[172:175], a[4:7], a[40:43], v[172:175]
    ds_read_b64_tr_b16 a[22:23], v17 offset:20480
    s_waitcnt vmcnt(4)
    s_barrier
    ds_read_b128 a[24:27], v35 offset:0
    ds_read_b128 a[28:31], v35 offset:1024
    s_waitcnt lgkmcnt(6)
    v_mfma_f32_16x16x32_bf16 v[144:147], a[8:11], a[36:39], v[144:147]
    ds_read_b64_tr_b16 a[0:1], v10 offset:32768
    v_mfma_f32_16x16x32_bf16 v[176:179], a[8:11], a[40:43], v[176:179]
    ds_read_b64_tr_b16 a[2:3], v10 offset:36864
    v_mfma_f32_16x16x32_bf16 v[148:151], a[12:15], a[36:39], v[148:151]
    ds_read_b64_tr_b16 a[4:5], v11 offset:32768
    v_mfma_f32_16x16x32_bf16 v[180:183], a[12:15], a[40:43], v[180:183]
    ds_read_b64_tr_b16 a[6:7], v11 offset:36864
    s_waitcnt lgkmcnt(6)
    v_mfma_f32_16x16x32_bf16 v[152:155], a[16:19], a[36:39], v[152:155]
    ds_read_b64_tr_b16 a[8:9], v12 offset:32768
    v_mfma_f32_16x16x32_bf16 v[184:187], a[16:19], a[40:43], v[184:187]
    ds_read_b64_tr_b16 a[10:11], v12 offset:36864
    v_mfma_f32_16x16x32_bf16 v[156:159], a[20:23], a[36:39], v[156:159]
    ds_read_b64_tr_b16 a[12:13], v13 offset:32768
    v_mfma_f32_16x16x32_bf16 v[188:191], a[20:23], a[40:43], v[188:191]
    ds_read_b64_tr_b16 a[14:15], v13 offset:36864
    s_add_u32 m0, s28, 0x0
    s_nop 0
    buffer_load_dwordx4 v8, s[8:11], s23 offen lds
    s_waitcnt lgkmcnt(4)
    v_mfma_f32_16x16x32_bf16 v[128:131], a[0:3], a[24:27], v[128:131]
    ds_read_b64_tr_b16 a[16:17], v14 offset:32768
    v_mfma_f32_16x16x32_bf16 v[160:163], a[0:3], a[28:31], v[160:163]
    ds_read_b64_tr_b16 a[18:19], v14 offset:36864
    v_mfma_f32_16x16x32_bf16 v[132:135], a[4:7], a[24:27], v[132:135]
    ds_read_b64_tr_b16 a[20:21], v15 offset:32768
    v_mfma_f32_16x16x32_bf16 v[164:167], a[4:7], a[28:31], v[164:167]
    ds_read_b64_tr_b16 a[22:23], v15 offset:36864
    s_add_u32 m0, s28, 0x400
    s_nop 0
    buffer_load_dwordx4 v9, s[8:11], s23 offen lds
    s_add_u32 s23, s23, 110592
    s_waitcnt lgkmcnt(4)
    v_mfma_f32_16x16x32_bf16 v[136:139], a[8:11], a[24:27], v[136:139]
    ds_read_b64_tr_b16 a[0:1], v16 offset:32768
    v_mfma_f32_16x16x32_bf16 v[168:171], a[8:11], a[28:31], v[168:171]
    ds_read_b64_tr_b16 a[2:3], v16 offset:36864
    v_mfma_f32_16x16x32_bf16 v[140:143], a[12:15], a[24:27], v[140:143]
    ds_read_b64_tr_b16 a[4:5], v17 offset:32768
    v_mfma_f32_16x16x32_bf16 v[172:175], a[12:15], a[28:31], v[172:175]
    ds_read_b64_tr_b16 a[6:7], v17 offset:36864
    s_waitcnt vmcnt(4)
    s_barrier
    ds_write_b128 v4, v[52:55] offset:0
    ds_write_b128 v5, v[72:75] offset:0
    ds_write_b128 v6, v[92:95] offset:0
    ds_write_b128 v7, v[112:115] offset:0
    ds_read_b128 a[36:39], v35 offset:8256
    ds_read_b128 a[40:43], v35 offset:9280
    s_waitcnt lgkmcnt(10)
    v_mfma_f32_16x16x32_bf16 v[144:147], a[16:19], a[24:27], v[144:147]
    ds_read_b64_tr_b16 a[8:9], v10 offset:49152
    v_mfma_f32_16x16x32_bf16 v[176:179], a[16:19], a[28:31], v[176:179]
    ds_read_b64_tr_b16 a[10:11], v10 offset:53248
    v_mfma_f32_16x16x32_bf16 v[148:151], a[20:23], a[24:27], v[148:151]
    ds_read_b64_tr_b16 a[12:13], v11 offset:49152
    v_mfma_f32_16x16x32_bf16 v[180:183], a[20:23], a[28:31], v[180:183]
    ds_read_b64_tr_b16 a[14:15], v11 offset:53248
    s_waitcnt lgkmcnt(10)
    v_mfma_f32_16x16x32_bf16 v[152:155], a[0:3], a[24:27], v[152:155]
    ds_read_b64_tr_b16 a[16:17], v12 offset:49152
    v_mfma_f32_16x16x32_bf16 v[184:187], a[0:3], a[28:31], v[184:187]
    ds_read_b64_tr_b16 a[18:19], v12 offset:53248
    v_mfma_f32_16x16x32_bf16 v[156:159], a[4:7], a[24:27], v[156:159]
    ds_read_b64_tr_b16 a[20:21], v13 offset:49152
    v_mfma_f32_16x16x32_bf16 v[188:191], a[4:7], a[28:31], v[188:191]
    ds_read_b64_tr_b16 a[22:23], v13 offset:53248
    s_add_u32 m0, s28, 0x4000
    s_nop 0
    buffer_load_dwordx4 v8, s[8:11], s23 offen lds
    s_waitcnt lgkmcnt(4)
    v_mfma_f32_16x16x32_bf16 v[128:131], a[8:11], a[36:39], v[128:131]
    ds_read_b64_tr_b16 a[0:1], v14 offset:49152
    v_mfma_f32_16x16x32_bf16 v[160:163], a[8:11], a[40:43], v[160:163]
    ds_read_b64_tr_b16 a[2:3], v14 offset:53248
    v_mfma_f32_16x16x32_bf16 v[132:135], a[12:15], a[36:39], v[132:135]
    ds_read_b64_tr_b16 a[4:5], v15 offset:49152
    v_mfma_f32_16x16x32_bf16 v[164:167], a[12:15], a[40:43], v[164:167]
    ds_read_b64_tr_b16 a[6:7], v15 offset:53248
    s_add_u32 m0, s28, 0x4400
    s_nop 0
    buffer_load_dwordx4 v9, s[8:11], s23 offen lds
    s_add_u32 s23, s23, 110592
    s_waitcnt lgkmcnt(4)
    v_mfma_f32_16x16x32_bf16 v[136:139], a[16:19], a[36:39], v[136:139]
    ds_read_b64_tr_b16 a[8:9], v16 offset:49152
    v_mfma_f32_16x16x32_bf16 v[168:171], a[16:19], a[40:43], v[168:171]
    ds_read_b64_tr_b16 a[10:11], v16 offset:53248
    v_mfma_f32_16x16x32_bf16 v[140:143], a[20:23], a[36:39], v[140:143]
    ds_read_b64_tr_b16 a[12:13], v17 offset:49152
    v_mfma_f32_16x16x32_bf16 v[172:175], a[20:23], a[40:43], v[172:175]
    ds_read_b64_tr_b16 a[14:15], v17 offset:53248
    s_waitcnt vmcnt(4)
    s_barrier
    ds_read_b128 a[24:27], v35 offset:16512
    ds_read_b128 a[28:31], v35 offset:17536
    s_waitcnt lgkmcnt(6)
    v_mfma_f32_16x16x32_bf16 v[144:147], a[0:3], a[36:39], v[144:147]
    ds_read_b64_tr_b16 a[16:17], v21 offset:0
    v_mfma_f32_16x16x32_bf16 v[176:179], a[0:3], a[40:43], v[176:179]
    ds_read_b64_tr_b16 a[18:19], v21 offset:4096
    v_mfma_f32_16x16x32_bf16 v[148:151], a[4:7], a[36:39], v[148:151]
    ds_read_b64_tr_b16 a[20:21], v22 offset:0
    v_mfma_f32_16x16x32_bf16 v[180:183], a[4:7], a[40:43], v[180:183]
    ds_read_b64_tr_b16 a[22:23], v22 offset:4096
    s_waitcnt lgkmcnt(6)
    v_mfma_f32_16x16x32_bf16 v[152:155], a[8:11], a[36:39], v[152:155]
    ds_read_b64_tr_b16 a[0:1], v23 offset:0
    v_mfma_f32_16x16x32_bf16 v[184:187], a[8:11], a[40:43], v[184:187]
    ds_read_b64_tr_b16 a[2:3], v23 offset:4096
    v_mfma_f32_16x16x32_bf16 v[156:159], a[12:15], a[36:39], v[156:159]
    ds_read_b64_tr_b16 a[4:5], v24 offset:0
    v_mfma_f32_16x16x32_bf16 v[188:191], a[12:15], a[40:43], v[188:191]
    ds_read_b64_tr_b16 a[6:7], v24 offset:4096
    s_add_u32 m0, s28, 0x8000
    s_nop 0
    buffer_load_dwordx4 v8, s[8:11], s23 offen lds
    s_waitcnt lgkmcnt(4)
    v_mfma_f32_16x16x32_bf16 v[128:131], a[16:19], a[24:27], v[128:131]
    ds_read_b64_tr_b16 a[8:9], v25 offset:0
    v_mfma_f32_16x16x32_bf16 v[160:163], a[16:19], a[28:31], v[160:163]
    ds_read_b64_tr_b16 a[10:11], v25 offset:4096
    v_mfma_f32_16x16x32_bf16 v[132:135], a[20:23], a[24:27], v[132:135]
    ds_read_b64_tr_b16 a[12:13], v26 offset:0
    v_mfma_f32_16x16x32_bf16 v[164:167], a[20:23], a[28:31], v[164:167]
    ds_read_b64_tr_b16 a[14:15], v26 offset:4096
    s_add_u32 m0, s28, 0x8400
    s_nop 0
    buffer_load_dwordx4 v9, s[8:11], s23 offen lds
    s_add_u32 s23, s23, 110592
    s_waitcnt lgkmcnt(4)
    v_mfma_f32_16x16x32_bf16 v[136:139], a[0:3], a[24:27], v[136:139]
    ds_read_b64_tr_b16 a[16:17], v27 offset:0
    v_mfma_f32_16x16x32_bf16 v[168:171], a[0:3], a[28:31], v[168:171]
    ds_read_b64_tr_b16 a[18:19], v27 offset:4096
    v_mfma_f32_16x16x32_bf16 v[140:143], a[4:7], a[24:27], v[140:143]
    ds_read_b64_tr_b16 a[20:21], v28 offset:0
    v_mfma_f32_16x16x32_bf16 v[172:175], a[4:7], a[28:31], v[172:175]
    ds_read_b64_tr_b16 a[22:23], v28 offset:4096
    s_waitcnt vmcnt(4)
    s_barrier
    ds_read_b128 a[36:39], v35 offset:24768
    ds_read_b128 a[40:43], v35 offset:25792
    s_waitcnt lgkmcnt(6)
    v_mfma_f32_16x16x32_bf16 v[144:147], a[8:11], a[24:27], v[144:147]
    ds_read_b64_tr_b16 a[0:1], v10 offset:0
    v_mfma_f32_16x16x32_bf16 v[176:179], a[8:11], a[28:31], v[176:179]
    ds_read_b64_tr_b16 a[2:3], v10 offset:4096
    v_mfma_f32_16x16x32_bf16 v[148:151], a[12:15], a[24:27], v[148:151]
    ds_read_b64_tr_b16 a[4:5], v11 offset:0
    v_mfma_f32_16x16x32_bf16 v[180:183], a[12:15], a[28:31], v[180:183]
    ds_read_b64_tr_b16 a[6:7], v11 offset:4096
    s_waitcnt lgkmcnt(6)
    v_mfma_f32_16x16x32_bf16 v[152:155], a[16:19], a[24:27], v[152:155]
    ds_read_b64_tr_b16 a[8:9], v12 offset:0
    v_mfma_f32_16x16x32_bf16 v[184:187], a[16:19], a[28:31], v[184:187]
    ds_read_b64_tr_b16 a[10:11], v12 offset:4096
    v_mfma_f32_16x16x32_bf16 v[156:159], a[20:23], a[24:27], v[156:159]
    ds_read_b64_tr_b16 a[12:13], v13 offset:0
    v_mfma_f32_16x16x32_bf16 v[188:191], a[20:23], a[28:31], v[188:191]
    ds_read_b64_tr_b16 a[14:15], v13 offset:4096
    s_add_u32 m0, s28, 0xc000
    s_nop 0
    buffer_load_dwordx4 v8, s[8:11], s23 offen lds
    s_waitcnt lgkmcnt(4)
    v_mfma_f32_16x16x32_bf16 v[128:131], a[0:3], a[36:39], v[128:131]
    ds_read_b64_tr_b16 a[16:17], v14 offset:0
    v_mfma_f32_16x16x32_bf16 v[160:163], a[0:3], a[40:43], v[160:163]
    ds_read_b64_tr_b16 a[18:19], v14 offset:4096
    v_mfma_f32_16x16x32_bf16 v[132:135], a[4:7], a[36:39], v[132:135]
    ds_read_b64_tr_b16 a[20:21], v15 offset:0
    v_mfma_f32_16x16x32_bf16 v[164:167], a[4:7], a[40:43], v[164:167]
    ds_read_b64_tr_b16 a[22:23], v15 offset:4096
    s_add_u32 m0, s28, 0xc400
    s_nop 0
    buffer_load_dwordx4 v9, s[8:11], s23 offen lds
    s_add_u32 s23, s23, 110592
    s_waitcnt lgkmcnt(4)
    v_mfma_f32_16x16x32_bf16 v[136:139], a[8:11], a[36:39], v[136:139]
    ds_read_b64_tr_b16 a[0:1], v16 offset:0
    v_mfma_f32_16x16x32_bf16 v[168:171], a[8:11], a[40:43], v[168:171]
    ds_read_b64_tr_b16 a[2:3], v16 offset:4096
    v_mfma_f32_16x16x32_bf16 v[140:143], a[12:15], a[36:39], v[140:143]
    ds_read_b64_tr_b16 a[4:5], v17 offset:0
    v_mfma_f32_16x16x32_bf16 v[172:175], a[12:15], a[40:43], v[172:175]
    ds_read_b64_tr_b16 a[6:7], v17 offset:4096
    s_waitcnt vmcnt(4)
    s_barrier
    ds_read_b128 a[24:27], v32 offset:0
    ds_read_b128 a[28:31], v32 offset:1024
    s_waitcnt lgkmcnt(6)
    v_mfma_f32_16x16x32_bf16 v[144:147], a[16:19], a[36:39], v[144:147]
    ds_read_b64_tr_b16 a[8:9], v10 offset:16384
    v_mfma_f32_16x16x32_bf16 v[176:179], a[16:19], a[40:43], v[176:179]
    ds_read_b64_tr_b16 a[10:11], v10 offset:20480
    v_mfma_f32_16x16x32_bf16 v[148:151], a[20:23], a[36:39], v[148:151]
    ds_read_b64_tr_b16 a[12:13], v11 offset:16384
    v_mfma_f32_16x16x32_bf16 v[180:183], a[20:23], a[40:43], v[180:183]
    ds_read_b64_tr_b16 a[14:15], v11 offset:20480
    s_waitcnt lgkmcnt(6)
    v_mfma_f32_16x16x32_bf16 v[152:155], a[0:3], a[36:39], v[152:155]
    ds_read_b64_tr_b16 a[16:17], v12 offset:16384
    v_mfma_f32_16x16x32_bf16 v[184:187], a[0:3], a[40:43], v[184:187]
    ds_read_b64_tr_b16 a[18:19], v12 offset:20480
    v_mfma_f32_16x16x32_bf16 v[156:159], a[4:7], a[36:39], v[156:159]
    ds_read_b64_tr_b16 a[20:21], v13 offset:16384
    v_mfma_f32_16x16x32_bf16 v[188:191], a[4:7], a[40:43], v[188:191]
    ds_read_b64_tr_b16 a[22:23], v13 offset:20480
    s_add_u32 m0, s28, 0x10000
    s_nop 0
    buffer_load_dwordx4 v8, s[8:11], s23 offen lds
    s_waitcnt lgkmcnt(4)
    v_mfma_f32_16x16x32_bf16 v[128:131], a[8:11], a[24:27], v[128:131]
    ds_read_b64_tr_b16 a[0:1], v14 offset:16384
    v_mfma_f32_16x16x32_bf16 v[160:163], a[8:11], a[28:31], v[160:163]
    ds_read_b64_tr_b16 a[2:3], v14 offset:20480
    v_mfma_f32_16x16x32_bf16 v[132:135], a[12:15], a[24:27], v[132:135]
    ds_read_b64_tr_b16 a[4:5], v15 offset:16384
    v_mfma_f32_16x16x32_bf16 v[164:167], a[12:15], a[28:31], v[164:167]
    ds_read_b64_tr_b16 a[6:7], v15 offset:20480
    s_add_u32 m0, s28, 0x10400
    s_nop 0
    buffer_load_dwordx4 v9, s[8:11], s23 offen lds
    s_add_u32 s23, s23, 110592
    s_waitcnt lgkmcnt(4)
    v_mfma_f32_16x16x32_bf16 v[136:139], a[16:19], a[24:27], v[136:139]
    ds_read_b64_tr_b16 a[8:9], v16 offset:16384
    v_mfma_f32_16x16x32_bf16 v[168:171], a[16:19], a[28:31], v[168:171]
    ds_read_b64_tr_b16 a[10:11], v16 offset:20480
    v_mfma_f32_16x16x32_bf16 v[140:143], a[20:23], a[24:27], v[140:143]
    ds_read_b64_tr_b16 a[12:13], v17 offset:16384
    v_mfma_f32_16x16x32_bf16 v[172:175], a[20:23], a[28:31], v[172:175]
    ds_read_b64_tr_b16 a[14:15], v17 offset:20480
    s_waitcnt vmcnt(4)
    s_barrier
    ds_read_b128 a[36:39], v32 offset:8256
    ds_read_b128 a[40:43], v32 offset:9280
    s_waitcnt lgkmcnt(6)
    v_mfma_f32_16x16x32_bf16 v[144:147], a[0:3], a[24:27], v[144:147]
    ds_read_b64_tr_b16 a[16:17], v10 offset:32768
    v_mfma_f32_16x16x32_bf16 v[176:179], a[0:3], a[28:31], v[176:179]
    ds_read_b64_tr_b16 a[18:19], v10 offset:36864
    v_mfma_f32_16x16x32_bf16 v[148:151], a[4:7], a[24:27], v[148:151]
    ds_read_b64_tr_b16 a[20:21], v11 offset:32768
    v_mfma_f32_16x16x32_bf16 v[180:183], a[4:7], a[28:31], v[180:183]
    ds_read_b64_tr_b16 a[22:23], v11 offset:36864
    s_waitcnt lgkmcnt(6)
    v_mfma_f32_16x16x32_bf16 v[152:155], a[8:11], a[24:27], v[152:155]
    ds_read_b64_tr_b16 a[0:1], v12 offset:32768
    v_mfma_f32_16x16x32_bf16 v[184:187], a[8:11], a[28:31], v[184:187]
    ds_read_b64_tr_b16 a[2:3], v12 offset:36864
    v_mfma_f32_16x16x32_bf16 v[156:159], a[12:15], a[24:27], v[156:159]
    ds_read_b64_tr_b16 a[4:5], v13 offset:32768
    v_mfma_f32_16x16x32_bf16 v[188:191], a[12:15], a[28:31], v[188:191]
    ds_read_b64_tr_b16 a[6:7], v13 offset:36864
    s_waitcnt lgkmcnt(4)
    v_mfma_f32_16x16x32_bf16 v[128:131], a[16:19], a[36:39], v[128:131]
    ds_read_b64_tr_b16 a[8:9], v14 offset:32768
    v_mfma_f32_16x16x32_bf16 v[160:163], a[16:19], a[40:43], v[160:163]
    ds_read_b64_tr_b16 a[10:11], v14 offset:36864
    v_mfma_f32_16x16x32_bf16 v[132:135], a[20:23], a[36:39], v[132:135]
    ds_read_b64_tr_b16 a[12:13], v15 offset:32768
    v_mfma_f32_16x16x32_bf16 v[164:167], a[20:23], a[40:43], v[164:167]
    ds_read_b64_tr_b16 a[14:15], v15 offset:36864
    s_waitcnt lgkmcnt(4)
    v_mfma_f32_16x16x32_bf16 v[136:139], a[0:3], a[36:39], v[136:139]
    ds_read_b64_tr_b16 a[16:17], v16 offset:32768
    v_mfma_f32_16x16x32_bf16 v[168:171], a[0:3], a[40:43], v[168:171]
    ds_read_b64_tr_b16 a[18:19], v16 offset:36864
    v_mfma_f32_16x16x32_bf16 v[140:143], a[4:7], a[36:39], v[140:143]
    ds_read_b64_tr_b16 a[20:21], v17 offset:32768
    v_mfma_f32_16x16x32_bf16 v[172:175], a[4:7], a[40:43], v[172:175]
    ds_read_b64_tr_b16 a[22:23], v17 offset:36864
    s_waitcnt vmcnt(2)
    s_barrier
    ds_read_b128 a[24:27], v32 offset:16512
    ds_read_b128 a[28:31], v32 offset:17536
    s_waitcnt lgkmcnt(6)
    v_mfma_f32_16x16x32_bf16 v[144:147], a[8:11], a[36:39], v[144:147]
    ds_read_b64_tr_b16 a[0:1], v10 offset:49152
    v_mfma_f32_16x16x32_bf16 v[176:179], a[8:11], a[40:43], v[176:179]
    ds_read_b64_tr_b16 a[2:3], v10 offset:53248
    v_mfma_f32_16x16x32_bf16 v[148:151], a[12:15], a[36:39], v[148:151]
    ds_read_b64_tr_b16 a[4:5], v11 offset:49152
    v_mfma_f32_16x16x32_bf16 v[180:183], a[12:15], a[40:43], v[180:183]
    ds_read_b64_tr_b16 a[6:7], v11 offset:53248
    s_waitcnt lgkmcnt(6)
    v_mfma_f32_16x16x32_bf16 v[152:155], a[16:19], a[36:39], v[152:155]
    ds_read_b64_tr_b16 a[8:9], v12 offset:49152
    v_mfma_f32_16x16x32_bf16 v[184:187], a[16:19], a[40:43], v[184:187]
    ds_read_b64_tr_b16 a[10:11], v12 offset:53248
    v_mfma_f32_16x16x32_bf16 v[156:159], a[20:23], a[36:39], v[156:159]
    ds_read_b64_tr_b16 a[12:13], v13 offset:49152
    v_mfma_f32_16x16x32_bf16 v[188:191], a[20:23], a[40:43], v[188:191]
    ds_read_b64_tr_b16 a[14:15], v13 offset:53248
    s_waitcnt lgkmcnt(4)
    v_mfma_f32_16x16x32_bf16 v[128:131], a[0:3], a[24:27], v[128:131]
    ds_read_b64_tr_b16 a[16:17], v14 offset:49152
    v_mfma_f32_16x16x32_bf16 v[160:163], a[0:3], a[28:31], v[160:163]
    ds_read_b64_tr_b16 a[18:19], v14 offset:53248
    v_mfma_f32_16x16x32_bf16 v[132:135], a[4:7], a[24:27], v[132:135]
    ds_read_b64_tr_b16 a[20:21], v15 offset:49152
    v_mfma_f32_16x16x32_bf16 v[164:167], a[4:7], a[28:31], v[164:167]
    ds_read_b64_tr_b16 a[22:23], v15 offset:53248
    s_waitcnt lgkmcnt(4)
    v_mfma_f32_16x16x32_bf16 v[136:139], a[8:11], a[24:27], v[136:139]
    ds_read_b64_tr_b16 a[0:1], v16 offset:49152
    v_mfma_f32_16x16x32_bf16 v[168:171], a[8:11], a[28:31], v[168:171]
    ds_read_b64_tr_b16 a[2:3], v16 offset:53248
    v_mfma_f32_16x16x32_bf16 v[140:143], a[12:15], a[24:27], v[140:143]
    ds_read_b64_tr_b16 a[4:5], v17 offset:49152
    v_mfma_f32_16x16x32_bf16 v[172:175], a[12:15], a[28:31], v[172:175]
    ds_read_b64_tr_b16 a[6:7], v17 offset:53248
    s_waitcnt vmcnt(0)
    s_barrier
    ds_read_b128 a[36:39], v32 offset:24768
    ds_read_b128 a[40:43], v32 offset:25792
    s_waitcnt lgkmcnt(6)
    v_mfma_f32_16x16x32_bf16 v[144:147], a[16:19], a[24:27], v[144:147]
    ds_read_b64_tr_b16 a[8:9], v21 offset:0
    v_mfma_f32_16x16x32_bf16 v[176:179], a[16:19], a[28:31], v[176:179]
    ds_read_b64_tr_b16 a[10:11], v21 offset:4096
    v_mfma_f32_16x16x32_bf16 v[148:151], a[20:23], a[24:27], v[148:151]
    ds_read_b64_tr_b16 a[12:13], v22 offset:0
    v_mfma_f32_16x16x32_bf16 v[180:183], a[20:23], a[28:31], v[180:183]
    ds_read_b64_tr_b16 a[14:15], v22 offset:4096
    s_waitcnt lgkmcnt(6)
    v_mfma_f32_16x16x32_bf16 v[152:155], a[0:3], a[24:27], v[152:155]
    ds_read_b64_tr_b16 a[16:17], v23 offset:0
    v_mfma_f32_16x16x32_bf16 v[184:187], a[0:3], a[28:31], v[184:187]
    ds_read_b64_tr_b16 a[18:19], v23 offset:4096
    v_mfma_f32_16x16x32_bf16 v[156:159], a[4:7], a[24:27], v[156:159]
    ds_read_b64_tr_b16 a[20:21], v24 offset:0
    v_mfma_f32_16x16x32_bf16 v[188:191], a[4:7], a[28:31], v[188:191]
    ds_read_b64_tr_b16 a[22:23], v24 offset:4096
    s_waitcnt lgkmcnt(4)
    v_mfma_f32_16x16x32_bf16 v[128:131], a[8:11], a[36:39], v[128:131]
    ds_read_b64_tr_b16 a[0:1], v25 offset:0
    v_mfma_f32_16x16x32_bf16 v[160:163], a[8:11], a[40:43], v[160:163]
    ds_read_b64_tr_b16 a[2:3], v25 offset:4096
    v_mfma_f32_16x16x32_bf16 v[132:135], a[12:15], a[36:39], v[132:135]
    ds_read_b64_tr_b16 a[4:5], v26 offset:0
    v_mfma_f32_16x16x32_bf16 v[164:167], a[12:15], a[40:43], v[164:167]
    ds_read_b64_tr_b16 a[6:7], v26 offset:4096
    s_waitcnt lgkmcnt(4)
    v_mfma_f32_16x16x32_bf16 v[136:139], a[16:19], a[36:39], v[136:139]
    ds_read_b64_tr_b16 a[8:9], v27 offset:0
    v_mfma_f32_16x16x32_bf16 v[168:171], a[16:19], a[40:43], v[168:171]
    ds_read_b64_tr_b16 a[10:11], v27 offset:4096
    v_mfma_f32_16x16x32_bf16 v[140:143], a[20:23], a[36:39], v[140:143]
    ds_read_b64_tr_b16 a[12:13], v28 offset:0
    v_mfma_f32_16x16x32_bf16 v[172:175], a[20:23], a[40:43], v[172:175]
    ds_read_b64_tr_b16 a[14:15], v28 offset:4096
    s_waitcnt lgkmcnt(4)
    v_mfma_f32_16x16x32_bf16 v[144:147], a[0:3], a[36:39], v[144:147]
    v_mfma_f32_16x16x32_bf16 v[176:179], a[0:3], a[40:43], v[176:179]
    v_mfma_f32_16x16x32_bf16 v[148:151], a[4:7], a[36:39], v[148:151]
    v_mfma_f32_16x16x32_bf16 v[180:183], a[4:7], a[40:43], v[180:183]
    s_waitcnt lgkmcnt(0)
    v_mfma_f32_16x16x32_bf16 v[152:155], a[8:11], a[36:39], v[152:155]
    v_mfma_f32_16x16x32_bf16 v[184:187], a[8:11], a[40:43], v[184:187]
    v_mfma_f32_16x16x32_bf16 v[156:159], a[12:15], a[36:39], v[156:159]
    v_mfma_f32_16x16x32_bf16 v[188:191], a[12:15], a[40:43], v[188:191]
L_k1_H_done:
    s_nop 15
    s_lshl_b32 s26, s24, 3
    s_lshl_b32 s27, s21, 1
    s_add_u32 s26, s26, s27
    s_add_u32 s26, s26, 0
    s_lshr_b32 s27, s26, 2
    s_mul_i32 s27, s27, 303104
    s_and_b32 s26, s26, 3
    s_lshl_b32 s26, s26, 10
    s_add_u32 s48, s26, s27
    s_lshl_b32 s27, s25, 6
    s_add_u32 s48, s48, s27
    s_lshl_b32 s27, s22, 14
    s_add_u32 s48, s48, s27
    s_add_u32 s48, s48, 81920
    v_cvt_pk_bf16_f32 v128, 0, v128
    v_cvt_pk_bf16_f32 v129, 0, v129
    v_cvt_pk_bf16_f32 v130, 0, v130
    v_cvt_pk_bf16_f32 v131, 0, v131
    v_cvt_pk_bf16_f32 v132, 0, v132
    v_cvt_pk_bf16_f32 v133, 0, v133
    v_cvt_pk_bf16_f32 v134, 0, v134
    v_cvt_pk_bf16_f32 v135, 0, v135
    v_cvt_pk_bf16_f32 v136, 0, v136
    v_cvt_pk_bf16_f32 v137, 0, v137
    v_cvt_pk_bf16_f32 v138, 0, v138
    v_cvt_pk_bf16_f32 v139, 0, v139
    v_cvt_pk_bf16_f32 v140, 0, v140
    v_cvt_pk_bf16_f32 v141, 0, v141
    v_cvt_pk_bf16_f32 v142, 0, v142
    v_cvt_pk_bf16_f32 v143, 0, v143
    v_cvt_pk_bf16_f32 v144, 0, v144
    v_cvt_pk_bf16_f32 v145, 0, v145
    v_cvt_pk_bf16_f32 v146, 0, v146
    v_cvt_pk_bf16_f32 v147, 0, v147
    v_cvt_pk_bf16_f32 v148, 0, v148
    v_cvt_pk_bf16_f32 v149, 0, v149
    v_cvt_pk_bf16_f32 v150, 0, v150
    v_cvt_pk_bf16_f32 v151, 0, v151
    v_cvt_pk_bf16_f32 v152, 0, v152
    v_cvt_pk_bf16_f32 v153, 0, v153
    v_cvt_pk_bf16_f32 v154, 0, v154
    v_cvt_pk_bf16_f32 v155, 0, v155
    v_cvt_pk_bf16_f32 v156, 0, v156
    v_cvt_pk_bf16_f32 v157, 0, v157
    v_cvt_pk_bf16_f32 v158, 0, v158
    v_cvt_pk_bf16_f32 v159, 0, v159
    v_mul_f32 v36, 0xbfb8aa3b, v128
    v_mul_f32 v37, 0xbfb8aa3b, v129
    v_mul_f32 v38, 0xbfb8aa3b, v130
    v_mul_f32 v39, 0xbfb8aa3b, v131
    v_mul_f32 v40, 0xbfb8aa3b, v132
    v_mul_f32 v41, 0xbfb8aa3b, v133
    v_mul_f32 v42, 0xbfb8aa3b, v134
    v_mul_f32 v43, 0xbfb8aa3b, v135
    v_mul_f32 v44, 0xbfb8aa3b, v136
    v_mul_f32 v45, 0xbfb8aa3b, v137
    v_mul_f32 v46, 0xbfb8aa3b, v138
    v_mul_f32 v47, 0xbfb8aa3b, v139
    v_mul_f32 v48, 0xbfb8aa3b, v140
    v_mul_f32 v49, 0xbfb8aa3b, v141
    v_mul_f32 v50, 0xbfb8aa3b, v142
    v_mul_f32 v51, 0xbfb8aa3b, v143
    v_mul_f32 v52, 0xbfb8aa3b, v144
    v_mul_f32 v53, 0xbfb8aa3b, v145
    v_mul_f32 v54, 0xbfb8aa3b, v146
    v_mul_f32 v55, 0xbfb8aa3b, v147
    v_mul_f32 v56, 0xbfb8aa3b, v148
    v_mul_f32 v57, 0xbfb8aa3b, v149
    v_mul_f32 v58, 0xbfb8aa3b, v150
    v_mul_f32 v59, 0xbfb8aa3b, v151
    v_mul_f32 v60, 0xbfb8aa3b, v152
    v_mul_f32 v61, 0xbfb8aa3b, v153
    v_mul_f32 v62, 0xbfb8aa3b, v154
    v_mul_f32 v63, 0xbfb8aa3b, v155
    v_mul_f32 v64, 0xbfb8aa3b, v156
    v_mul_f32 v65, 0xbfb8aa3b, v157
    v_mul_f32 v66, 0xbfb8aa3b, v158
    v_mul_f32 v67, 0xbfb8aa3b, v159
    v_exp_f32 v36, v36
    v_exp_f32 v37, v37
    v_exp_f32 v38, v38
    v_exp_f32 v39, v39
    v_exp_f32 v40, v40
    v_exp_f32 v41, v41
    v_exp_f32 v42, v42
    v_exp_f32 v43, v43
    v_exp_f32 v44, v44
    v_exp_f32 v45, v45
    v_exp_f32 v46, v46
    v_exp_f32 v47, v47
    v_exp_f32 v48, v48
    v_exp_f32 v49, v49
    v_exp_f32 v50, v50
    v_exp_f32 v51, v51
    v_exp_f32 v52, v52
    v_exp_f32 v53, v53
    v_exp_f32 v54, v54
    v_exp_f32 v55, v55
    v_exp_f32 v56, v56
    v_exp_f32 v57, v57
    v_exp_f32 v58, v58
    v_exp_f32 v59, v59
    v_exp_f32 v60, v60
    v_exp_f32 v61, v61
    v_exp_f32 v62, v62
    v_exp_f32 v63, v63
    v_exp_f32 v64, v64
    v_exp_f32 v65, v65
    v_exp_f32 v66, v66
    v_exp_f32 v67, v67
    v_add_f32 v36, 1.0, v36
    v_add_f32 v37, 1.0, v37
    v_add_f32 v38, 1.0, v38
    v_add_f32 v39, 1.0, v39
    v_add_f32 v40, 1.0, v40
    v_add_f32 v41, 1.0, v41
    v_add_f32 v42, 1.0, v42
    v_add_f32 v43, 1.0, v43
    v_add_f32 v44, 1.0, v44
    v_add_f32 v45, 1.0, v45
    v_add_f32 v46, 1.0, v46
    v_add_f32 v47, 1.0, v47
    v_add_f32 v48, 1.0, v48
    v_add_f32 v49, 1.0, v49
    v_add_f32 v50, 1.0, v50
    v_add_f32 v51, 1.0, v51
    v_add_f32 v52, 1.0, v52
    v_add_f32 v53, 1.0, v53
    v_add_f32 v54, 1.0, v54
    v_add_f32 v55, 1.0, v55
    v_add_f32 v56, 1.0, v56
    v_add_f32 v57, 1.0, v57
    v_add_f32 v58, 1.0, v58
    v_add_f32 v59, 1.0, v59
    v_add_f32 v60, 1.0, v60
    v_add_f32 v61, 1.0, v61
    v_add_f32 v62, 1.0, v62
    v_add_f32 v63, 1.0, v63
    v_add_f32 v64, 1.0, v64
    v_add_f32 v65, 1.0, v65
    v_add_f32 v66, 1.0, v66
    v_add_f32 v67, 1.0, v67
    v_rcp_f32 v36, v36
    v_rcp_f32 v37, v37
    v_rcp_f32 v38, v38
    v_rcp_f32 v39, v39
    v_rcp_f32 v40, v40
    v_rcp_f32 v41, v41
    v_rcp_f32 v42, v42
    v_rcp_f32 v43, v43
    v_rcp_f32 v44, v44
    v_rcp_f32 v45, v45
    v_rcp_f32 v46, v46
    v_rcp_f32 v47, v47
    v_rcp_f32 v48, v48
    v_rcp_f32 v49, v49
    v_rcp_f32 v50, v50
    v_rcp_f32 v51, v51
    v_rcp_f32 v52, v52
    v_rcp_f32 v53, v53
    v_rcp_f32 v54, v54
    v_rcp_f32 v55, v55
    v_rcp_f32 v56, v56
    v_rcp_f32 v57, v57
    v_rcp_f32 v58, v58
    v_rcp_f32 v59, v59
    v_rcp_f32 v60, v60
    v_rcp_f32 v61, v61
    v_rcp_f32 v62, v62
    v_rcp_f32 v63, v63
    v_rcp_f32 v64, v64
    v_rcp_f32 v65, v65
    v_rcp_f32 v66, v66
    v_rcp_f32 v67, v67
    v_mul_f32 v128, v128, v36
    v_mul_f32 v129, v129, v37
    v_mul_f32 v130, v130, v38
    v_mul_f32 v131, v131, v39
    v_mul_f32 v132, v132, v40
    v_mul_f32 v133, v133, v41
    v_mul_f32 v134, v134, v42
    v_mul_f32 v135, v135, v43
    v_mul_f32 v136, v136, v44
    v_mul_f32 v137, v137, v45
    v_mul_f32 v138, v138, v46
    v_mul_f32 v139, v139, v47
    v_mul_f32 v140, v140, v48
    v_mul_f32 v141, v141, v49
    v_mul_f32 v142, v142, v50
    v_mul_f32 v143, v143, v51
    v_mul_f32 v144, v144, v52
    v_mul_f32 v145, v145, v53
    v_mul_f32 v146, v146, v54
    v_mul_f32 v147, v147, v55
    v_mul_f32 v148, v148, v56
    v_mul_f32 v149, v149, v57
    v_mul_f32 v150, v150, v58
    v_mul_f32 v151, v151, v59
    v_mul_f32 v152, v152, v60
    v_mul_f32 v153, v153, v61
    v_mul_f32 v154, v154, v62
    v_mul_f32 v155, v155, v63
    v_mul_f32 v156, v156, v64
    v_mul_f32 v157, v157, v65
    v_mul_f32 v158, v158, v66
    v_mul_f32 v159, v159, v67
    v_cvt_pk_bf16_f32 v68, v128, v129
    v_cvt_pk_bf16_f32 v69, v130, v131
    v_cvt_pk_bf16_f32 v70, v132, v133
    v_cvt_pk_bf16_f32 v71, v134, v135
    buffer_store_dwordx4 v[68:71], v2, s[16:19], s48 offen offset:0
    s_add_u32 s48, s48, 4096
    v_cvt_pk_bf16_f32 v72, v136, v137
    v_cvt_pk_bf16_f32 v73, v138, v139
    v_cvt_pk_bf16_f32 v74, v140, v141
    v_cvt_pk_bf16_f32 v75, v142, v143
    buffer_store_dwordx4 v[72:75], v2, s[16:19], s48 offen offset:0
    s_add_u32 s48, s48, 4096
    v_cvt_pk_bf16_f32 v76, v144, v145
    v_cvt_pk_bf16_f32 v77, v146, v147
    v_cvt_pk_bf16_f32 v78, v148, v149
    v_cvt_pk_bf16_f32 v79, v150, v151
    buffer_store_dwordx4 v[76:79], v2, s[16:19], s48 offen offset:0
    s_add_u32 s48, s48, 4096
    v_cvt_pk_bf16_f32 v80, v152, v153
    v_cvt_pk_bf16_f32 v81, v154, v155
    v_cvt_pk_bf16_f32 v82, v156, v157
    v_cvt_pk_bf16_f32 v83, v158, v159
    buffer_store_dwordx4 v[80:83], v2, s[16:19], s48 offen offset:0
    s_add_u32 s48, s48, 4096
    s_lshl_b32 s26, s24, 3
    s_lshl_b32 s27, s21, 1
    s_add_u32 s26, s26, s27
    s_add_u32 s26, s26, 1
    s_lshr_b32 s27, s26, 2
    s_mul_i32 s27, s27, 303104
    s_and_b32 s26, s26, 3
    s_lshl_b32 s26, s26, 10
    s_add_u32 s48, s26, s27
    s_lshl_b32 s27, s25, 6
    s_add_u32 s48, s48, s27
    s_lshl_b32 s27, s22, 14
    s_add_u32 s48, s48, s27
    s_add_u32 s48, s48, 81920
    v_cvt_pk_bf16_f32 v160, 0, v160
    v_cvt_pk_bf16_f32 v161, 0, v161
    v_cvt_pk_bf16_f32 v162, 0, v162
    v_cvt_pk_bf16_f32 v163, 0, v163
    v_cvt_pk_bf16_f32 v164, 0, v164
    v_cvt_pk_bf16_f32 v165, 0, v165
    v_cvt_pk_bf16_f32 v166, 0, v166
    v_cvt_pk_bf16_f32 v167, 0, v167
    v_cvt_pk_bf16_f32 v168, 0, v168
    v_cvt_pk_bf16_f32 v169, 0, v169
    v_cvt_pk_bf16_f32 v170, 0, v170
    v_cvt_pk_bf16_f32 v171, 0, v171
    v_cvt_pk_bf16_f32 v172, 0, v172
    v_cvt_pk_bf16_f32 v173, 0, v173
    v_cvt_pk_bf16_f32 v174, 0, v174
    v_cvt_pk_bf16_f32 v175, 0, v175
    v_cvt_pk_bf16_f32 v176, 0, v176
    v_cvt_pk_bf16_f32 v177, 0, v177
    v_cvt_pk_bf16_f32 v178, 0, v178
    v_cvt_pk_bf16_f32 v179, 0, v179
    v_cvt_pk_bf16_f32 v180, 0, v180
    v_cvt_pk_bf16_f32 v181, 0, v181
    v_cvt_pk_bf16_f32 v182, 0, v182
    v_cvt_pk_bf16_f32 v183, 0, v183
    v_cvt_pk_bf16_f32 v184, 0, v184
    v_cvt_pk_bf16_f32 v185, 0, v185
    v_cvt_pk_bf16_f32 v186, 0, v186
    v_cvt_pk_bf16_f32 v187, 0, v187
    v_cvt_pk_bf16_f32 v188, 0, v188
    v_cvt_pk_bf16_f32 v189, 0, v189
    v_cvt_pk_bf16_f32 v190, 0, v190
    v_cvt_pk_bf16_f32 v191, 0, v191
    v_mul_f32 v36, 0xbfb8aa3b, v160
    v_mul_f32 v37, 0xbfb8aa3b, v161
    v_mul_f32 v38, 0xbfb8aa3b, v162
    v_mul_f32 v39, 0xbfb8aa3b, v163
    v_mul_f32 v40, 0xbfb8aa3b, v164
    v_mul_f32 v41, 0xbfb8aa3b, v165
    v_mul_f32 v42, 0xbfb8aa3b, v166
    v_mul_f32 v43, 0xbfb8aa3b, v167
    v_mul_f32 v44, 0xbfb8aa3b, v168
    v_mul_f32 v45, 0xbfb8aa3b, v169
    v_mul_f32 v46, 0xbfb8aa3b, v170
    v_mul_f32 v47, 0xbfb8aa3b, v171
    v_mul_f32 v48, 0xbfb8aa3b, v172
    v_mul_f32 v49, 0xbfb8aa3b, v173
    v_mul_f32 v50, 0xbfb8aa3b, v174
    v_mul_f32 v51, 0xbfb8aa3b, v175
    v_mul_f32 v52, 0xbfb8aa3b, v176
    v_mul_f32 v53, 0xbfb8aa3b, v177
    v_mul_f32 v54, 0xbfb8aa3b, v178
    v_mul_f32 v55, 0xbfb8aa3b, v179
    v_mul_f32 v56, 0xbfb8aa3b, v180
    v_mul_f32 v57, 0xbfb8aa3b, v181
    v_mul_f32 v58, 0xbfb8aa3b, v182
    v_mul_f32 v59, 0xbfb8aa3b, v183
    v_mul_f32 v60, 0xbfb8aa3b, v184
    v_mul_f32 v61, 0xbfb8aa3b, v185
    v_mul_f32 v62, 0xbfb8aa3b, v186
    v_mul_f32 v63, 0xbfb8aa3b, v187
    v_mul_f32 v64, 0xbfb8aa3b, v188
    v_mul_f32 v65, 0xbfb8aa3b, v189
    v_mul_f32 v66, 0xbfb8aa3b, v190
    v_mul_f32 v67, 0xbfb8aa3b, v191
    v_exp_f32 v36, v36
    v_exp_f32 v37, v37
    v_exp_f32 v38, v38
    v_exp_f32 v39, v39
    v_exp_f32 v40, v40
    v_exp_f32 v41, v41
    v_exp_f32 v42, v42
    v_exp_f32 v43, v43
    v_exp_f32 v44, v44
    v_exp_f32 v45, v45
    v_exp_f32 v46, v46
    v_exp_f32 v47, v47
    v_exp_f32 v48, v48
    v_exp_f32 v49, v49
    v_exp_f32 v50, v50
    v_exp_f32 v51, v51
    v_exp_f32 v52, v52
    v_exp_f32 v53, v53
    v_exp_f32 v54, v54
    v_exp_f32 v55, v55
    v_exp_f32 v56, v56
    v_exp_f32 v57, v57
    v_exp_f32 v58, v58
    v_exp_f32 v59, v59
    v_exp_f32 v60, v60
    v_exp_f32 v61, v61
    v_exp_f32 v62, v62
    v_exp_f32 v63, v63
    v_exp_f32 v64, v64
    v_exp_f32 v65, v65
    v_exp_f32 v66, v66
    v_exp_f32 v67, v67
    v_add_f32 v36, 1.0, v36
    v_add_f32 v37, 1.0, v37
    v_add_f32 v38, 1.0, v38
    v_add_f32 v39, 1.0, v39
    v_add_f32 v40, 1.0, v40
    v_add_f32 v41, 1.0, v41
    v_add_f32 v42, 1.0, v42
    v_add_f32 v43, 1.0, v43
    v_add_f32 v44, 1.0, v44
    v_add_f32 v45, 1.0, v45
    v_add_f32 v46, 1.0, v46
    v_add_f32 v47, 1.0, v47
    v_add_f32 v48, 1.0, v48
    v_add_f32 v49, 1.0, v49
    v_add_f32 v50, 1.0, v50
    v_add_f32 v51, 1.0, v51
    v_add_f32 v52, 1.0, v52
    v_add_f32 v53, 1.0, v53
    v_add_f32 v54, 1.0, v54
    v_add_f32 v55, 1.0, v55
    v_add_f32 v56, 1.0, v56
    v_add_f32 v57, 1.0, v57
    v_add_f32 v58, 1.0, v58
    v_add_f32 v59, 1.0, v59
    v_add_f32 v60, 1.0, v60
    v_add_f32 v61, 1.0, v61
    v_add_f32 v62, 1.0, v62
    v_add_f32 v63, 1.0, v63
    v_add_f32 v64, 1.0, v64
    v_add_f32 v65, 1.0, v65
    v_add_f32 v66, 1.0, v66
    v_add_f32 v67, 1.0, v67
    v_rcp_f32 v36, v36
    v_rcp_f32 v37, v37
    v_rcp_f32 v38, v38
    v_rcp_f32 v39, v39
    v_rcp_f32 v40, v40
    v_rcp_f32 v41, v41
    v_rcp_f32 v42, v42
    v_rcp_f32 v43, v43
    v_rcp_f32 v44, v44
    v_rcp_f32 v45, v45
    v_rcp_f32 v46, v46
    v_rcp_f32 v47, v47
    v_rcp_f32 v48, v48
    v_rcp_f32 v49, v49
    v_rcp_f32 v50, v50
    v_rcp_f32 v51, v51
    v_rcp_f32 v52, v52
    v_rcp_f32 v53, v53
    v_rcp_f32 v54, v54
    v_rcp_f32 v55, v55
    v_rcp_f32 v56, v56
    v_rcp_f32 v57, v57
    v_rcp_f32 v58, v58
    v_rcp_f32 v59, v59
    v_rcp_f32 v60, v60
    v_rcp_f32 v61, v61
    v_rcp_f32 v62, v62
    v_rcp_f32 v63, v63
    v_rcp_f32 v64, v64
    v_rcp_f32 v65, v65
    v_rcp_f32 v66, v66
    v_rcp_f32 v67, v67
    v_mul_f32 v160, v160, v36
    v_mul_f32 v161, v161, v37
    v_mul_f32 v162, v162, v38
    v_mul_f32 v163, v163, v39
    v_mul_f32 v164, v164, v40
    v_mul_f32 v165, v165, v41
    v_mul_f32 v166, v166, v42
    v_mul_f32 v167, v167, v43
    v_mul_f32 v168, v168, v44
    v_mul_f32 v169, v169, v45
    v_mul_f32 v170, v170, v46
    v_mul_f32 v171, v171, v47
    v_mul_f32 v172, v172, v48
    v_mul_f32 v173, v173, v49
    v_mul_f32 v174, v174, v50
    v_mul_f32 v175, v175, v51
    v_mul_f32 v176, v176, v52
    v_mul_f32 v177, v177, v53
    v_mul_f32 v178, v178, v54
    v_mul_f32 v179, v179, v55
    v_mul_f32 v180, v180, v56
    v_mul_f32 v181, v181, v57
    v_mul_f32 v182, v182, v58
    v_mul_f32 v183, v183, v59
    v_mul_f32 v184, v184, v60
    v_mul_f32 v185, v185, v61
    v_mul_f32 v186, v186, v62
    v_mul_f32 v187, v187, v63
    v_mul_f32 v188, v188, v64
    v_mul_f32 v189, v189, v65
    v_mul_f32 v190, v190, v66
    v_mul_f32 v191, v191, v67
    v_cvt_pk_bf16_f32 v84, v160, v161
    v_cvt_pk_bf16_f32 v85, v162, v163
    v_cvt_pk_bf16_f32 v86, v164, v165
    v_cvt_pk_bf16_f32 v87, v166, v167
    buffer_store_dwordx4 v[84:87], v2, s[16:19], s48 offen offset:0
    s_add_u32 s48, s48, 4096
    v_cvt_pk_bf16_f32 v88, v168, v169
    v_cvt_pk_bf16_f32 v89, v170, v171
    v_cvt_pk_bf16_f32 v90, v172, v173
    v_cvt_pk_bf16_f32 v91, v174, v175
    buffer_store_dwordx4 v[88:91], v2, s[16:19], s48 offen offset:0
    s_add_u32 s48, s48, 4096
    v_cvt_pk_bf16_f32 v92, v176, v177
    v_cvt_pk_bf16_f32 v93, v178, v179
    v_cvt_pk_bf16_f32 v94, v180, v181
    v_cvt_pk_bf16_f32 v95, v182, v183
    buffer_store_dwordx4 v[92:95], v2, s[16:19], s48 offen offset:0
    s_add_u32 s48, s48, 4096
    v_cvt_pk_bf16_f32 v96, v184, v185
    v_cvt_pk_bf16_f32 v97, v186, v187
    v_cvt_pk_bf16_f32 v98, v188, v189
    v_cvt_pk_bf16_f32 v99, v190, v191
    buffer_store_dwordx4 v[96:99], v2, s[16:19], s48 offen offset:0
    s_add_u32 s48, s48, 4096
    s_endpgm
L_k1_r:
    s_lshl_b32 s25, s3, 1
    s_add_u32 s25, s25, s4
    s_sub_u32 s25, s25, 30
    s_add_u32 s16, s60, 0x1000000
    s_addc_u32 s17, s61, 0
    s_and_b32 s17, s17, 0xffff
    s_mov_b32 s18, 0x2e4000
    s_mov_b32 s19, 0x00020000
    v_and_b32 v1, 63, v0
    v_lshlrev_b32 v2, 4, v1
    s_mul_i32 s26, s20, 320
    v_add_u32 v128, s26, v1
    v_add_u32 v128, 0, v128
    v_mul_u32_u24 v129, 3277, v128
    v_lshrrev_b32 v129, 18, v129
    v_mul_u32_u24 v130, 80, v129
    v_sub_u32 v128, v128, v130
    v_and_b32 v130, 7, v129
    v_lshlrev_b32 v130, 1, v130
    v_xor_b32 v128, v128, v130
    v_mul_u32_u24 v129, 1280, v129
    v_lshl_add_u32 v8, v128, 4, v129
    v_add_u32 v128, s26, v1
    v_add_u32 v128, 64, v128
    v_mul_u32_u24 v129, 3277, v128
    v_lshrrev_b32 v129, 18, v129
    v_mul_u32_u24 v130, 80, v129
    v_sub_u32 v128, v128, v130
    v_and_b32 v130, 7, v129
    v_lshlrev_b32 v130, 1, v130
    v_xor_b32 v128, v128, v130
    v_mul_u32_u24 v129, 1280, v129
    v_lshl_add_u32 v9, v128, 4, v129
    v_add_u32 v128, s26, v1
    v_add_u32 v128, 128, v128
    v_mul_u32_u24 v129, 3277, v128
    v_lshrrev_b32 v129, 18, v129
    v_mul_u32_u24 v130, 80, v129
    v_sub_u32 v128, v128, v130
    v_and_b32 v130, 7, v129
    v_lshlrev_b32 v130, 1, v130
    v_xor_b32 v128, v128, v130
    v_mul_u32_u24 v129, 1280, v129
    v_lshl_add_u32 v10, v128, 4, v129
    v_add_u32 v128, s26, v1
    v_add_u32 v128, 192, v128
    v_mul_u32_u24 v129, 3277, v128
    v_lshrrev_b32 v129, 18, v129
    v_mul_u32_u24 v130, 80, v129
    v_sub_u32 v128, v128, v130
    v_and_b32 v130, 7, v129
    v_lshlrev_b32 v130, 1, v130
    v_xor_b32 v128, v128, v130
    v_mul_u32_u24 v129, 1280, v129
    v_lshl_add_u32 v11, v128, 4, v129
    v_add_u32 v128, s26, v1
    v_add_u32 v128, 256, v128
    v_mul_u32_u24 v129, 3277, v128
    v_lshrrev_b32 v129, 18, v129
    v_mul_u32_u24 v130, 80, v129
    v_sub_u32 v128, v128, v130
    v_and_b32 v130, 7, v129
    v_lshlrev_b32 v130, 1, v130
    v_xor_b32 v128, v128, v130
    v_mul_u32_u24 v129, 1280, v129
    v_lshl_add_u32 v12, v128, 4, v129
    v_lshrrev_b32 v128, 4, v1
    v_bfe_u32 v129, v1, 2, 2
    v_and_b32 v130, 1, v128
    v_lshl_add_u32 v130, v130, 2, v129
    v_lshl_add_u32 v131, v128, 2, v129
    v_mul_u32_u24 v131, 1280, v131
    v_and_b32 v132, 3, v1
    v_lshl_add_u32 v131, v132, 3, v131
    s_mul_i32 s26, s20, 5
    s_add_u32 s26, s26, 0
    s_and_b32 s27, s26, 7
    v_xor_b32 v132, s27, v130
    v_lshl_add_u32 v132, v132, 5, v131
    s_lshr_b32 s27, s26, 3
    s_lshl_b32 s27, s27, 8
    v_add_u32 v16, s27, v132
    v_add_u32 v21, 0x14000, v16
    s_mul_i32 s26, s20, 5
    s_add_u32 s26, s26, 1
    s_and_b32 s27, s26, 7
    v_xor_b32 v132, s27, v130
    v_lshl_add_u32 v132, v132, 5, v131
    s_lshr_b32 s27, s26, 3
    s_lshl_b32 s27, s27, 8
    v_add_u32 v17, s27, v132
    v_add_u32 v22, 0x14000, v17
    s_mul_i32 s26, s20, 5
    s_add_u32 s26, s26, 2
    s_and_b32 s27, s26, 7
    v_xor_b32 v132, s27, v130
    v_lshl_add_u32 v132, v132, 5, v131
    s_lshr_b32 s27, s26, 3
    s_lshl_b32 s27, s27, 8
    v_add_u32 v18, s27, v132
    v_add_u32 v23, 0x14000, v18
    s_mul_i32 s26, s20, 5
    s_add_u32 s26, s26, 3
    s_and_b32 s27, s26, 7
    v_xor_b32 v132, s27, v130
    v_lshl_add_u32 v132, v132, 5, v131
    s_lshr_b32 s27, s26, 3
    s_lshl_b32 s27, s27, 8
    v_add_u32 v19, s27, v132
    v_add_u32 v24, 0x14000, v19
    s_mul_i32 s26, s20, 5
    s_add_u32 s26, s26, 4
    s_and_b32 s27, s26, 7
    v_xor_b32 v132, s27, v130
    v_lshl_add_u32 v132, v132, 5, v131
    s_lshr_b32 s27, s26, 3
    s_lshl_b32 s27, s27, 8
    v_add_u32 v20, s27, v132
    v_add_u32 v25, 0x14000, v20
    s_mul_i32 s28, s20, 5120
    s_mov_b32 s62, 0xc8000
    s_mov_b32 s63, 0x21c000
    s_add_u32 s72, s25, 0
    s_add_u32 s73, s25, 16
    s_add_u32 s74, s25, 32
    s_add_u32 s75, s25, 48
    s_add_u32 s76, s25, 64
    s_cmp_lt_u32 s76, 74
    s_cselect_b32 s76, s76, s75
    s_cmp_lt_u32 s72, 20
    s_cselect_b32 s8, s54, s58
    s_cselect_b32 s9, s55, s59
    s_cselect_b32 s10, s62, s63
    s_cselect_b32 s52, 0, 20
    s_and_b32 s9, s9, 0xffff
    s_mov_b32 s11, 0x00020000
    s_sub_u32 s51, s72, s52
    s_mul_i32 s51, s51, 40960
    s_add_u32 m0, s28, 0
    s_nop 0
    buffer_load_dwordx4 v8, s[8:11], s51 offen lds
    s_add_u32 m0, s28, 1024
    s_nop 0
    buffer_load_dwordx4 v9, s[8:11], s51 offen lds
    s_add_u32 m0, s28, 2048
    s_nop 0
    buffer_load_dwordx4 v10, s[8:11], s51 offen lds
    s_add_u32 m0, s28, 3072
    s_nop 0
    buffer_load_dwordx4 v11, s[8:11], s51 offen lds
    s_add_u32 m0, s28, 4096
    s_nop 0
    buffer_load_dwordx4 v12, s[8:11], s51 offen lds
    s_cmp_lt_u32 s73, 20
    s_cselect_b32 s8, s54, s58
    s_cselect_b32 s9, s55, s59
    s_cselect_b32 s10, s62, s63
    s_cselect_b32 s52, 0, 20
    s_and_b32 s9, s9, 0xffff
    s_mov_b32 s11, 0x00020000
    s_sub_u32 s51, s73, s52
    s_mul_i32 s51, s51, 40960
    s_add_u32 m0, s28, 40960
    s_nop 0
    buffer_load_dwordx4 v8, s[8:11], s51 offen lds
    s_add_u32 m0, s28, 41984
    s_nop 0
    buffer_load_dwordx4 v9, s[8:11], s51 offen lds
    s_add_u32 m0, s28, 43008
    s_nop 0
    buffer_load_dwordx4 v10, s[8:11], s51 offen lds
    s_add_u32 m0, s28, 44032
    s_nop 0
    buffer_load_dwordx4 v11, s[8:11], s51 offen lds
    s_add_u32 m0, s28, 45056
    s_nop 0
    buffer_load_dwordx4 v12, s[8:11], s51 offen lds
    s_cmp_lt_u32 s74, 20
    s_cselect_b32 s8, s54, s58
    s_cselect_b32 s9, s55, s59
    s_cselect_b32 s10, s62, s63
    s_cselect_b32 s52, 0, 20
    s_and_b32 s9, s9, 0xffff
    s_mov_b32 s11, 0x00020000
    s_sub_u32 s51, s74, s52
    s_mul_i32 s51, s51, 40960
    s_add_u32 m0, s28, 81920
    s_nop 0
    buffer_load_dwordx4 v8, s[8:11], s51 offen lds
    s_add_u32 m0, s28, 82944
    s_nop 0
    buffer_load_dwordx4 v9, s[8:11], s51 offen lds
    s_add_u32 m0, s28, 83968
    s_nop 0
    buffer_load_dwordx4 v10, s[8:11], s51 offen lds
    s_add_u32 m0, s28, 84992
    s_nop 0
    buffer_load_dwordx4 v11, s[8:11], s51 offen lds
    s_add_u32 m0, s28, 86016
    s_nop 0
    buffer_load_dwordx4 v12, s[8:11], s51 offen lds
    s_cmp_lt_u32 s75, 20
    s_cselect_b32 s8, s54, s58
    s_cselect_b32 s9, s55, s59
    s_cselect_b32 s10, s62, s63
    s_cselect_b32 s52, 0, 20
    s_and_b32 s9, s9, 0xffff
    s_mov_b32 s11, 0x00020000
    s_sub_u32 s51, s75, s52
    s_mul_i32 s51, s51, 40960
    s_add_u32 m0, s28, 122880
    s_nop 0
    buffer_load_dwordx4 v8, s[8:11], s51 offen lds
    s_add_u32 m0, s28, 123904
    s_nop 0
    buffer_load_dwordx4 v9, s[8:11], s51 offen lds
    s_add_u32 m0, s28, 124928
    s_nop 0
    buffer_load_dwordx4 v10, s[8:11], s51 offen lds
    s_add_u32 m0, s28, 125952
    s_nop 0
    buffer_load_dwordx4 v11, s[8:11], s51 offen lds
    s_add_u32 m0, s28, 126976
    s_nop 0
    buffer_load_dwordx4 v12, s[8:11], s51 offen lds
    s_waitcnt vmcnt(15)
    s_barrier
    ds_read_b64_tr_b16 v[64:65], v16 offset:0
    ds_read_b64_tr_b16 v[66:67], v16 offset:20480
    ds_read_b64_tr_b16 v[68:69], v17 offset:0
    ds_read_b64_tr_b16 v[70:71], v17 offset:20480
    ds_read_b64_tr_b16 v[72:73], v18 offset:0
    ds_read_b64_tr_b16 v[74:75], v18 offset:20480
    ds_read_b64_tr_b16 v[76:77], v19 offset:0
    ds_read_b64_tr_b16 v[78:79], v19 offset:20480
    ds_read_b64_tr_b16 v[80:81], v20 offset:0
    ds_read_b64_tr_b16 v[82:83], v20 offset:20480
    s_waitcnt lgkmcnt(0)
    s_mul_i32 s26, s20, 74
    s_add_u32 s26, s26, s72
    s_mul_i32 s26, s26, 5120
    buffer_store_dwordx4 v[64:67], v2, s[16:19], s26 offen offset:0
    buffer_store_dwordx4 v[68:71], v2, s[16:19], s26 offen offset:1024
    buffer_store_dwordx4 v[72:75], v2, s[16:19], s26 offen offset:2048
    buffer_store_dwordx4 v[76:79], v2, s[16:19], s26 offen offset:3072
    s_add_u32 s26, s26, 4096
    buffer_store_dwordx4 v[80:83], v2, s[16:19], s26 offen offset:0
    s_barrier
    s_cmp_lt_u32 s76, 20
    s_cselect_b32 s8, s54, s58
    s_cselect_b32 s9, s55, s59
    s_cselect_b32 s10, s62, s63
    s_cselect_b32 s52, 0, 20
    s_and_b32 s9, s9, 0xffff
    s_mov_b32 s11, 0x00020000
    s_sub_u32 s51, s76, s52
    s_mul_i32 s51, s51, 40960
    s_add_u32 m0, s28, 0
    s_nop 0
    buffer_load_dwordx4 v8, s[8:11], s51 offen lds
    s_add_u32 m0, s28, 1024
    s_nop 0
    buffer_load_dwordx4 v9, s[8:11], s51 offen lds
    s_add_u32 m0, s28, 2048
    s_nop 0
    buffer_load_dwordx4 v10, s[8:11], s51 offen lds
    s_add_u32 m0, s28, 3072
    s_nop 0
    buffer_load_dwordx4 v11, s[8:11], s51 offen lds
    s_add_u32 m0, s28, 4096
    s_nop 0
    buffer_load_dwordx4 v12, s[8:11], s51 offen lds
    s_waitcnt vmcnt(20)
    s_barrier
    ds_read_b64_tr_b16 v[84:85], v16 offset:40960
    ds_read_b64_tr_b16 v[86:87], v16 offset:61440
    ds_read_b64_tr_b16 v[88:89], v17 offset:40960
    ds_read_b64_tr_b16 v[90:91], v17 offset:61440
    ds_read_b64_tr_b16 v[92:93], v18 offset:40960
    ds_read_b64_tr_b16 v[94:95], v18 offset:61440
    ds_read_b64_tr_b16 v[96:97], v19 offset:40960
    ds_read_b64_tr_b16 v[98:99], v19 offset:61440
    ds_read_b64_tr_b16 v[100:101], v20 offset:40960
    ds_read_b64_tr_b16 v[102:103], v20 offset:61440
    s_waitcnt lgkmcnt(0)
    s_mul_i32 s26, s20, 74
    s_add_u32 s26, s26, s73
    s_mul_i32 s26, s26, 5120
    buffer_store_dwordx4 v[84:87], v2, s[16:19], s26 offen offset:0
    buffer_store_dwordx4 v[88:91], v2, s[16:19], s26 offen offset:1024
    buffer_store_dwordx4 v[92:95], v2, s[16:19], s26 offen offset:2048
    buffer_store_dwordx4 v[96:99], v2, s[16:19], s26 offen offset:3072
    s_add_u32 s26, s26, 4096
    buffer_store_dwordx4 v[100:103], v2, s[16:19], s26 offen offset:0
    s_waitcnt vmcnt(20)
    s_barrier
    ds_read_b64_tr_b16 v[64:65], v21 offset:0
    ds_read_b64_tr_b16 v[66:67], v21 offset:20480
    ds_read_b64_tr_b16 v[68:69], v22 offset:0
    ds_read_b64_tr_b16 v[70:71], v22 offset:20480
    ds_read_b64_tr_b16 v[72:73], v23 offset:0
    ds_read_b64_tr_b16 v[74:75], v23 offset:20480
    ds_read_b64_tr_b16 v[76:77], v24 offset:0
    ds_read_b64_tr_b16 v[78:79], v24 offset:20480
    ds_read_b64_tr_b16 v[80:81], v25 offset:0
    ds_read_b64_tr_b16 v[82:83], v25 offset:20480
    s_waitcnt lgkmcnt(0)
    s_mul_i32 s26, s20, 74
    s_add_u32 s26, s26, s74
    s_mul_i32 s26, s26, 5120
    buffer_store_dwordx4 v[64:67], v2, s[16:19], s26 offen offset:0
    buffer_store_dwordx4 v[68:71], v2, s[16:19], s26 offen offset:1024
    buffer_store_dwordx4 v[72:75], v2, s[16:19], s26 offen offset:2048
    buffer_store_dwordx4 v[76:79], v2, s[16:19], s26 offen offset:3072
    s_add_u32 s26, s26, 4096
    buffer_store_dwordx4 v[80:83], v2, s[16:19], s26 offen offset:0
    s_waitcnt vmcnt(20)
    s_barrier
    ds_read_b64_tr_b16 v[84:85], v21 offset:40960
    ds_read_b64_tr_b16 v[86:87], v21 offset:61440
    ds_read_b64_tr_b16 v[88:89], v22 offset:40960
    ds_read_b64_tr_b16 v[90:91], v22 offset:61440
    ds_read_b64_tr_b16 v[92:93], v23 offset:40960
    ds_read_b64_tr_b16 v[94:95], v23 offset:61440
    ds_read_b64_tr_b16 v[96:97], v24 offset:40960
    ds_read_b64_tr_b16 v[98:99], v24 offset:61440
    ds_read_b64_tr_b16 v[100:101], v25 offset:40960
    ds_read_b64_tr_b16 v[102:103], v25 offset:61440
    s_waitcnt lgkmcnt(0)
    s_mul_i32 s26, s20, 74
    s_add_u32 s26, s26, s75
    s_mul_i32 s26, s26, 5120
    buffer_store_dwordx4 v[84:87], v2, s[16:19], s26 offen offset:0
    buffer_store_dwordx4 v[88:91], v2, s[16:19], s26 offen offset:1024
    buffer_store_dwordx4 v[92:95], v2, s[16:19], s26 offen offset:2048
    buffer_store_dwordx4 v[96:99], v2, s[16:19], s26 offen offset:3072
    s_add_u32 s26, s26, 4096
    buffer_store_dwordx4 v[100:103], v2, s[16:19], s26 offen offset:0
    s_waitcnt vmcnt(15)
    s_barrier
    ds_read_b64_tr_b16 v[64:65], v16 offset:0
    ds_read_b64_tr_b16 v[66:67], v16 offset:20480
    ds_read_b64_tr_b16 v[68:69], v17 offset:0
    ds_read_b64_tr_b16 v[70:71], v17 offset:20480
    ds_read_b64_tr_b16 v[72:73], v18 offset:0
    ds_read_b64_tr_b16 v[74:75], v18 offset:20480
    ds_read_b64_tr_b16 v[76:77], v19 offset:0
    ds_read_b64_tr_b16 v[78:79], v19 offset:20480
    ds_read_b64_tr_b16 v[80:81], v20 offset:0
    ds_read_b64_tr_b16 v[82:83], v20 offset:20480
    s_waitcnt lgkmcnt(0)
    s_mul_i32 s26, s20, 74
    s_add_u32 s26, s26, s76
    s_mul_i32 s26, s26, 5120
    buffer_store_dwordx4 v[64:67], v2, s[16:19], s26 offen offset:0
    buffer_store_dwordx4 v[68:71], v2, s[16:19], s26 offen offset:1024
    buffer_store_dwordx4 v[72:75], v2, s[16:19], s26 offen offset:2048
    buffer_store_dwordx4 v[76:79], v2, s[16:19], s26 offen offset:3072
    s_add_u32 s26, s26, 4096
    buffer_store_dwordx4 v[80:83], v2, s[16:19], s26 offen offset:0
L_k1_end:
    s_endpgm
.section .rodata,"a"
.p2align 6
.amdhsa_kernel rs_g1_kernel
  .amdhsa_next_free_vgpr 256
  .amdhsa_next_free_sgpr 96
  .amdhsa_accum_offset 208
  .amdhsa_group_segment_fixed_size 0
  .amdhsa_kernarg_size 72
  .amdhsa_user_sgpr_count 2
  .amdhsa_user_sgpr_kernarg_segment_ptr 1
  .amdhsa_system_sgpr_workgroup_id_x 1
.end_amdhsa_kernel
.text
.globl rs_g2_kernel
.p2align 8
.type rs_g2_kernel,@function
rs_g2_kernel:
    s_cmp_ge_u32 s2, 256
    s_cbranch_scc1 L_k2_end
    s_load_dwordx2 s[4:5], s[0:1], 0
    s_load_dwordx2 s[6:7], s[0:1], 48
    s_load_dwordx2 s[60:61], s[0:1], 64
    v_lshrrev_b32 v1, 6, v0
    s_nop 0
    v_readfirstlane_b32 s20, v1
    v_and_b32 v1, 63, v0
    v_lshlrev_b32 v2, 4, v1
    v_add_u32 v3, 4096, v2
    s_and_b32 s3, s2, 7
    s_lshr_b32 s21, s2, 3
    s_lshr_b32 s22, s3, 1
    s_lshl_b32 s22, s22, 3
    s_and_b32 s23, s21, 7
    s_add_u32 s22, s22, s23
    s_and_b32 s23, s3, 1
    s_lshl_b32 s23, s23, 2
    s_lshr_b32 s24, s21, 3
    s_add_u32 s23, s23, s24
    s_mul_i32 s24, s20, 9
    s_add_u32 s24, s24, 2
    s_mul_i32 s25, s20, 10
    s_cmp_lt_u32 s20, 2
    s_cselect_b32 s24, s25, s24
    s_mul_i32 s25, s22, 74
    s_add_u32 s25, s25, s24
    s_lshl_b32 s25, s25, 12
    s_mul_i32 s26, s23, 74
    s_add_u32 s26, s26, s24
    s_mul_i32 s26, s26, 5120
    s_waitcnt lgkmcnt(0)
    s_add_u32 s8, s60, 0x400000
    s_addc_u32 s9, s61, 0
    s_and_b32 s9, s9, 0xffff
    s_mov_b32 s10, 0x940000
    s_mov_b32 s11, 0x00020000
    s_add_u32 s12, s60, 0x1000000
    s_addc_u32 s13, s61, 0
    s_and_b32 s13, s13, 0xffff
    s_mov_b32 s14, 0x2e4000
    s_mov_b32 s15, 0x00020000
    s_mov_b32 s16, s4
    s_and_b32 s17, s5, 0xffff
    s_mov_b32 s18, 0x280000
    s_mov_b32 s19, 0x00020000
    s_mov_b32 s28, s6
    s_and_b32 s29, s7, 0xffff
    s_mov_b32 s30, 0x280000
    s_mov_b32 s31, 0x00020000
    s_cmp_lt_u32 s20, 2
    s_cbranch_scc0 L_k2_w9
    buffer_load_dwordx4 v[32:35], v2, s[8:11], s25 offen offset:0
    buffer_load_dwordx4 v[36:39], v2, s[8:11], s25 offen offset:1024
    buffer_load_dwordx4 v[40:43], v2, s[8:11], s25 offen offset:2048
    buffer_load_dwordx4 v[44:47], v2, s[8:11], s25 offen offset:3072
    buffer_load_dwordx4 v[48:51], v2, s[12:15], s26 offen offset:0
    buffer_load_dwordx4 v[52:55], v2, s[12:15], s26 offen offset:1024
    buffer_load_dwordx4 v[56:59], v2, s[12:15], s26 offen offset:2048
    buffer_load_dwordx4 v[60:63], v2, s[12:15], s26 offen offset:3072
    buffer_load_dwordx4 v[64:67], v3, s[12:15], s26 offen
    s_add_u32 s25, s25, 4096
    s_add_u32 s26, s26, 5120
    buffer_load_dwordx4 v[68:71], v2, s[8:11], s25 offen offset:0
    buffer_load_dwordx4 v[72:75], v2, s[8:11], s25 offen offset:1024
    buffer_load_dwordx4 v[76:79], v2, s[8:11], s25 offen offset:2048
    buffer_load_dwordx4 v[80:83], v2, s[8:11], s25 offen offset:3072
    buffer_load_dwordx4 v[84:87], v2, s[12:15], s26 offen offset:0
    buffer_load_dwordx4 v[88:91], v2, s[12:15], s26 offen offset:1024
    buffer_load_dwordx4 v[92:95], v2, s[12:15], s26 offen offset:2048
    buffer_load_dwordx4 v[96:99], v2, s[12:15], s26 offen offset:3072
    buffer_load_dwordx4 v[100:103], v3, s[12:15], s26 offen
    s_add_u32 s25, s25, 4096
    s_add_u32 s26, s26, 5120
    buffer_load_dwordx4 v[104:107], v2, s[8:11], s25 offen offset:0
    buffer_load_dwordx4 v[108:111], v2, s[8:11], s25 offen offset:1024
    buffer_load_dwordx4 v[112:115], v2, s[8:11], s25 offen offset:2048
    buffer_load_dwordx4 v[116:119], v2, s[8:11], s25 offen offset:3072
    buffer_load_dwordx4 v[120:123], v2, s[12:15], s26 offen offset:0
    buffer_load_dwordx4 v[124:127], v2, s[12:15], s26 offen offset:1024
    buffer_load_dwordx4 v[128:131], v2, s[12:15], s26 offen offset:2048
    buffer_load_dwordx4 v[132:135], v2, s[12:15], s26 offen offset:3072
    buffer_load_dwordx4 v[136:139], v3, s[12:15], s26 offen
    s_add_u32 s25, s25, 4096
    s_add_u32 s26, s26, 5120
    buffer_load_dwordx4 v[140:143], v2, s[8:11], s25 offen offset:0
    buffer_load_dwordx4 v[144:147], v2, s[8:11], s25 offen offset:1024
    buffer_load_dwordx4 v[148:151], v2, s[8:11], s25 offen offset:2048
    buffer_load_dwordx4 v[152:155], v2, s[8:11], s25 offen offset:3072
    buffer_load_dwordx4 v[156:159], v2, s[12:15], s26 offen offset:0
    buffer_load_dwordx4 v[160:163], v2, s[12:15], s26 offen offset:1024
    buffer_load_dwordx4 v[164:167], v2, s[12:15], s26 offen offset:2048
    buffer_load_dwordx4 v[168:171], v2, s[12:15], s26 offen offset:3072
    buffer_load_dwordx4 v[172:175], v3, s[12:15], s26 offen
    s_add_u32 s25, s25, 4096
    s_add_u32 s26, s26, 5120
    s_mul_i32 s27, s22, 81920
    s_mul_i32 s32, s23, 160
    s_add_u32 s27, s27, s32
    v_add_u32 v4, 0, v0
    v_mul_u32_u24 v5, 3277, v4
    v_lshrrev_b32 v5, 16, v5
    v_mul_u32_u24 v6, 20, v5
    v_sub_u32 v6, v4, v6
    v_mul_u32_u24 v7, 1280, v5
    v_lshl_add_u32 v7, v6, 3, v7
    v_add_u32 v14, s27, v7
    v_mul_u32_u24 v7, 320, v5
    v_lshl_add_u32 v17, v6, 4, v7
    buffer_load_dwordx2 v[8:9], v14, s[16:19], 0 offen
    v_add_u32 v4, 512, v0
    v_mul_u32_u24 v5, 3277, v4
    v_lshrrev_b32 v5, 16, v5
    v_mul_u32_u24 v6, 20, v5
    v_sub_u32 v6, v4, v6
    v_mul_u32_u24 v7, 1280, v5
    v_lshl_add_u32 v7, v6, 3, v7
    v_add_u32 v15, s27, v7
    v_mul_u32_u24 v7, 320, v5
    v_lshl_add_u32 v18, v6, 4, v7
    buffer_load_dwordx2 v[10:11], v15, s[16:19], 0 offen
    v_add_u32 v4, 1024, v0
    v_min_u32 v4, 1279, v4
    v_mul_u32_u24 v5, 3277, v4
    v_lshrrev_b32 v5, 16, v5
    v_mul_u32_u24 v6, 20, v5
    v_sub_u32 v6, v4, v6
    v_mul_u32_u24 v7, 1280, v5
    v_lshl_add_u32 v7, v6, 3, v7
    v_add_u32 v16, s27, v7
    v_mul_u32_u24 v7, 320, v5
    v_lshl_add_u32 v19, v6, 4, v7
    buffer_load_dwordx2 v[12:13], v16, s[16:19], 0 offen
    s_waitcnt vmcnt(30)
    v_mfma_f32_16x16x32_bf16 a[0:3], v[48:51], v[32:35], 0
    v_mfma_f32_16x16x32_bf16 a[4:7], v[48:51], v[36:39], 0
    v_mfma_f32_16x16x32_bf16 a[8:11], v[48:51], v[40:43], 0
    v_mfma_f32_16x16x32_bf16 a[12:15], v[48:51], v[44:47], 0
    v_mfma_f32_16x16x32_bf16 a[16:19], v[52:55], v[32:35], 0
    v_mfma_f32_16x16x32_bf16 a[20:23], v[52:55], v[36:39], 0
    v_mfma_f32_16x16x32_bf16 a[24:27], v[52:55], v[40:43], 0
    v_mfma_f32_16x16x32_bf16 a[28:31], v[52:55], v[44:47], 0
    v_mfma_f32_16x16x32_bf16 a[32:35], v[56:59], v[32:35], 0
    v_mfma_f32_16x16x32_bf16 a[36:39], v[56:59], v[36:39], 0
    v_mfma_f32_16x16x32_bf16 a[40:43], v[56:59], v[40:43], 0
    v_mfma_f32_16x16x32_bf16 a[44:47], v[56:59], v[44:47], 0
    v_mfma_f32_16x16x32_bf16 a[48:51], v[60:63], v[32:35], 0
    v_mfma_f32_16x16x32_bf16 a[52:55], v[60:63], v[36:39], 0
    v_mfma_f32_16x16x32_bf16 a[56:59], v[60:63], v[40:43], 0
    v_mfma_f32_16x16x32_bf16 a[60:63], v[60:63], v[44:47], 0
    v_mfma_f32_16x16x32_bf16 a[64:67], v[64:67], v[32:35], 0
    v_mfma_f32_16x16x32_bf16 a[68:71], v[64:67], v[36:39], 0
    v_mfma_f32_16x16x32_bf16 a[72:75], v[64:67], v[40:43], 0
    v_mfma_f32_16x16x32_bf16 a[76:79], v[64:67], v[44:47], 0
    buffer_load_dwordx4 v[32:35], v2, s[8:11], s25 offen offset:0
    buffer_load_dwordx4 v[36:39], v2, s[8:11], s25 offen offset:1024
    buffer_load_dwordx4 v[40:43], v2, s[8:11], s25 offen offset:2048
    buffer_load_dwordx4 v[44:47], v2, s[8:11], s25 offen offset:3072
    buffer_load_dwordx4 v[48:51], v2, s[12:15], s26 offen offset:0
    buffer_load_dwordx4 v[52:55], v2, s[12:15], s26 offen offset:1024
    buffer_load_dwordx4 v[56:59], v2, s[12:15], s26 offen offset:2048
    buffer_load_dwordx4 v[60:63], v2, s[12:15], s26 offen offset:3072
    buffer_load_dwordx4 v[64:67], v3, s[12:15], s26 offen
    s_add_u32 s25, s25, 4096
    s_add_u32 s26, s26, 5120
    s_waitcnt vmcnt(30)
    v_mfma_f32_16x16x32_bf16 a[0:3], v[84:87], v[68:71], a[0:3]
    v_mfma_f32_16x16x32_bf16 a[4:7], v[84:87], v[72:75], a[4:7]
    v_mfma_f32_16x16x32_bf16 a[8:11], v[84:87], v[76:79], a[8:11]
    v_mfma_f32_16x16x32_bf16 a[12:15], v[84:87], v[80:83], a[12:15]
    v_mfma_f32_16x16x32_bf16 a[16:19], v[88:91], v[68:71], a[16:19]
    v_mfma_f32_16x16x32_bf16 a[20:23], v[88:91], v[72:75], a[20:23]
    v_mfma_f32_16x16x32_bf16 a[24:27], v[88:91], v[76:79], a[24:27]
    v_mfma_f32_16x16x32_bf16 a[28:31], v[88:91], v[80:83], a[28:31]
    v_mfma_f32_16x16x32_bf16 a[32:35], v[92:95], v[68:71], a[32:35]
    v_mfma_f32_16x16x32_bf16 a[36:39], v[92:95], v[72:75], a[36:39]
    v_mfma_f32_16x16x32_bf16 a[40:43], v[92:95], v[76:79], a[40:43]
    v_mfma_f32_16x16x32_bf16 a[44:47], v[92:95], v[80:83], a[44:47]
    v_mfma_f32_16x16x32_bf16 a[48:51], v[96:99], v[68:71], a[48:51]
    v_mfma_f32_16x16x32_bf16 a[52:55], v[96:99], v[72:75], a[52:55]
    v_mfma_f32_16x16x32_bf16 a[56:59], v[96:99], v[76:79], a[56:59]
    v_mfma_f32_16x16x32_bf16 a[60:63], v[96:99], v[80:83], a[60:63]
    v_mfma_f32_16x16x32_bf16 a[64:67], v[100:103], v[68:71], a[64:67]
    v_mfma_f32_16x16x32_bf16 a[68:71], v[100:103], v[72:75], a[68:71]
    v_mfma_f32_16x16x32_bf16 a[72:75], v[100:103], v[76:79], a[72:75]
    v_mfma_f32_16x16x32_bf16 a[76:79], v[100:103], v[80:83], a[76:79]
    buffer_load_dwordx4 v[68:71], v2, s[8:11], s25 offen offset:0
    buffer_load_dwordx4 v[72:75], v2, s[8:11], s25 offen offset:1024
    buffer_load_dwordx4 v[76:79], v2, s[8:11], s25 offen offset:2048
    buffer_load_dwordx4 v[80:83], v2, s[8:11], s25 offen offset:3072
    buffer_load_dwordx4 v[84:87], v2, s[12:15], s26 offen offset:0
    buffer_load_dwordx4 v[88:91], v2, s[12:15], s26 offen offset:1024
    buffer_load_dwordx4 v[92:95], v2, s[12:15], s26 offen offset:2048
    buffer_load_dwordx4 v[96:99], v2, s[12:15], s26 offen offset:3072
    buffer_load_dwordx4 v[100:103], v3, s[12:15], s26 offen
    s_add_u32 s25, s25, 4096
    s_add_u32 s26, s26, 5120
    s_waitcnt vmcnt(30)
    v_mfma_f32_16x16x32_bf16 a[0:3], v[120:123], v[104:107], a[0:3]
    v_mfma_f32_16x16x32_bf16 a[4:7], v[120:123], v[108:111], a[4:7]
    v_mfma_f32_16x16x32_bf16 a[8:11], v[120:123], v[112:115], a[8:11]
    v_mfma_f32_16x16x32_bf16 a[12:15], v[120:123], v[116:119], a[12:15]
    v_mfma_f32_16x16x32_bf16 a[16:19], v[124:127], v[104:107], a[16:19]
    v_mfma_f32_16x16x32_bf16 a[20:23], v[124:127], v[108:111], a[20:23]
    v_mfma_f32_16x16x32_bf16 a[24:27], v[124:127], v[112:115], a[24:27]
    v_mfma_f32_16x16x32_bf16 a[28:31], v[124:127], v[116:119], a[28:31]
    v_mfma_f32_16x16x32_bf16 a[32:35], v[128:131], v[104:107], a[32:35]
    v_mfma_f32_16x16x32_bf16 a[36:39], v[128:131], v[108:111], a[36:39]
    v_mfma_f32_16x16x32_bf16 a[40:43], v[128:131], v[112:115], a[40:43]
    v_mfma_f32_16x16x32_bf16 a[44:47], v[128:131], v[116:119], a[44:47]
    v_mfma_f32_16x16x32_bf16 a[48:51], v[132:135], v[104:107], a[48:51]
    v_mfma_f32_16x16x32_bf16 a[52:55], v[132:135], v[108:111], a[52:55]
    v_mfma_f32_16x16x32_bf16 a[56:59], v[132:135], v[112:115], a[56:59]
    v_mfma_f32_16x16x32_bf16 a[60:63], v[132:135], v[116:119], a[60:63]
    v_mfma_f32_16x16x32_bf16 a[64:67], v[136:139], v[104:107], a[64:67]
    v_mfma_f32_16x16x32_bf16 a[68:71], v[136:139], v[108:111], a[68:71]
    v_mfma_f32_16x16x32_bf16 a[72:75], v[136:139], v[112:115], a[72:75]
    v_mfma_f32_16x16x32_bf16 a[76:79], v[136:139], v[116:119], a[76:79]
    buffer_load_dwordx4 v[104:107], v2, s[8:11], s25 offen offset:0
    buffer_load_dwordx4 v[108:111], v2, s[8:11], s25 offen offset:1024
    buffer_load_dwordx4 v[112:115], v2, s[8:11], s25 offen offset:2048
    buffer_load_dwordx4 v[116:119], v2, s[8:11], s25 offen offset:3072
    buffer_load_dwordx4 v[120:123], v2, s[12:15], s26 offen offset:0
    buffer_load_dwordx4 v[124:127], v2, s[12:15], s26 offen offset:1024
    buffer_load_dwordx4 v[128:131], v2, s[12:15], s26 offen offset:2048
    buffer_load_dwordx4 v[132:135], v2, s[12:15], s26 offen offset:3072
    buffer_load_dwordx4 v[136:139], v3, s[12:15], s26 offen
    s_add_u32 s25, s25, 4096
    s_add_u32 s26, s26, 5120
    s_waitcnt vmcnt(30)
    v_mfma_f32_16x16x32_bf16 a[0:3], v[156:159], v[140:143], a[0:3]
    v_mfma_f32_16x16x32_bf16 a[4:7], v[156:159], v[144:147], a[4:7]
    v_mfma_f32_16x16x32_bf16 a[8:11], v[156:159], v[148:151], a[8:11]
    v_mfma_f32_16x16x32_bf16 a[12:15], v[156:159], v[152:155], a[12:15]
    v_mfma_f32_16x16x32_bf16 a[16:19], v[160:163], v[140:143], a[16:19]
    v_mfma_f32_16x16x32_bf16 a[20:23], v[160:163], v[144:147], a[20:23]
    v_mfma_f32_16x16x32_bf16 a[24:27], v[160:163], v[148:151], a[24:27]
    v_mfma_f32_16x16x32_bf16 a[28:31], v[160:163], v[152:155], a[28:31]
    v_mfma_f32_16x16x32_bf16 a[32:35], v[164:167], v[140:143], a[32:35]
    v_mfma_f32_16x16x32_bf16 a[36:39], v[164:167], v[144:147], a[36:39]
    v_mfma_f32_16x16x32_bf16 a[40:43], v[164:167], v[148:151], a[40:43]
    v_mfma_f32_16x16x32_bf16 a[44:47], v[164:167], v[152:155], a[44:47]
    v_mfma_f32_16x16x32_bf16 a[48:51], v[168:171], v[140:143], a[48:51]
    v_mfma_f32_16x16x32_bf16 a[52:55], v[168:171], v[144:147], a[52:55]
    v_mfma_f32_16x16x32_bf16 a[56:59], v[168:171], v[148:151], a[56:59]
    v_mfma_f32_16x16x32_bf16 a[60:63], v[168:171], v[152:155], a[60:63]
    v_mfma_f32_16x16x32_bf16 a[64:67], v[172:175], v[140:143], a[64:67]
    v_mfma_f32_16x16x32_bf16 a[68:71], v[172:175], v[144:147], a[68:71]
    v_mfma_f32_16x16x32_bf16 a[72:75], v[172:175], v[148:151], a[72:75]
    v_mfma_f32_16x16x32_bf16 a[76:79], v[172:175], v[152:155], a[76:79]
    buffer_load_dwordx4 v[140:143], v2, s[8:11], s25 offen offset:0
    buffer_load_dwordx4 v[144:147], v2, s[8:11], s25 offen offset:1024
    buffer_load_dwordx4 v[148:151], v2, s[8:11], s25 offen offset:2048
    buffer_load_dwordx4 v[152:155], v2, s[8:11], s25 offen offset:3072
    buffer_load_dwordx4 v[156:159], v2, s[12:15], s26 offen offset:0
    buffer_load_dwordx4 v[160:163], v2, s[12:15], s26 offen offset:1024
    buffer_load_dwordx4 v[164:167], v2, s[12:15], s26 offen offset:2048
    buffer_load_dwordx4 v[168:171], v2, s[12:15], s26 offen offset:3072
    buffer_load_dwordx4 v[172:175], v3, s[12:15], s26 offen
    s_add_u32 s25, s25, 4096
    s_add_u32 s26, s26, 5120
    s_waitcnt vmcnt(27)
    v_mfma_f32_16x16x32_bf16 a[0:3], v[48:51], v[32:35], a[0:3]
    v_mfma_f32_16x16x32_bf16 a[4:7], v[48:51], v[36:39], a[4:7]
    v_mfma_f32_16x16x32_bf16 a[8:11], v[48:51], v[40:43], a[8:11]
    v_mfma_f32_16x16x32_bf16 a[12:15], v[48:51], v[44:47], a[12:15]
    v_mfma_f32_16x16x32_bf16 a[16:19], v[52:55], v[32:35], a[16:19]
    v_mfma_f32_16x16x32_bf16 a[20:23], v[52:55], v[36:39], a[20:23]
    v_mfma_f32_16x16x32_bf16 a[24:27], v[52:55], v[40:43], a[24:27]
    v_mfma_f32_16x16x32_bf16 a[28:31], v[52:55], v[44:47], a[28:31]
    v_mfma_f32_16x16x32_bf16 a[32:35], v[56:59], v[32:35], a[32:35]
    v_mfma_f32_16x16x32_bf16 a[36:39], v[56:59], v[36:39], a[36:39]
    v_mfma_f32_16x16x32_bf16 a[40:43], v[56:59], v[40:43], a[40:43]
    v_mfma_f32_16x16x32_bf16 a[44:47], v[56:59], v[44:47], a[44:47]
    v_mfma_f32_16x16x32_bf16 a[48:51], v[60:63], v[32:35], a[48:51]
    v_mfma_f32_16x16x32_bf16 a[52:55], v[60:63], v[36:39], a[52:55]
    v_mfma_f32_16x16x32_bf16 a[56:59], v[60:63], v[40:43], a[56:59]
    v_mfma_f32_16x16x32_bf16 a[60:63], v[60:63], v[44:47], a[60:63]
    v_mfma_f32_16x16x32_bf16 a[64:67], v[64:67], v[32:35], a[64:67]
    v_mfma_f32_16x16x32_bf16 a[68:71], v[64:67], v[36:39], a[68:71]
    v_mfma_f32_16x16x32_bf16 a[72:75], v[64:67], v[40:43], a[72:75]
    v_mfma_f32_16x16x32_bf16 a[76:79], v[64:67], v[44:47], a[76:79]
    buffer_load_dwordx4 v[32:35], v2, s[8:11], s25 offen offset:0
    buffer_load_dwordx4 v[36:39], v2, s[8:11], s25 offen offset:1024
    buffer_load_dwordx4 v[40:43], v2, s[8:11], s25 offen offset:2048
    buffer_load_dwordx4 v[44:47], v2, s[8:11], s25 offen offset:3072
    buffer_load_dwordx4 v[48:51], v2, s[12:15], s26 offen offset:0
    buffer_load_dwordx4 v[52:55], v2, s[12:15], s26 offen offset:1024
    buffer_load_dwordx4 v[56:59], v2, s[12:15], s26 offen offset:2048
    buffer_load_dwordx4 v[60:63], v2, s[12:15], s26 offen offset:3072
    buffer_load_dwordx4 v[64:67], v3, s[12:15], s26 offen
    s_add_u32 s25, s25, 4096
    s_add_u32 s26, s26, 5120
    s_waitcnt vmcnt(27)
    v_mfma_f32_16x16x32_bf16 a[0:3], v[84:87], v[68:71], a[0:3]
    v_mfma_f32_16x16x32_bf16 a[4:7], v[84:87], v[72:75], a[4:7]
    v_mfma_f32_16x16x32_bf16 a[8:11], v[84:87], v[76:79], a[8:11]
    v_mfma_f32_16x16x32_bf16 a[12:15], v[84:87], v[80:83], a[12:15]
    v_mfma_f32_16x16x32_bf16 a[16:19], v[88:91], v[68:71], a[16:19]
    v_mfma_f32_16x16x32_bf16 a[20:23], v[88:91], v[72:75], a[20:23]
    v_mfma_f32_16x16x32_bf16 a[24:27], v[88:91], v[76:79], a[24:27]
    v_mfma_f32_16x16x32_bf16 a[28:31], v[88:91], v[80:83], a[28:31]
    v_mfma_f32_16x16x32_bf16 a[32:35], v[92:95], v[68:71], a[32:35]
    v_mfma_f32_16x16x32_bf16 a[36:39], v[92:95], v[72:75], a[36:39]
    v_mfma_f32_16x16x32_bf16 a[40:43], v[92:95], v[76:79], a[40:43]
    v_mfma_f32_16x16x32_bf16 a[44:47], v[92:95], v[80:83], a[44:47]
    v_mfma_f32_16x16x32_bf16 a[48:51], v[96:99], v[68:71], a[48:51]
    v_mfma_f32_16x16x32_bf16 a[52:55], v[96:99], v[72:75], a[52:55]
    v_mfma_f32_16x16x32_bf16 a[56:59], v[96:99], v[76:79], a[56:59]
    v_mfma_f32_16x16x32_bf16 a[60:63], v[96:99], v[80:83], a[60:63]
    v_mfma_f32_16x16x32_bf16 a[64:67], v[100:103], v[68:71], a[64:67]
    v_mfma_f32_16x16x32_bf16 a[68:71], v[100:103], v[72:75], a[68:71]
    v_mfma_f32_16x16x32_bf16 a[72:75], v[100:103], v[76:79], a[72:75]
    v_mfma_f32_16x16x32_bf16 a[76:79], v[100:103], v[80:83], a[76:79]
    buffer_load_dwordx4 v[68:71], v2, s[8:11], s25 offen offset:0
    buffer_load_dwordx4 v[72:75], v2, s[8:11], s25 offen offset:1024
    buffer_load_dwordx4 v[76:79], v2, s[8:11], s25 offen offset:2048
    buffer_load_dwordx4 v[80:83], v2, s[8:11], s25 offen offset:3072
    buffer_load_dwordx4 v[84:87], v2, s[12:15], s26 offen offset:0
    buffer_load_dwordx4 v[88:91], v2, s[12:15], s26 offen offset:1024
    buffer_load_dwordx4 v[92:95], v2, s[12:15], s26 offen offset:2048
    buffer_load_dwordx4 v[96:99], v2, s[12:15], s26 offen offset:3072
    buffer_load_dwordx4 v[100:103], v3, s[12:15], s26 offen
    s_add_u32 s25, s25, 4096
    s_add_u32 s26, s26, 5120
    s_waitcnt vmcnt(27)
    v_mfma_f32_16x16x32_bf16 a[0:3], v[120:123], v[104:107], a[0:3]
    v_mfma_f32_16x16x32_bf16 a[4:7], v[120:123], v[108:111], a[4:7]
    v_mfma_f32_16x16x32_bf16 a[8:11], v[120:123], v[112:115], a[8:11]
    v_mfma_f32_16x16x32_bf16 a[12:15], v[120:123], v[116:119], a[12:15]
    v_mfma_f32_16x16x32_bf16 a[16:19], v[124:127], v[104:107], a[16:19]
    v_mfma_f32_16x16x32_bf16 a[20:23], v[124:127], v[108:111], a[20:23]
    v_mfma_f32_16x16x32_bf16 a[24:27], v[124:127], v[112:115], a[24:27]
    v_mfma_f32_16x16x32_bf16 a[28:31], v[124:127], v[116:119], a[28:31]
    v_mfma_f32_16x16x32_bf16 a[32:35], v[128:131], v[104:107], a[32:35]
    v_mfma_f32_16x16x32_bf16 a[36:39], v[128:131], v[108:111], a[36:39]
    v_mfma_f32_16x16x32_bf16 a[40:43], v[128:131], v[112:115], a[40:43]
    v_mfma_f32_16x16x32_bf16 a[44:47], v[128:131], v[116:119], a[44:47]
    v_mfma_f32_16x16x32_bf16 a[48:51], v[132:135], v[104:107], a[48:51]
    v_mfma_f32_16x16x32_bf16 a[52:55], v[132:135], v[108:111], a[52:55]
    v_mfma_f32_16x16x32_bf16 a[56:59], v[132:135], v[112:115], a[56:59]
    v_mfma_f32_16x16x32_bf16 a[60:63], v[132:135], v[116:119], a[60:63]
    v_mfma_f32_16x16x32_bf16 a[64:67], v[136:139], v[104:107], a[64:67]
    v_mfma_f32_16x16x32_bf16 a[68:71], v[136:139], v[108:111], a[68:71]
    v_mfma_f32_16x16x32_bf16 a[72:75], v[136:139], v[112:115], a[72:75]
    v_mfma_f32_16x16x32_bf16 a[76:79], v[136:139], v[116:119], a[76:79]
    s_waitcnt vmcnt(18)
    v_mfma_f32_16x16x32_bf16 a[0:3], v[156:159], v[140:143], a[0:3]
    v_mfma_f32_16x16x32_bf16 a[4:7], v[156:159], v[144:147], a[4:7]
    v_mfma_f32_16x16x32_bf16 a[8:11], v[156:159], v[148:151], a[8:11]
    v_mfma_f32_16x16x32_bf16 a[12:15], v[156:159], v[152:155], a[12:15]
    v_mfma_f32_16x16x32_bf16 a[16:19], v[160:163], v[140:143], a[16:19]
    v_mfma_f32_16x16x32_bf16 a[20:23], v[160:163], v[144:147], a[20:23]
    v_mfma_f32_16x16x32_bf16 a[24:27], v[160:163], v[148:151], a[24:27]
    v_mfma_f32_16x16x32_bf16 a[28:31], v[160:163], v[152:155], a[28:31]
    v_mfma_f32_16x16x32_bf16 a[32:35], v[164:167], v[140:143], a[32:35]
    v_mfma_f32_16x16x32_bf16 a[36:39], v[164:167], v[144:147], a[36:39]
    v_mfma_f32_16x16x32_bf16 a[40:43], v[164:167], v[148:151], a[40:43]
    v_mfma_f32_16x16x32_bf16 a[44:47], v[164:167], v[152:155], a[44:47]
    v_mfma_f32_16x16x32_bf16 a[48:51], v[168:171], v[140:143], a[48:51]
    v_mfma_f32_16x16x32_bf16 a[52:55], v[168:171], v[144:147], a[52:55]
    v_mfma_f32_16x16x32_bf16 a[56:59], v[168:171], v[148:151], a[56:59]
    v_mfma_f32_16x16x32_bf16 a[60:63], v[168:171], v[152:155], a[60:63]
    v_mfma_f32_16x16x32_bf16 a[64:67], v[172:175], v[140:143], a[64:67]
    v_mfma_f32_16x16x32_bf16 a[68:71], v[172:175], v[144:147], a[68:71]
    v_mfma_f32_16x16x32_bf16 a[72:75], v[172:175], v[148:151], a[72:75]
    v_mfma_f32_16x16x32_bf16 a[76:79], v[172:175], v[152:155], a[76:79]
    s_waitcnt vmcnt(9)
    v_mfma_f32_16x16x32_bf16 a[0:3], v[48:51], v[32:35], a[0:3]
    v_mfma_f32_16x16x32_bf16 a[4:7], v[48:51], v[36:39], a[4:7]
    v_mfma_f32_16x16x32_bf16 a[8:11], v[48:51], v[40:43], a[8:11]
    v_mfma_f32_16x16x32_bf16 a[12:15], v[48:51], v[44:47], a[12:15]
    v_mfma_f32_16x16x32_bf16 a[16:19], v[52:55], v[32:35], a[16:19]
    v_mfma_f32_16x16x32_bf16 a[20:23], v[52:55], v[36:39], a[20:23]
    v_mfma_f32_16x16x32_bf16 a[24:27], v[52:55], v[40:43], a[24:27]
    v_mfma_f32_16x16x32_bf16 a[28:31], v[52:55], v[44:47], a[28:31]
    v_mfma_f32_16x16x32_bf16 a[32:35], v[56:59], v[32:35], a[32:35]
    v_mfma_f32_16x16x32_bf16 a[36:39], v[56:59], v[36:39], a[36:39]
    v_mfma_f32_16x16x32_bf16 a[40:43], v[56:59], v[40:43], a[40:43]
    v_mfma_f32_16x16x32_bf16 a[44:47], v[56:59], v[44:47], a[44:47]
    v_mfma_f32_16x16x32_bf16 a[48:51], v[60:63], v[32:35], a[48:51]
    v_mfma_f32_16x16x32_bf16 a[52:55], v[60:63], v[36:39], a[52:55]
    v_mfma_f32_16x16x32_bf16 a[56:59], v[60:63], v[40:43], a[56:59]
    v_mfma_f32_16x16x32_bf16 a[60:63], v[60:63], v[44:47], a[60:63]
    v_mfma_f32_16x16x32_bf16 a[64:67], v[64:67], v[32:35], a[64:67]
    v_mfma_f32_16x16x32_bf16 a[68:71], v[64:67], v[36:39], a[68:71]
    v_mfma_f32_16x16x32_bf16 a[72:75], v[64:67], v[40:43], a[72:75]
    v_mfma_f32_16x16x32_bf16 a[76:79], v[64:67], v[44:47], a[76:79]
    s_waitcnt vmcnt(0)
    v_mfma_f32_16x16x32_bf16 a[0:3], v[84:87], v[68:71], a[0:3]
    v_mfma_f32_16x16x32_bf16 a[4:7], v[84:87], v[72:75], a[4:7]
    v_mfma_f32_16x16x32_bf16 a[8:11], v[84:87], v[76:79], a[8:11]
    v_mfma_f32_16x16x32_bf16 a[12:15], v[84:87], v[80:83], a[12:15]
    v_mfma_f32_16x16x32_bf16 a[16:19], v[88:91], v[68:71], a[16:19]
    v_mfma_f32_16x16x32_bf16 a[20:23], v[88:91], v[72:75], a[20:23]
    v_mfma_f32_16x16x32_bf16 a[24:27], v[88:91], v[76:79], a[24:27]
    v_mfma_f32_16x16x32_bf16 a[28:31], v[88:91], v[80:83], a[28:31]
    v_mfma_f32_16x16x32_bf16 a[32:35], v[92:95], v[68:71], a[32:35]
    v_mfma_f32_16x16x32_bf16 a[36:39], v[92:95], v[72:75], a[36:39]
    v_mfma_f32_16x16x32_bf16 a[40:43], v[92:95], v[76:79], a[40:43]
    v_mfma_f32_16x16x32_bf16 a[44:47], v[92:95], v[80:83], a[44:47]
    v_mfma_f32_16x16x32_bf16 a[48:51], v[96:99], v[68:71], a[48:51]
    v_mfma_f32_16x16x32_bf16 a[52:55], v[96:99], v[72:75], a[52:55]
    v_mfma_f32_16x16x32_bf16 a[56:59], v[96:99], v[76:79], a[56:59]
    v_mfma_f32_16x16x32_bf16 a[60:63], v[96:99], v[80:83], a[60:63]
    v_mfma_f32_16x16x32_bf16 a[64:67], v[100:103], v[68:71], a[64:67]
    v_mfma_f32_16x16x32_bf16 a[68:71], v[100:103], v[72:75], a[68:71]
    v_mfma_f32_16x16x32_bf16 a[72:75], v[100:103], v[76:79], a[72:75]
    v_mfma_f32_16x16x32_bf16 a[76:79], v[100:103], v[80:83], a[76:79]
    s_branch L_k2_epi
L_k2_w9:
    buffer_load_dwordx4 v[32:35], v2, s[8:11], s25 offen offset:0
    buffer_load_dwordx4 v[36:39], v2, s[8:11], s25 offen offset:1024
    buffer_load_dwordx4 v[40:43], v2, s[8:11], s25 offen offset:2048
    buffer_load_dwordx4 v[44:47], v2, s[8:11], s25 offen offset:3072
    buffer_load_dwordx4 v[48:51], v2, s[12:15], s26 offen offset:0
    buffer_load_dwordx4 v[52:55], v2, s[12:15], s26 offen offset:1024
    buffer_load_dwordx4 v[56:59], v2, s[12:15], s26 offen offset:2048
    buffer_load_dwordx4 v[60:63], v2, s[12:15], s26 offen offset:3072
    buffer_load_dwordx4 v[64:67], v3, s[12:15], s26 offen
    s_add_u32 s25, s25, 4096
    s_add_u32 s26, s26, 5120
    buffer_load_dwordx4 v[68:71], v2, s[8:11], s25 offen offset:0
    buffer_load_dwordx4 v[72:75], v2, s[8:11], s25 offen offset:1024
    buffer_load_dwordx4 v[76:79], v2, s[8:11], s25 offen offset:2048
    buffer_load_dwordx4 v[80:83], v2, s[8:11], s25 offen offset:3072
    buffer_load_dwordx4 v[84:87], v2, s[12:15], s26 offen offset:0
    buffer_load_dwordx4 v[88:91], v2, s[12:15], s26 offen offset:1024
    buffer_load_dwordx4 v[92:95], v2, s[12:15], s26 offen offset:2048
    buffer_load_dwordx4 v[96:99], v2, s[12:15], s26 offen offset:3072
    buffer_load_dwordx4 v[100:103], v3, s[12:15], s26 offen
    s_add_u32 s25, s25, 4096
    s_add_u32 s26, s26, 5120
    buffer_load_dwordx4 v[104:107], v2, s[8:11], s25 offen offset:0
    buffer_load_dwordx4 v[108:111], v2, s[8:11], s25 offen offset:1024
    buffer_load_dwordx4 v[112:115], v2, s[8:11], s25 offen offset:2048
    buffer_load_dwordx4 v[116:119], v2, s[8:11], s25 offen offset:3072
    buffer_load_dwordx4 v[120:123], v2, s[12:15], s26 offen offset:0
    buffer_load_dwordx4 v[124:127], v2, s[12:15], s26 offen offset:1024
    buffer_load_dwordx4 v[128:131], v2, s[12:15], s26 offen offset:2048
    buffer_load_dwordx4 v[132:135], v2, s[12:15], s26 offen offset:3072
    buffer_load_dwordx4 v[136:139], v3, s[12:15], s26 offen
    s_add_u32 s25, s25, 4096
    s_add_u32 s26, s26, 5120
    buffer_load_dwordx4 v[140:143], v2, s[8:11], s25 offen offset:0
    buffer_load_dwordx4 v[144:147], v2, s[8:11], s25 offen offset:1024
    buffer_load_dwordx4 v[148:151], v2, s[8:11], s25 offen offset:2048
    buffer_load_dwordx4 v[152:155], v2, s[8:11], s25 offen offset:3072
    buffer_load_dwordx4 v[156:159], v2, s[12:15], s26 offen offset:0
    buffer_load_dwordx4 v[160:163], v2, s[12:15], s26 offen offset:1024
    buffer_load_dwordx4 v[164:167], v2, s[12:15], s26 offen offset:2048
    buffer_load_dwordx4 v[168:171], v2, s[12:15], s26 offen offset:3072
    buffer_load_dwordx4 v[172:175], v3, s[12:15], s26 offen
    s_add_u32 s25, s25, 4096
    s_add_u32 s26, s26, 5120
    s_mul_i32 s27, s22, 81920
    s_mul_i32 s32, s23, 160
    s_add_u32 s27, s27, s32
    v_add_u32 v4, 0, v0
    v_mul_u32_u24 v5, 3277, v4
    v_lshrrev_b32 v5, 16, v5
    v_mul_u32_u24 v6, 20, v5
    v_sub_u32 v6, v4, v6
    v_mul_u32_u24 v7, 1280, v5
    v_lshl_add_u32 v7, v6, 3, v7
    v_add_u32 v14, s27, v7
    v_mul_u32_u24 v7, 320, v5
    v_lshl_add_u32 v17, v6, 4, v7
    buffer_load_dwordx2 v[8:9], v14, s[16:19], 0 offen
    v_add_u32 v4, 512, v0
    v_mul_u32_u24 v5, 3277, v4
    v_lshrrev_b32 v5, 16, v5
    v_mul_u32_u24 v6, 20, v5
    v_sub_u32 v6, v4, v6
    v_mul_u32_u24 v7, 1280, v5
    v_lshl_add_u32 v7, v6, 3, v7
    v_add_u32 v15, s27, v7
    v_mul_u32_u24 v7, 320, v5
    v_lshl_add_u32 v18, v6, 4, v7
    buffer_load_dwordx2 v[10:11], v15, s[16:19], 0 offen
    v_add_u32 v4, 1024, v0
    v_min_u32 v4, 1279, v4
    v_mul_u32_u24 v5, 3277, v4
    v_lshrrev_b32 v5, 16, v5
    v_mul_u32_u24 v6, 20, v5
    v_sub_u32 v6, v4, v6
    v_mul_u32_u24 v7, 1280, v5
    v_lshl_add_u32 v7, v6, 3, v7
    v_add_u32 v16, s27, v7
    v_mul_u32_u24 v7, 320, v5
    v_lshl_add_u32 v19, v6, 4, v7
    buffer_load_dwordx2 v[12:13], v16, s[16:19], 0 offen
    s_waitcnt vmcnt(30)
    v_mfma_f32_16x16x32_bf16 a[0:3], v[48:51], v[32:35], 0
    v_mfma_f32_16x16x32_bf16 a[4:7], v[48:51], v[36:39], 0
    v_mfma_f32_16x16x32_bf16 a[8:11], v[48:51], v[40:43], 0
    v_mfma_f32_16x16x32_bf16 a[12:15], v[48:51], v[44:47], 0
    v_mfma_f32_16x16x32_bf16 a[16:19], v[52:55], v[32:35], 0
    v_mfma_f32_16x16x32_bf16 a[20:23], v[52:55], v[36:39], 0
    v_mfma_f32_16x16x32_bf16 a[24:27], v[52:55], v[40:43], 0
    v_mfma_f32_16x16x32_bf16 a[28:31], v[52:55], v[44:47], 0
    v_mfma_f32_16x16x32_bf16 a[32:35], v[56:59], v[32:35], 0
    v_mfma_f32_16x16x32_bf16 a[36:39], v[56:59], v[36:39], 0
    v_mfma_f32_16x16x32_bf16 a[40:43], v[56:59], v[40:43], 0
    v_mfma_f32_16x16x32_bf16 a[44:47], v[56:59], v[44:47], 0
    v_mfma_f32_16x16x32_bf16 a[48:51], v[60:63], v[32:35], 0
    v_mfma_f32_16x16x32_bf16 a[52:55], v[60:63], v[36:39], 0
    v_mfma_f32_16x16x32_bf16 a[56:59], v[60:63], v[40:43], 0
    v_mfma_f32_16x16x32_bf16 a[60:63], v[60:63], v[44:47], 0
    v_mfma_f32_16x16x32_bf16 a[64:67], v[64:67], v[32:35], 0
    v_mfma_f32_16x16x32_bf16 a[68:71], v[64:67], v[36:39], 0
    v_mfma_f32_16x16x32_bf16 a[72:75], v[64:67], v[40:43], 0
    v_mfma_f32_16x16x32_bf16 a[76:79], v[64:67], v[44:47], 0
    buffer_load_dwordx4 v[32:35], v2, s[8:11], s25 offen offset:0
    buffer_load_dwordx4 v[36:39], v2, s[8:11], s25 offen offset:1024
    buffer_load_dwordx4 v[40:43], v2, s[8:11], s25 offen offset:2048
    buffer_load_dwordx4 v[44:47], v2, s[8:11], s25 offen offset:3072
    buffer_load_dwordx4 v[48:51], v2, s[12:15], s26 offen offset:0
    buffer_load_dwordx4 v[52:55], v2, s[12:15], s26 offen offset:1024
    buffer_load_dwordx4 v[56:59], v2, s[12:15], s26 offen offset:2048
    buffer_load_dwordx4 v[60:63], v2, s[12:15], s26 offen offset:3072
    buffer_load_dwordx4 v[64:67], v3, s[12:15], s26 offen
    s_add_u32 s25, s25, 4096
    s_add_u32 s26, s26, 5120
    s_waitcnt vmcnt(30)
    v_mfma_f32_16x16x32_bf16 a[0:3], v[84:87], v[68:71], a[0:3]
    v_mfma_f32_16x16x32_bf16 a[4:7], v[84:87], v[72:75], a[4:7]
    v_mfma_f32_16x16x32_bf16 a[8:11], v[84:87], v[76:79], a[8:11]
    v_mfma_f32_16x16x32_bf16 a[12:15], v[84:87], v[80:83], a[12:15]
    v_mfma_f32_16x16x32_bf16 a[16:19], v[88:91], v[68:71], a[16:19]
    v_mfma_f32_16x16x32_bf16 a[20:23], v[88:91], v[72:75], a[20:23]
    v_mfma_f32_16x16x32_bf16 a[24:27], v[88:91], v[76:79], a[24:27]
    v_mfma_f32_16x16x32_bf16 a[28:31], v[88:91], v[80:83], a[28:31]
    v_mfma_f32_16x16x32_bf16 a[32:35], v[92:95], v[68:71], a[32:35]
    v_mfma_f32_16x16x32_bf16 a[36:39], v[92:95], v[72:75], a[36:39]
    v_mfma_f32_16x16x32_bf16 a[40:43], v[92:95], v[76:79], a[40:43]
    v_mfma_f32_16x16x32_bf16 a[44:47], v[92:95], v[80:83], a[44:47]
    v_mfma_f32_16x16x32_bf16 a[48:51], v[96:99], v[68:71], a[48:51]
    v_mfma_f32_16x16x32_bf16 a[52:55], v[96:99], v[72:75], a[52:55]
    v_mfma_f32_16x16x32_bf16 a[56:59], v[96:99], v[76:79], a[56:59]
    v_mfma_f32_16x16x32_bf16 a[60:63], v[96:99], v[80:83], a[60:63]
    v_mfma_f32_16x16x32_bf16 a[64:67], v[100:103], v[68:71], a[64:67]
    v_mfma_f32_16x16x32_bf16 a[68:71], v[100:103], v[72:75], a[68:71]
    v_mfma_f32_16x16x32_bf16 a[72:75], v[100:103], v[76:79], a[72:75]
    v_mfma_f32_16x16x32_bf16 a[76:79], v[100:103], v[80:83], a[76:79]
    buffer_load_dwordx4 v[68:71], v2, s[8:11], s25 offen offset:0
    buffer_load_dwordx4 v[72:75], v2, s[8:11], s25 offen offset:1024
    buffer_load_dwordx4 v[76:79], v2, s[8:11], s25 offen offset:2048
    buffer_load_dwordx4 v[80:83], v2, s[8:11], s25 offen offset:3072
    buffer_load_dwordx4 v[84:87], v2, s[12:15], s26 offen offset:0
    buffer_load_dwordx4 v[88:91], v2, s[12:15], s26 offen offset:1024
    buffer_load_dwordx4 v[92:95], v2, s[12:15], s26 offen offset:2048
    buffer_load_dwordx4 v[96:99], v2, s[12:15], s26 offen offset:3072
    buffer_load_dwordx4 v[100:103], v3, s[12:15], s26 offen
    s_add_u32 s25, s25, 4096
    s_add_u32 s26, s26, 5120
    s_waitcnt vmcnt(30)
    v_mfma_f32_16x16x32_bf16 a[0:3], v[120:123], v[104:107], a[0:3]
    v_mfma_f32_16x16x32_bf16 a[4:7], v[120:123], v[108:111], a[4:7]
    v_mfma_f32_16x16x32_bf16 a[8:11], v[120:123], v[112:115], a[8:11]
    v_mfma_f32_16x16x32_bf16 a[12:15], v[120:123], v[116:119], a[12:15]
    v_mfma_f32_16x16x32_bf16 a[16:19], v[124:127], v[104:107], a[16:19]
    v_mfma_f32_16x16x32_bf16 a[20:23], v[124:127], v[108:111], a[20:23]
    v_mfma_f32_16x16x32_bf16 a[24:27], v[124:127], v[112:115], a[24:27]
    v_mfma_f32_16x16x32_bf16 a[28:31], v[124:127], v[116:119], a[28:31]
    v_mfma_f32_16x16x32_bf16 a[32:35], v[128:131], v[104:107], a[32:35]
    v_mfma_f32_16x16x32_bf16 a[36:39], v[128:131], v[108:111], a[36:39]
    v_mfma_f32_16x16x32_bf16 a[40:43], v[128:131], v[112:115], a[40:43]
    v_mfma_f32_16x16x32_bf16 a[44:47], v[128:131], v[116:119], a[44:47]
    v_mfma_f32_16x16x32_bf16 a[48:51], v[132:135], v[104:107], a[48:51]
    v_mfma_f32_16x16x32_bf16 a[52:55], v[132:135], v[108:111], a[52:55]
    v_mfma_f32_16x16x32_bf16 a[56:59], v[132:135], v[112:115], a[56:59]
    v_mfma_f32_16x16x32_bf16 a[60:63], v[132:135], v[116:119], a[60:63]
    v_mfma_f32_16x16x32_bf16 a[64:67], v[136:139], v[104:107], a[64:67]
    v_mfma_f32_16x16x32_bf16 a[68:71], v[136:139], v[108:111], a[68:71]
    v_mfma_f32_16x16x32_bf16 a[72:75], v[136:139], v[112:115], a[72:75]
    v_mfma_f32_16x16x32_bf16 a[76:79], v[136:139], v[116:119], a[76:79]
    buffer_load_dwordx4 v[104:107], v2, s[8:11], s25 offen offset:0
    buffer_load_dwordx4 v[108:111], v2, s[8:11], s25 offen offset:1024
    buffer_load_dwordx4 v[112:115], v2, s[8:11], s25 offen offset:2048
    buffer_load_dwordx4 v[116:119], v2, s[8:11], s25 offen offset:3072
    buffer_load_dwordx4 v[120:123], v2, s[12:15], s26 offen offset:0
    buffer_load_dwordx4 v[124:127], v2, s[12:15], s26 offen offset:1024
    buffer_load_dwordx4 v[128:131], v2, s[12:15], s26 offen offset:2048
    buffer_load_dwordx4 v[132:135], v2, s[12:15], s26 offen offset:3072
    buffer_load_dwordx4 v[136:139], v3, s[12:15], s26 offen
    s_add_u32 s25, s25, 4096
    s_add_u32 s26, s26, 5120
    s_waitcnt vmcnt(30)
    v_mfma_f32_16x16x32_bf16 a[0:3], v[156:159], v[140:143], a[0:3]
    v_mfma_f32_16x16x32_bf16 a[4:7], v[156:159], v[144:147], a[4:7]
    v_mfma_f32_16x16x32_bf16 a[8:11], v[156:159], v[148:151], a[8:11]
    v_mfma_f32_16x16x32_bf16 a[12:15], v[156:159], v[152:155], a[12:15]
    v_mfma_f32_16x16x32_bf16 a[16:19], v[160:163], v[140:143], a[16:19]
    v_mfma_f32_16x16x32_bf16 a[20:23], v[160:163], v[144:147], a[20:23]
    v_mfma_f32_16x16x32_bf16 a[24:27], v[160:163], v[148:151], a[24:27]
    v_mfma_f32_16x16x32_bf16 a[28:31], v[160:163], v[152:155], a[28:31]
    v_mfma_f32_16x16x32_bf16 a[32:35], v[164:167], v[140:143], a[32:35]
    v_mfma_f32_16x16x32_bf16 a[36:39], v[164:167], v[144:147], a[36:39]
    v_mfma_f32_16x16x32_bf16 a[40:43], v[164:167], v[148:151], a[40:43]
    v_mfma_f32_16x16x32_bf16 a[44:47], v[164:167], v[152:155], a[44:47]
    v_mfma_f32_16x16x32_bf16 a[48:51], v[168:171], v[140:143], a[48:51]
    v_mfma_f32_16x16x32_bf16 a[52:55], v[168:171], v[144:147], a[52:55]
    v_mfma_f32_16x16x32_bf16 a[56:59], v[168:171], v[148:151], a[56:59]
    v_mfma_f32_16x16x32_bf16 a[60:63], v[168:171], v[152:155], a[60:63]
    v_mfma_f32_16x16x32_bf16 a[64:67], v[172:175], v[140:143], a[64:67]
    v_mfma_f32_16x16x32_bf16 a[68:71], v[172:175], v[144:147], a[68:71]
    v_mfma_f32_16x16x32_bf16 a[72:75], v[172:175], v[148:151], a[72:75]
    v_mfma_f32_16x16x32_bf16 a[76:79], v[172:175], v[152:155], a[76:79]
    buffer_load_dwordx4 v[140:143], v2, s[8:11], s25 offen offset:0
    buffer_load_dwordx4 v[144:147], v2, s[8:11], s25 offen offset:1024
    buffer_load_dwordx4 v[148:151], v2, s[8:11], s25 offen offset:2048
    buffer_load_dwordx4 v[152:155], v2, s[8:11], s25 offen offset:3072
    buffer_load_dwordx4 v[156:159], v2, s[12:15], s26 offen offset:0
    buffer_load_dwordx4 v[160:163], v2, s[12:15], s26 offen offset:1024
    buffer_load_dwordx4 v[164:167], v2, s[12:15], s26 offen offset:2048
    buffer_load_dwordx4 v[168:171], v2, s[12:15], s26 offen offset:3072
    buffer_load_dwordx4 v[172:175], v3, s[12:15], s26 offen
    s_add_u32 s25, s25, 4096
    s_add_u32 s26, s26, 5120
    s_waitcnt vmcnt(27)
    v_mfma_f32_16x16x32_bf16 a[0:3], v[48:51], v[32:35], a[0:3]
    v_mfma_f32_16x16x32_bf16 a[4:7], v[48:51], v[36:39], a[4:7]
    v_mfma_f32_16x16x32_bf16 a[8:11], v[48:51], v[40:43], a[8:11]
    v_mfma_f32_16x16x32_bf16 a[12:15], v[48:51], v[44:47], a[12:15]
    v_mfma_f32_16x16x32_bf16 a[16:19], v[52:55], v[32:35], a[16:19]
    v_mfma_f32_16x16x32_bf16 a[20:23], v[52:55], v[36:39], a[20:23]
    v_mfma_f32_16x16x32_bf16 a[24:27], v[52:55], v[40:43], a[24:27]
    v_mfma_f32_16x16x32_bf16 a[28:31], v[52:55], v[44:47], a[28:31]
    v_mfma_f32_16x16x32_bf16 a[32:35], v[56:59], v[32:35], a[32:35]
    v_mfma_f32_16x16x32_bf16 a[36:39], v[56:59], v[36:39], a[36:39]
    v_mfma_f32_16x16x32_bf16 a[40:43], v[56:59], v[40:43], a[40:43]
    v_mfma_f32_16x16x32_bf16 a[44:47], v[56:59], v[44:47], a[44:47]
    v_mfma_f32_16x16x32_bf16 a[48:51], v[60:63], v[32:35], a[48:51]
    v_mfma_f32_16x16x32_bf16 a[52:55], v[60:63], v[36:39], a[52:55]
    v_mfma_f32_16x16x32_bf16 a[56:59], v[60:63], v[40:43], a[56:59]
    v_mfma_f32_16x16x32_bf16 a[60:63], v[60:63], v[44:47], a[60:63]
    v_mfma_f32_16x16x32_bf16 a[64:67], v[64:67], v[32:35], a[64:67]
    v_mfma_f32_16x16x32_bf16 a[68:71], v[64:67], v[36:39], a[68:71]
    v_mfma_f32_16x16x32_bf16 a[72:75], v[64:67], v[40:43], a[72:75]
    v_mfma_f32_16x16x32_bf16 a[76:79], v[64:67], v[44:47], a[76:79]
    buffer_load_dwordx4 v[32:35], v2, s[8:11], s25 offen offset:0
    buffer_load_dwordx4 v[36:39], v2, s[8:11], s25 offen offset:1024
    buffer_load_dwordx4 v[40:43], v2, s[8:11], s25 offen offset:2048
    buffer_load_dwordx4 v[44:47], v2, s[8:11], s25 offen offset:3072
    buffer_load_dwordx4 v[48:51], v2, s[12:15], s26 offen offset:0
    buffer_load_dwordx4 v[52:55], v2, s[12:15], s26 offen offset:1024
    buffer_load_dwordx4 v[56:59], v2, s[12:15], s26 offen offset:2048
    buffer_load_dwordx4 v[60:63], v2, s[12:15], s26 offen offset:3072
    buffer_load_dwordx4 v[64:67], v3, s[12:15], s26 offen
    s_add_u32 s25, s25, 4096
    s_add_u32 s26, s26, 5120
    s_waitcnt vmcnt(27)
    v_mfma_f32_16x16x32_bf16 a[0:3], v[84:87], v[68:71], a[0:3]
    v_mfma_f32_16x16x32_bf16 a[4:7], v[84:87], v[72:75], a[4:7]
    v_mfma_f32_16x16x32_bf16 a[8:11], v[84:87], v[76:79], a[8:11]
    v_mfma_f32_16x16x32_bf16 a[12:15], v[84:87], v[80:83], a[12:15]
    v_mfma_f32_16x16x32_bf16 a[16:19], v[88:91], v[68:71], a[16:19]
    v_mfma_f32_16x16x32_bf16 a[20:23], v[88:91], v[72:75], a[20:23]
    v_mfma_f32_16x16x32_bf16 a[24:27], v[88:91], v[76:79], a[24:27]
    v_mfma_f32_16x16x32_bf16 a[28:31], v[88:91], v[80:83], a[28:31]
    v_mfma_f32_16x16x32_bf16 a[32:35], v[92:95], v[68:71], a[32:35]
    v_mfma_f32_16x16x32_bf16 a[36:39], v[92:95], v[72:75], a[36:39]
    v_mfma_f32_16x16x32_bf16 a[40:43], v[92:95], v[76:79], a[40:43]
    v_mfma_f32_16x16x32_bf16 a[44:47], v[92:95], v[80:83], a[44:47]
    v_mfma_f32_16x16x32_bf16 a[48:51], v[96:99], v[68:71], a[48:51]
    v_mfma_f32_16x16x32_bf16 a[52:55], v[96:99], v[72:75], a[52:55]
    v_mfma_f32_16x16x32_bf16 a[56:59], v[96:99], v[76:79], a[56:59]
    v_mfma_f32_16x16x32_bf16 a[60:63], v[96:99], v[80:83], a[60:63]
    v_mfma_f32_16x16x32_bf16 a[64:67], v[100:103], v[68:71], a[64:67]
    v_mfma_f32_16x16x32_bf16 a[68:71], v[100:103], v[72:75], a[68:71]
    v_mfma_f32_16x16x32_bf16 a[72:75], v[100:103], v[76:79], a[72:75]
    v_mfma_f32_16x16x32_bf16 a[76:79], v[100:103], v[80:83], a[76:79]
    s_waitcnt vmcnt(18)
    v_mfma_f32_16x16x32_bf16 a[0:3], v[120:123], v[104:107], a[0:3]
    v_mfma_f32_16x16x32_bf16 a[4:7], v[120:123], v[108:111], a[4:7]
    v_mfma_f32_16x16x32_bf16 a[8:11], v[120:123], v[112:115], a[8:11]
    v_mfma_f32_16x16x32_bf16 a[12:15], v[120:123], v[116:119], a[12:15]
    v_mfma_f32_16x16x32_bf16 a[16:19], v[124:127], v[104:107], a[16:19]
    v_mfma_f32_16x16x32_bf16 a[20:23], v[124:127], v[108:111], a[20:23]
    v_mfma_f32_16x16x32_bf16 a[24:27], v[124:127], v[112:115], a[24:27]
    v_mfma_f32_16x16x32_bf16 a[28:31], v[124:127], v[116:119], a[28:31]
    v_mfma_f32_16x16x32_bf16 a[32:35], v[128:131], v[104:107], a[32:35]
    v_mfma_f32_16x16x32_bf16 a[36:39], v[128:131], v[108:111], a[36:39]
    v_mfma_f32_16x16x32_bf16 a[40:43], v[128:131], v[112:115], a[40:43]
    v_mfma_f32_16x16x32_bf16 a[44:47], v[128:131], v[116:119], a[44:47]
    v_mfma_f32_16x16x32_bf16 a[48:51], v[132:135], v[104:107], a[48:51]
    v_mfma_f32_16x16x32_bf16 a[52:55], v[132:135], v[108:111], a[52:55]
    v_mfma_f32_16x16x32_bf16 a[56:59], v[132:135], v[112:115], a[56:59]
    v_mfma_f32_16x16x32_bf16 a[60:63], v[132:135], v[116:119], a[60:63]
    v_mfma_f32_16x16x32_bf16 a[64:67], v[136:139], v[104:107], a[64:67]
    v_mfma_f32_16x16x32_bf16 a[68:71], v[136:139], v[108:111], a[68:71]
    v_mfma_f32_16x16x32_bf16 a[72:75], v[136:139], v[112:115], a[72:75]
    v_mfma_f32_16x16x32_bf16 a[76:79], v[136:139], v[116:119], a[76:79]
    s_waitcnt vmcnt(9)
    v_mfma_f32_16x16x32_bf16 a[0:3], v[156:159], v[140:143], a[0:3]
    v_mfma_f32_16x16x32_bf16 a[4:7], v[156:159], v[144:147], a[4:7]
    v_mfma_f32_16x16x32_bf16 a[8:11], v[156:159], v[148:151], a[8:11]
    v_mfma_f32_16x16x32_bf16 a[12:15], v[156:159], v[152:155], a[12:15]
    v_mfma_f32_16x16x32_bf16 a[16:19], v[160:163], v[140:143], a[16:19]
    v_mfma_f32_16x16x32_bf16 a[20:23], v[160:163], v[144:147], a[20:23]
    v_mfma_f32_16x16x32_bf16 a[24:27], v[160:163], v[148:151], a[24:27]
    v_mfma_f32_16x16x32_bf16 a[28:31], v[160:163], v[152:155], a[28:31]
    v_mfma_f32_16x16x32_bf16 a[32:35], v[164:167], v[140:143], a[32:35]
    v_mfma_f32_16x16x32_bf16 a[36:39], v[164:167], v[144:147], a[36:39]
    v_mfma_f32_16x16x32_bf16 a[40:43], v[164:167], v[148:151], a[40:43]
    v_mfma_f32_16x16x32_bf16 a[44:47], v[164:167], v[152:155], a[44:47]
    v_mfma_f32_16x16x32_bf16 a[48:51], v[168:171], v[140:143], a[48:51]
    v_mfma_f32_16x16x32_bf16 a[52:55], v[168:171], v[144:147], a[52:55]
    v_mfma_f32_16x16x32_bf16 a[56:59], v[168:171], v[148:151], a[56:59]
    v_mfma_f32_16x16x32_bf16 a[60:63], v[168:171], v[152:155], a[60:63]
    v_mfma_f32_16x16x32_bf16 a[64:67], v[172:175], v[140:143], a[64:67]
    v_mfma_f32_16x16x32_bf16 a[68:71], v[172:175], v[144:147], a[68:71]
    v_mfma_f32_16x16x32_bf16 a[72:75], v[172:175], v[148:151], a[72:75]
    v_mfma_f32_16x16x32_bf16 a[76:79], v[172:175], v[152:155], a[76:79]
    s_waitcnt vmcnt(0)
    v_mfma_f32_16x16x32_bf16 a[0:3], v[48:51], v[32:35], a[0:3]
    v_mfma_f32_16x16x32_bf16 a[4:7], v[48:51], v[36:39], a[4:7]
    v_mfma_f32_16x16x32_bf16 a[8:11], v[48:51], v[40:43], a[8:11]
    v_mfma_f32_16x16x32_bf16 a[12:15], v[48:51], v[44:47], a[12:15]
    v_mfma_f32_16x16x32_bf16 a[16:19], v[52:55], v[32:35], a[16:19]
    v_mfma_f32_16x16x32_bf16 a[20:23], v[52:55], v[36:39], a[20:23]
    v_mfma_f32_16x16x32_bf16 a[24:27], v[52:55], v[40:43], a[24:27]
    v_mfma_f32_16x16x32_bf16 a[28:31], v[52:55], v[44:47], a[28:31]
    v_mfma_f32_16x16x32_bf16 a[32:35], v[56:59], v[32:35], a[32:35]
    v_mfma_f32_16x16x32_bf16 a[36:39], v[56:59], v[36:39], a[36:39]
    v_mfma_f32_16x16x32_bf16 a[40:43], v[56:59], v[40:43], a[40:43]
    v_mfma_f32_16x16x32_bf16 a[44:47], v[56:59], v[44:47], a[44:47]
    v_mfma_f32_16x16x32_bf16 a[48:51], v[60:63], v[32:35], a[48:51]
    v_mfma_f32_16x16x32_bf16 a[52:55], v[60:63], v[36:39], a[52:55]
    v_mfma_f32_16x16x32_bf16 a[56:59], v[60:63], v[40:43], a[56:59]
    v_mfma_f32_16x16x32_bf16 a[60:63], v[60:63], v[44:47], a[60:63]
    v_mfma_f32_16x16x32_bf16 a[64:67], v[64:67], v[32:35], a[64:67]
    v_mfma_f32_16x16x32_bf16 a[68:71], v[64:67], v[36:39], a[68:71]
    v_mfma_f32_16x16x32_bf16 a[72:75], v[64:67], v[40:43], a[72:75]
    v_mfma_f32_16x16x32_bf16 a[76:79], v[64:67], v[44:47], a[76:79]
L_k2_epi:
    s_nop 15
    v_and_b32 v4, 15, v1
    v_mul_u32_u24 v4, 320, v4
    v_lshrrev_b32 v5, 4, v1
    v_lshl_add_u32 v4, v5, 4, v4
    s_mul_i32 s32, s20, 20480
    v_add_u32 v4, s32, v4
    ds_write_b128 v4, a[0:3] offset:0
    ds_write_b128 v4, a[4:7] offset:5120
    ds_write_b128 v4, a[8:11] offset:10240
    ds_write_b128 v4, a[12:15] offset:15360
    ds_write_b128 v4, a[16:19] offset:64
    ds_write_b128 v4, a[20:23] offset:5184
    ds_write_b128 v4, a[24:27] offset:10304
    ds_write_b128 v4, a[28:31] offset:15424
    ds_write_b128 v4, a[32:35] offset:128
    ds_write_b128 v4, a[36:39] offset:5248
    ds_write_b128 v4, a[40:43] offset:10368
    ds_write_b128 v4, a[44:47] offset:15488
    ds_write_b128 v4, a[48:51] offset:192
    ds_write_b128 v4, a[52:55] offset:5312
    ds_write_b128 v4, a[56:59] offset:10432
    ds_write_b128 v4, a[60:63] offset:15552
    ds_write_b128 v4, a[64:67] offset:256
    ds_write_b128 v4, a[68:71] offset:5376
    ds_write_b128 v4, a[72:75] offset:10496
    ds_write_b128 v4, a[76:79] offset:15616
    s_waitcnt vmcnt(0) lgkmcnt(0)
    s_barrier
    v_add_u32 v7, 0x14000, v17
    ds_read_b128 v[32:35], v17 offset:0
    ds_read_b128 v[36:39], v17 offset:20480
    ds_read_b128 v[40:43], v17 offset:40960
    ds_read_b128 v[44:47], v17 offset:61440
    ds_read_b128 v[48:51], v7 offset:0
    ds_read_b128 v[52:55], v7 offset:20480
    ds_read_b128 v[56:59], v7 offset:40960
    ds_read_b128 v[60:63], v7 offset:61440
    v_add_u32 v7, 0x14000, v18
    ds_read_b128 v[64:67], v18 offset:0
    ds_read_b128 v[68:71], v18 offset:20480
    ds_read_b128 v[72:75], v18 offset:40960
    ds_read_b128 v[76:79], v18 offset:61440
    ds_read_b128 v[80:83], v7 offset:0
    ds_read_b128 v[84:87], v7 offset:20480
    ds_read_b128 v[88:91], v7 offset:40960
    ds_read_b128 v[92:95], v7 offset:61440
    v_add_u32 v7, 0x14000, v19
    ds_read_b128 v[96:99], v19 offset:0
    ds_read_b128 v[100:103], v19 offset:20480
    ds_read_b128 v[104:107], v19 offset:40960
    ds_read_b128 v[108:111], v19 offset:61440
    ds_read_b128 v[112:115], v7 offset:0
    ds_read_b128 v[116:119], v7 offset:20480
    ds_read_b128 v[120:123], v7 offset:40960
    ds_read_b128 v[124:127], v7 offset:61440
    s_waitcnt lgkmcnt(0)
    v_add_f32 v32, v32, v36
    v_add_f32 v40, v40, v44
    v_add_f32 v48, v48, v52
    v_add_f32 v56, v56, v60
    v_add_f32 v33, v33, v37
    v_add_f32 v41, v41, v45
    v_add_f32 v49, v49, v53
    v_add_f32 v57, v57, v61
    v_add_f32 v34, v34, v38
    v_add_f32 v42, v42, v46
    v_add_f32 v50, v50, v54
    v_add_f32 v58, v58, v62
    v_add_f32 v35, v35, v39
    v_add_f32 v43, v43, v47
    v_add_f32 v51, v51, v55
    v_add_f32 v59, v59, v63
    v_add_f32 v40, v40, v48
    v_add_f32 v41, v41, v49
    v_add_f32 v42, v42, v50
    v_add_f32 v43, v43, v51
    v_add_f32 v36, v40, v56
    v_add_f32 v37, v41, v57
    v_add_f32 v38, v42, v58
    v_add_f32 v39, v43, v59
    v_cvt_pk_bf16_f32 v36, 0, v36
    v_cvt_pk_bf16_f32 v32, 0, v32
    v_cvt_pk_bf16_f32 v37, 0, v37
    v_cvt_pk_bf16_f32 v33, 0, v33
    v_cvt_pk_bf16_f32 v38, 0, v38
    v_cvt_pk_bf16_f32 v34, 0, v34
    v_cvt_pk_bf16_f32 v39, 0, v39
    v_cvt_pk_bf16_f32 v35, 0, v35
    v_mul_f32 v140, 0xbfb8aa3b, v36
    v_mul_f32 v141, 0xbfb8aa3b, v37
    v_mul_f32 v142, 0xbfb8aa3b, v38
    v_mul_f32 v143, 0xbfb8aa3b, v39
    v_exp_f32 v140, v140
    v_exp_f32 v141, v141
    v_exp_f32 v142, v142
    v_exp_f32 v143, v143
    v_add_f32 v140, 1.0, v140
    v_add_f32 v141, 1.0, v141
    v_add_f32 v142, 1.0, v142
    v_add_f32 v143, 1.0, v143
    v_rcp_f32 v140, v140
    v_rcp_f32 v141, v141
    v_rcp_f32 v142, v142
    v_rcp_f32 v143, v143
    v_mul_f32 v36, v36, v140
    v_mul_f32 v37, v37, v141
    v_mul_f32 v38, v38, v142
    v_mul_f32 v39, v39, v143
    v_cvt_pk_bf16_f32 v36, 0, v36
    v_cvt_pk_bf16_f32 v37, 0, v37
    v_cvt_pk_bf16_f32 v38, 0, v38
    v_cvt_pk_bf16_f32 v39, 0, v39
    v_mul_f32 v32, v32, v36
    v_mul_f32 v33, v33, v37
    v_mul_f32 v34, v34, v38
    v_mul_f32 v35, v35, v39
    v_cvt_pk_bf16_f32 v32, 0, v32
    v_cvt_pk_bf16_f32 v33, 0, v33
    v_cvt_pk_bf16_f32 v34, 0, v34
    v_cvt_pk_bf16_f32 v35, 0, v35
    v_lshlrev_b32 v140, 16, v8
    v_and_b32 v141, 0xffff0000, v8
    v_lshlrev_b32 v142, 16, v9
    v_and_b32 v143, 0xffff0000, v9
    v_add_f32 v32, v32, v140
    v_add_f32 v33, v33, v141
    v_add_f32 v34, v34, v142
    v_add_f32 v35, v35, v143
    v_cvt_pk_bf16_f32 v36, v32, v33
    v_cvt_pk_bf16_f32 v37, v34, v35
    buffer_store_dwordx2 v[36:37], v14, s[28:31], 0 offen
    v_add_f32 v64, v64, v68
    v_add_f32 v72, v72, v76
    v_add_f32 v80, v80, v84
    v_add_f32 v88, v88, v92
    v_add_f32 v65, v65, v69
    v_add_f32 v73, v73, v77
    v_add_f32 v81, v81, v85
    v_add_f32 v89, v89, v93
    v_add_f32 v66, v66, v70
    v_add_f32 v74, v74, v78
    v_add_f32 v82, v82, v86
    v_add_f32 v90, v90, v94
    v_add_f32 v67, v67, v71
    v_add_f32 v75, v75, v79
    v_add_f32 v83, v83, v87
    v_add_f32 v91, v91, v95
    v_add_f32 v72, v72, v80
    v_add_f32 v73, v73, v81
    v_add_f32 v74, v74, v82
    v_add_f32 v75, v75, v83
    v_add_f32 v68, v72, v88
    v_add_f32 v69, v73, v89
    v_add_f32 v70, v74, v90
    v_add_f32 v71, v75, v91
    v_cvt_pk_bf16_f32 v68, 0, v68
    v_cvt_pk_bf16_f32 v64, 0, v64
    v_cvt_pk_bf16_f32 v69, 0, v69
    v_cvt_pk_bf16_f32 v65, 0, v65
    v_cvt_pk_bf16_f32 v70, 0, v70
    v_cvt_pk_bf16_f32 v66, 0, v66
    v_cvt_pk_bf16_f32 v71, 0, v71
    v_cvt_pk_bf16_f32 v67, 0, v67
    v_mul_f32 v140, 0xbfb8aa3b, v68
    v_mul_f32 v141, 0xbfb8aa3b, v69
    v_mul_f32 v142, 0xbfb8aa3b, v70
    v_mul_f32 v143, 0xbfb8aa3b, v71
    v_exp_f32 v140, v140
    v_exp_f32 v141, v141
    v_exp_f32 v142, v142
    v_exp_f32 v143, v143
    v_add_f32 v140, 1.0, v140
    v_add_f32 v141, 1.0, v141
    v_add_f32 v142, 1.0, v142
    v_add_f32 v143, 1.0, v143
    v_rcp_f32 v140, v140
    v_rcp_f32 v141, v141
    v_rcp_f32 v142, v142
    v_rcp_f32 v143, v143
    v_mul_f32 v68, v68, v140
    v_mul_f32 v69, v69, v141
    v_mul_f32 v70, v70, v142
    v_mul_f32 v71, v71, v143
    v_cvt_pk_bf16_f32 v68, 0, v68
    v_cvt_pk_bf16_f32 v69, 0, v69
    v_cvt_pk_bf16_f32 v70, 0, v70
    v_cvt_pk_bf16_f32 v71, 0, v71
    v_mul_f32 v64, v64, v68
    v_mul_f32 v65, v65, v69
    v_mul_f32 v66, v66, v70
    v_mul_f32 v67, v67, v71
    v_cvt_pk_bf16_f32 v64, 0, v64
    v_cvt_pk_bf16_f32 v65, 0, v65
    v_cvt_pk_bf16_f32 v66, 0, v66
    v_cvt_pk_bf16_f32 v67, 0, v67
    v_lshlrev_b32 v140, 16, v10
    v_and_b32 v141, 0xffff0000, v10
    v_lshlrev_b32 v142, 16, v11
    v_and_b32 v143, 0xffff0000, v11
    v_add_f32 v64, v64, v140
    v_add_f32 v65, v65, v141
    v_add_f32 v66, v66, v142
    v_add_f32 v67, v67, v143
    v_cvt_pk_bf16_f32 v68, v64, v65
    v_cvt_pk_bf16_f32 v69, v66, v67
    buffer_store_dwordx2 v[68:69], v15, s[28:31], 0 offen
    v_add_f32 v96, v96, v100
    v_add_f32 v104, v104, v108
    v_add_f32 v112, v112, v116
    v_add_f32 v120, v120, v124
    v_add_f32 v97, v97, v101
    v_add_f32 v105, v105, v109
    v_add_f32 v113, v113, v117
    v_add_f32 v121, v121, v125
    v_add_f32 v98, v98, v102
    v_add_f32 v106, v106, v110
    v_add_f32 v114, v114, v118
    v_add_f32 v122, v122, v126
    v_add_f32 v99, v99, v103
    v_add_f32 v107, v107, v111
    v_add_f32 v115, v115, v119
    v_add_f32 v123, v123, v127
    v_add_f32 v104, v104, v112
    v_add_f32 v105, v105, v113
    v_add_f32 v106, v106, v114
    v_add_f32 v107, v107, v115
    v_add_f32 v100, v104, v120
    v_add_f32 v101, v105, v121
    v_add_f32 v102, v106, v122
    v_add_f32 v103, v107, v123
    v_cvt_pk_bf16_f32 v100, 0, v100
    v_cvt_pk_bf16_f32 v96, 0, v96
    v_cvt_pk_bf16_f32 v101, 0, v101
    v_cvt_pk_bf16_f32 v97, 0, v97
    v_cvt_pk_bf16_f32 v102, 0, v102
    v_cvt_pk_bf16_f32 v98, 0, v98
    v_cvt_pk_bf16_f32 v103, 0, v103
    v_cvt_pk_bf16_f32 v99, 0, v99
    v_mul_f32 v140, 0xbfb8aa3b, v100
    v_mul_f32 v141, 0xbfb8aa3b, v101
    v_mul_f32 v142, 0xbfb8aa3b, v102
    v_mul_f32 v143, 0xbfb8aa3b, v103
    v_exp_f32 v140, v140
    v_exp_f32 v141, v141
    v_exp_f32 v142, v142
    v_exp_f32 v143, v143
    v_add_f32 v140, 1.0, v140
    v_add_f32 v141, 1.0, v141
    v_add_f32 v142, 1.0, v142
    v_add_f32 v143, 1.0, v143
    v_rcp_f32 v140, v140
    v_rcp_f32 v141, v141
    v_rcp_f32 v142, v142
    v_rcp_f32 v143, v143
    v_mul_f32 v100, v100, v140
    v_mul_f32 v101, v101, v141
    v_mul_f32 v102, v102, v142
    v_mul_f32 v103, v103, v143
    v_cvt_pk_bf16_f32 v100, 0, v100
    v_cvt_pk_bf16_f32 v101, 0, v101
    v_cvt_pk_bf16_f32 v102, 0, v102
    v_cvt_pk_bf16_f32 v103, 0, v103
    v_mul_f32 v96, v96, v100
    v_mul_f32 v97, v97, v101
    v_mul_f32 v98, v98, v102
    v_mul_f32 v99, v99, v103
    v_cvt_pk_bf16_f32 v96, 0, v96
    v_cvt_pk_bf16_f32 v97, 0, v97
    v_cvt_pk_bf16_f32 v98, 0, v98
    v_cvt_pk_bf16_f32 v99, 0, v99
    v_lshlrev_b32 v140, 16, v12
    v_and_b32 v141, 0xffff0000, v12
    v_lshlrev_b32 v142, 16, v13
    v_and_b32 v143, 0xffff0000, v13
    v_add_f32 v96, v96, v140
    v_add_f32 v97, v97, v141
    v_add_f32 v98, v98, v142
    v_add_f32 v99, v99, v143
    v_cvt_pk_bf16_f32 v100, v96, v97
    v_cvt_pk_bf16_f32 v101, v98, v99
    v_cmp_gt_u32 vcc, 256, v0
    s_and_saveexec_b64 s[34:35], vcc
    s_cbranch_execz L_k2_skip
    buffer_store_dwordx2 v[100:101], v16, s[28:31], 0 offen
L_k2_skip:
L_k2_end:
    s_endpgm
.section .rodata,"a"
.p2align 6
.amdhsa_kernel rs_g2_kernel
  .amdhsa_next_free_vgpr 256
  .amdhsa_next_free_sgpr 96
  .amdhsa_accum_offset 176
  .amdhsa_group_segment_fixed_size 0
  .amdhsa_kernarg_size 72
  .amdhsa_user_sgpr_count 2
  .amdhsa_user_sgpr_kernarg_segment_ptr 1
  .amdhsa_system_sgpr_workgroup_id_x 1
.end_amdhsa_kernel
```
